```python
import torch

def _softmax(x, axis=-1):
    return torch.softmax(x, dim=axis)
def _gelu(x):
    return torch.nn.functional.gelu(x, approximate="tanh")
def _silu(x):
    return torch.nn.functional.silu(x)
def _sigmoid(x):
    return torch.sigmoid(x)
def _layernorm(x, axis=-1, eps=1e-5):
    m = x.mean(dim=axis, keepdim=True)
    v = x.var(dim=axis, keepdim=True, unbiased=False)
    return (x - m) / torch.sqrt(v + eps)
def _scatter_add(tgt, idx, src, axis=0):
    return tgt.clone().index_add_(axis, idx, src)
def _segment_sum(src, seg, n):
    out = torch.zeros((n,) + src.shape[1:], dtype=src.dtype)
    return out.index_add_(0, seg, src)
def _pad(x, pw):
    flat = tuple(v for pair in reversed(pw) for v in pair)
    return torch.nn.functional.pad(x, flat)

kernel_name = 'recurrent_scan__ssm_conv_h3__glu_gated_bilinear__prompt'

def setup_inputs():

    _w = (lambda a: (lambda t: t.to(torch.bfloat16) if t.is_floating_point() else t)(torch.as_tensor(a)))
    def _A_setup():
        B, S, D = 1, 2048, 576
        ks = 4
        return {
            "q": _w((lambda *s: torch.randn(*s, dtype=torch.bfloat16) * 0.05)(B, S, D)),
            "k": _w((lambda *s: torch.randn(*s, dtype=torch.bfloat16) * 0.8)(B, S, D)),
            "v": _w((lambda *s: torch.randn(*s, dtype=torch.bfloat16) * 0.8)(B, S, D)),
            "shift_k": _w((lambda *s: torch.randn(*s, dtype=torch.bfloat16) * 0.8)(D, ks) * 0.5),
            "ssm_k": _w((lambda *s: torch.randn(*s, dtype=torch.bfloat16) * 0.8)(D, S) * (1.0 / S ** 0.5)),
            "ssm_D": _w((lambda *s: torch.randn(*s, dtype=torch.bfloat16) * 0.8)(D)),
        }
    _A_in = _A_setup()

    def _B_setup():
        B, S, D, F = 1, 2048, 576, 4608
        return {
            "x": _w((lambda *s: torch.randn(*s, dtype=torch.bfloat16) * 0.05)(B, S, D)),
            "w_gate": _w((lambda *s: torch.randn(*s, dtype=torch.bfloat16) * 0.2)(D, F) * (D ** -0.5)),
            "w_up": _w((lambda *s: torch.randn(*s, dtype=torch.bfloat16) * 0.2)(D, F) * (D ** -0.5)),
            "w_down": _w((lambda *s: torch.randn(*s, dtype=torch.bfloat16) * 0.2)(F, D) * (F ** -0.5)),
        }
    _B_in = _B_setup()

    return {
        "A_q": _A_in["q"],
        "A_k": _A_in["k"],
        "A_v": _A_in["v"],
        "A_shift_k": _A_in["shift_k"],
        "A_ssm_k": _A_in["ssm_k"],
        "A_ssm_D": _A_in["ssm_D"],
        "B_x": _B_in["x"],
        "B_w_gate": _B_in["w_gate"],
        "B_w_up": _B_in["w_up"],
        "B_w_down": _B_in["w_down"],
    }

def reference(A_q, A_k, A_v, A_shift_k, A_ssm_k, A_ssm_D, B_x, B_w_gate, B_w_up, B_w_down):
    def _A_ref(q, k, v, shift_k, ssm_k, ssm_D):
        B, S, D = q.shape
        ks = shift_k.shape[-1]
        k_pad = _pad(k, ((0, 0), (ks - 1, 0), (0, 0)))
        k_shift = torch.zeros_like(k)
        for t in range(ks):
            k_shift = k_shift + k_pad[:, t:t + S, :] * shift_k[:, ks - 1 - t][None, None, :]
        kv = k_shift * v
        L = 2 * S
        kv_pad = _pad(kv, ((0, 0), (0, S), (0, 0)))
        kf_pad = _pad(ssm_k, ((0, 0), (0, S)))
        kv_f = (lambda x, axes=(-2,-1): torch.fft.rfft2(x.float(), dim=axes))(kv_pad[:, None, :, :], axes=(1, 2))
        kf_f = (lambda x, axes=(-2,-1): torch.fft.rfft2(x.float(), dim=axes))(kf_pad[:, None, :], axes=(1, 2))
        kf_f = (lambda x, *d: x.permute(*d))(kf_f, 1, 2, 0)
        y_f = kv_f * kf_f[None, :, :, :]
        y = (lambda x, s, axes=(-2,-1): torch.fft.irfft2(x, s=s, dim=axes).to(torch.bfloat16))(y_f, (1, L), axes=(1, 2))[:, 0, :S, :]
        y = y + kv * ssm_D[None, None, :]
        return q * y

    def _B_ref(x, w_gate, w_up, w_down):
        g = torch.einsum("bsd,df->bsf", x, w_gate)
        u = torch.einsum("bsd,df->bsf", x, w_up)
        h = g * u
        return torch.einsum("bsf,fd->bsd", h, w_down)

    x = A_q
    xn = _layernorm(x, axis=-1)
    s = _A_ref(xn, A_k, A_v, A_shift_k, A_ssm_k, A_ssm_D)
    g = _silu(_B_ref(xn, B_w_gate, B_w_up, B_w_down))
    return x + s * g
```

```asm
; @launch grid=(256,1,1) block=(256,1,1) lds=163840
.amdgcn_target "amdgcn-amd-amdhsa--gfx950"
.text
.p2align 12
.text
.globl recurrent_scan__ssm_conv_h3__glu_gated_bilinear__prompt_kernel
.p2align 8
.type recurrent_scan__ssm_conv_h3__glu_gated_bilinear__prompt_kernel,@function
recurrent_scan__ssm_conv_h3__glu_gated_bilinear__prompt_kernel:
s_cmp_ge_u32 s2, 256
s_cbranch_scc1 K_EXIT
s_mov_b32 s98, s2
s_load_dwordx16 s[68:83], s[0:1], 0
s_load_dwordx8 s[84:91], s[0:1], 64
s_load_dwordx2 s[92:93], s[0:1], 96
s_memrealtime s[94:95]
s_getpc_b64 s[8:9]
v_lshrrev_b32 v3, 2, v0
s_and_b32 s8, s8, 0xffffff00
s_mov_b32 s10, 8192
s_mov_b32 s11, 0x20000
v_lshlrev_b32 v3, 7, v3
buffer_load_dword v255, v3, s[8:11], 0 offen
v_lshrrev_b32 v2, 6, v0
v_and_b32 v1, 63, v0
v_readfirstlane_b32 s14, v2
s_getpc_b64 s[4:5]
s_and_b32 s44, s2, 7
s_lshr_b32 s45, s2, 3
s_and_b32 s41, s44, 3
s_lshr_b32 s44, s44, 2
s_lshl_b32 s44, s44, 3
s_lshr_b32 s48, s45, 2
s_add_u32 s40, s48, s44
s_and_b32 s42, s45, 3
s_lshl_b32 s43, s41, 2
s_add_u32 s43, s43, s42
s_lshr_b32 s46, s14, 1
s_and_b32 s47, s14, 1
s_lshl_b32 s66, s45, 2
s_add_u32 s66, s66, s14
s_mul_i32 s66, s66, 640
s_mov_b32 s58, 0xba987510
s_mov_b32 s59, 0xfedc6432
s_lshl_b32 s60, s40, 2
s_lshr_b64 s[58:59], s[58:59], s60
s_and_b32 s58, s58, 15
s_lshl_b32 s58, s58, 4
s_add_u32 s2, s58, s43
s_lshl_b32 s49, s40, 7
s_lshl_b32 s58, s43, 3
s_add_u32 s58, s58, s49
s_lshl_b32 s59, s14, 1
s_add_u32 s58, s58, s59
v_lshrrev_b32 v197, 5, v1
v_add_u32 v197, s58, v197
v_mul_u32_u24 v197, 1152, v197
v_and_b32 v198, 31, v1
v_lshl_add_u32 v197, v198, 4, v197
v_cmp_gt_u32 vcc, 8, v198
v_mov_b32 v201, 2146435072
v_mov_b32 v218, 0
v_cndmask_b32 v198, v201, v197, vcc
s_waitcnt lgkmcnt(0)
s_mov_b32 s36, s68
s_mov_b32 s37, s69
s_mov_b32 s38, 2359296
s_mov_b32 s39, 0x20000
s_mov_b32 s80, 0xffff0000
buffer_load_dwordx4 v[64:67], v197, s[36:39], 0 offen offset:0
buffer_load_dwordx4 v[68:71], v197, s[36:39], 0 offen offset:512
buffer_load_dwordx4 v[72:75], v198, s[36:39], 0 offen offset:1024
s_mov_b32 s28, s90
s_mov_b32 s29, s91
s_mov_b32 s30, 256
s_mov_b32 s31, 0x20000
s_or_b32 s58, s98, s14
s_cmp_lg_u32 s58, 0
s_cbranch_scc1 NO_NONCE
s_or_b32 s94, s94, 1
s_or_b32 s95, s95, 0x80000000
v_mov_b32 v216, s94
v_mov_b32 v217, s95
buffer_store_dwordx2 v[216:217], v218, s[28:31], 0 offen sc1
s_nop 1
NO_NONCE:
s_and_b32 s81, s4, 0xffffff00
v_lshlrev_b32 v7, 4, v1
v_and_b32 v192, 15, v1
v_lshrrev_b32 v193, 4, v1
s_lshl_b32 s49, s40, 7
s_lshl_b32 s58, s14, 5
s_add_u32 s49, s49, s58
v_lshrrev_b32 v194, 3, v1
v_add_u32 v6, s49, v194
v_mul_u32_u24 v6, 1152, v6
v_and_b32 v196, 7, v1
v_xor_b32 v196, v196, v194
v_lshl_add_u32 v6, v196, 4, v6
v_bfe_u32 v195, v1, 4, 1
s_lshl_b32 s58, s47, 1
v_or_b32 v195, s58, v195
v_bfe_u32 v196, v1, 1, 2
v_xor_b32 v195, v195, v196
s_lshl_b32 s58, s14, 3
v_add_u32 v194, s58, v194
v_mul_u32_u24 v194, 9216, v194
v_and_b32 v196, 1, v1
v_lshl_add_u32 v194, v196, 4, v194
v_lshl_add_u32 v2, v195, 5, v194
v_add_u32 v3, 292864, v2
s_mul_i32 s64, s43, 576
s_and_b32 s45, s43, 1
s_lshl_b32 s58, s45, 9
s_sub_u32 s63, s64, s58
s_add_u32 s63, s63, 512
s_lshl_b32 s58, s45, 6
s_add_u32 s64, s64, s58
s_mul_i32 s65, s14, 6144
s_lshl_b32 s60, s14, 12
v_mov_b32 v201, 2146435072
s_and_b32 s4, s4, 0xffffff00
s_mov_b32 s6, K_EXIT+4-recurrent_scan__ssm_conv_h3__glu_gated_bilinear__prompt_kernel
s_mov_b32 s7, 0x20000
v_lshlrev_b32 v60, 7, v1
v_add_u32 v60, s66, v60
v_cmp_gt_u32 vcc, 5, v1
s_nop 1
v_cndmask_b32 v60, v201, v60, vcc
s_lshl_b32 s49, s2, 1
s_add_u32 s49, s49, s46
s_mul_i32 s58, s49, 18
s_add_u32 s58, s58, 0
v_add_u32 v212, s58, v1
v_and_b32 v219, 15, v212
v_lshrrev_b32 v212, 4, v212
v_mul_u32_u24 v212, 9216, v212
v_mul_u32_u24 v213, 9, v219
v_and_b32 v219, 1, v219
v_add_u32 v219, v213, v219
v_lshl_add_u32 v212, v219, 6, v212
s_mul_i32 s58, s49, 18
s_add_u32 s58, s58, 9
v_add_u32 v215, s58, v1
v_and_b32 v219, 15, v215
v_lshrrev_b32 v215, 4, v215
v_mul_u32_u24 v215, 9216, v215
v_mul_u32_u24 v213, 9, v219
v_and_b32 v219, 1, v219
v_add_u32 v219, v213, v219
v_lshl_add_u32 v215, v219, 6, v215
v_cmp_gt_u32 vcc, 9, v1
s_nop 1
v_cndmask_b32 v212, v201, v212, vcc
v_cndmask_b32 v215, v201, v215, vcc
s_sub_u32 s44, s49, 144
s_mul_i32 s58, s44, 116
v_add_u32 v61, s58, v1
v_and_b32 v199, 15, v61
v_lshrrev_b32 v61, 4, v61
v_mul_u32_u24 v61, 9216, v61
v_mul_u32_u24 v200, 9, v199
v_and_b32 v199, 1, v199
v_add_u32 v200, v200, v199
v_lshl_add_u32 v61, v200, 6, v61
v_cmp_gt_u32 vcc, 58, v1
s_nop 1
v_cndmask_b32 v61, v201, v61, vcc
s_add_u32 s58, s58, 58
v_add_u32 v62, s58, v1
v_and_b32 v199, 15, v62
v_lshrrev_b32 v62, 4, v62
v_mul_u32_u24 v62, 9216, v62
v_mul_u32_u24 v200, 9, v199
v_and_b32 v199, 1, v199
v_add_u32 v200, v200, v199
v_lshl_add_u32 v62, v200, 6, v62
v_cmp_gt_u32 vcc, 58, v1
s_nop 1
v_cndmask_b32 v62, v201, v62, vcc
s_cmp_eq_u32 s47, 0
s_cselect_b32 s8, s82, s84
s_cselect_b32 s9, s83, s85
s_mov_b32 s10, 5308416
s_mov_b32 s11, 0x20000
buffer_load_dword v213, v212, s[8:11], 0 offen
buffer_load_dword v213, v215, s[8:11], 0 offen
buffer_load_dword v213, v60, s[4:7], 0 offen
s_mov_b32 s16, s82
s_mov_b32 s17, s83
s_mov_b32 s18, 5308416
s_mov_b32 s19, 0x20000
s_mov_b32 s32, s92
s_mov_b32 s33, s93
s_mov_b32 s34, 65011712
s_mov_b32 s35, 0x20000
s_add_u32 s24, s92, 37748736
s_addc_u32 s25, s93, 0
s_mov_b32 s26, 2359296
s_mov_b32 s27, 0x20000
s_sub_u32 s20, s84, 1024
s_subb_u32 s21, s85, 0
s_mov_b32 s22, 5309440
s_mov_b32 s23, 0x20000
s_lshl_b32 s0, s40, 9
s_add_u32 s0, s0, 63176704
s_lshl_b32 s1, s43, 2
s_add_u32 s1, s1, s14
s_lshl_b32 s1, s1, 3
s_add_u32 s1, s1, s0
v_lshlrev_b32 v63, 3, v1
v_mov_b32 v184, 0x3f803f80
s_waitcnt vmcnt(3)
buffer_load_dwordx2 v[216:217], v218, s[28:31], 0 offen sc1
v_mov_b32 v180, 0
v_mov_b32 v182, 0
v_mov_b32 v181, 0
v_mov_b32 v183, 0
v_dot2c_f32_bf16 v180, v64, v184
v_dot2c_f32_bf16 v182, v64, v64
v_dot2c_f32_bf16 v181, v65, v184
v_dot2c_f32_bf16 v183, v65, v65
v_dot2c_f32_bf16 v180, v66, v184
v_dot2c_f32_bf16 v182, v66, v66
v_dot2c_f32_bf16 v181, v67, v184
v_dot2c_f32_bf16 v183, v67, v67
v_dot2c_f32_bf16 v180, v68, v184
v_dot2c_f32_bf16 v182, v68, v68
v_dot2c_f32_bf16 v181, v69, v184
v_dot2c_f32_bf16 v183, v69, v69
v_dot2c_f32_bf16 v180, v70, v184
v_dot2c_f32_bf16 v182, v70, v70
v_dot2c_f32_bf16 v181, v71, v184
v_dot2c_f32_bf16 v183, v71, v71
v_dot2c_f32_bf16 v180, v72, v184
v_dot2c_f32_bf16 v182, v72, v72
v_dot2c_f32_bf16 v181, v73, v184
v_dot2c_f32_bf16 v183, v73, v73
v_dot2c_f32_bf16 v180, v74, v184
v_dot2c_f32_bf16 v182, v74, v74
v_dot2c_f32_bf16 v181, v75, v184
v_dot2c_f32_bf16 v183, v75, v75
v_lshlrev_b32 v76, 16, v64
v_and_b32 v77, s80, v64
v_lshlrev_b32 v78, 16, v65
v_and_b32 v79, s80, v65
v_add_f32 v180, v180, v181
v_add_f32 v182, v182, v183
v_lshlrev_b32 v80, 16, v66
v_and_b32 v81, s80, v66
v_add_f32_dpp v180, v180, v180 quad_perm:[1,0,3,2] row_mask:0xf bank_mask:0xf
v_add_f32_dpp v182, v182, v182 quad_perm:[1,0,3,2] row_mask:0xf bank_mask:0xf
v_lshlrev_b32 v82, 16, v67
v_and_b32 v83, s80, v67
v_add_f32_dpp v180, v180, v180 quad_perm:[2,3,0,1] row_mask:0xf bank_mask:0xf
v_add_f32_dpp v182, v182, v182 quad_perm:[2,3,0,1] row_mask:0xf bank_mask:0xf
v_lshlrev_b32 v84, 16, v68
v_and_b32 v85, s80, v68
v_add_f32_dpp v180, v180, v180 row_half_mirror row_mask:0xf bank_mask:0xf
v_add_f32_dpp v182, v182, v182 row_half_mirror row_mask:0xf bank_mask:0xf
v_lshlrev_b32 v86, 16, v69
v_and_b32 v87, s80, v69
v_add_f32_dpp v180, v180, v180 row_mirror row_mask:0xf bank_mask:0xf
v_add_f32_dpp v182, v182, v182 row_mirror row_mask:0xf bank_mask:0xf
v_mov_b32 v181, v180
v_mov_b32 v183, v182
v_lshlrev_b32 v88, 16, v70
v_and_b32 v89, s80, v70
v_permlane16_swap_b32 v180, v181
v_permlane16_swap_b32 v182, v183
v_lshlrev_b32 v90, 16, v71
v_and_b32 v91, s80, v71
v_add_f32 v180, v180, v181
v_add_f32 v182, v182, v183
v_mul_f32 v180, 0x3ae38e39, v180
v_mul_f32 v182, 0x3ae38e39, v182
v_fma_f32 v182, -v180, v180, v182
v_max_f32 v182, 0, v182
v_add_f32 v182, 0x3727c5ac, v182
v_rsq_f32 v182, v182
v_lshlrev_b32 v92, 16, v72
v_and_b32 v93, s80, v72
v_lshlrev_b32 v94, 16, v73
v_and_b32 v95, s80, v73
v_lshlrev_b32 v96, 16, v74
v_and_b32 v97, s80, v74
v_lshlrev_b32 v98, 16, v75
v_and_b32 v99, s80, v75
v_mul_f32 v180, v180, v182
v_fma_f32 v76, v76, v182, -v180
v_fma_f32 v77, v77, v182, -v180
v_fma_f32 v78, v78, v182, -v180
v_fma_f32 v79, v79, v182, -v180
v_fma_f32 v80, v80, v182, -v180
v_fma_f32 v81, v81, v182, -v180
v_fma_f32 v82, v82, v182, -v180
v_fma_f32 v83, v83, v182, -v180
v_cvt_pk_bf16_f32 v64, v76, v77
v_cvt_pk_bf16_f32 v65, v78, v79
v_cvt_pk_bf16_f32 v66, v80, v81
v_cvt_pk_bf16_f32 v67, v82, v83
buffer_store_dwordx4 v[64:67], v197, s[24:27], 0 offen offset:0 sc1
v_fma_f32 v84, v84, v182, -v180
v_fma_f32 v85, v85, v182, -v180
v_fma_f32 v86, v86, v182, -v180
v_fma_f32 v87, v87, v182, -v180
v_fma_f32 v88, v88, v182, -v180
v_fma_f32 v89, v89, v182, -v180
v_fma_f32 v90, v90, v182, -v180
v_fma_f32 v91, v91, v182, -v180
v_cvt_pk_bf16_f32 v68, v84, v85
v_cvt_pk_bf16_f32 v69, v86, v87
v_cvt_pk_bf16_f32 v70, v88, v89
v_cvt_pk_bf16_f32 v71, v90, v91
buffer_store_dwordx4 v[68:71], v197, s[24:27], 0 offen offset:512 sc1
v_fma_f32 v92, v92, v182, -v180
v_fma_f32 v93, v93, v182, -v180
v_fma_f32 v94, v94, v182, -v180
v_fma_f32 v95, v95, v182, -v180
v_fma_f32 v96, v96, v182, -v180
v_fma_f32 v97, v97, v182, -v180
v_fma_f32 v98, v98, v182, -v180
v_fma_f32 v99, v99, v182, -v180
v_cvt_pk_bf16_f32 v72, v92, v93
v_cvt_pk_bf16_f32 v73, v94, v95
v_cvt_pk_bf16_f32 v74, v96, v97
v_cvt_pk_bf16_f32 v75, v98, v99
buffer_store_dwordx4 v[72:75], v198, s[24:27], 0 offen offset:1024 sc1
v_and_b32 v196, 1, v195
v_lshl_add_u32 v4, v196, 5, v194
v_lshrrev_b32 v195, 1, v195
v_mul_u32_u24 v195, 2654208, v195
v_add_u32 v4, v4, v195
v_add_u32 v5, 292864, v4
v_bfe_u32 v196, v1, 2, 2
v_mul_u32_u24 v200, 6144, v193
v_lshl_add_u32 v200, v196, 7, v200
v_and_b32 v195, 1, v193
v_lshlrev_b32 v195, 1, v195
v_lshrrev_b32 v196, 1, v196
v_or_b32 v195, v195, v196
v_lshl_add_u32 v200, v195, 5, v200
v_and_b32 v195, 3, v1
v_lshl_add_u32 v200, v195, 3, v200
s_lshl_b32 s58, s47, 6
v_xor_b32 v8, s58, v200
v_xor_b32 v9, 32, v8
v_add_u32 v10, 49152, v8
v_add_u32 v11, 49152, v9
v_add_u32 v12, 98304, v8
v_add_u32 v13, 98304, v9
s_lshl_b32 s58, s47, 5
v_xor_b32 v220, s58, v200
v_xor_b32 v221, 64, v220
v_add_u32 v222, 49152, v220
v_add_u32 v223, 49152, v221
s_lshl_b32 s58, s46, 2
s_lshl_b32 s59, s47, 1
s_add_u32 s67, s58, s59
s_lshl_b32 s66, s67, 11
s_add_u32 s66, s66, 73728
v_and_b32 v195, 7, v192
v_xor_b32 v195, v195, v193
v_lshlrev_b32 v195, 4, v195
v_lshl_add_u32 v195, v192, 7, v195
v_add_u32 v14, s66, v195
v_xor_b32 v15, 4096, v14
v_xor_b32 v56, 64, v14
v_xor_b32 v57, 64, v15
s_lshl_b32 s58, s40, 3
s_lshl_b32 s59, s46, 2
s_add_u32 s58, s58, s59
s_lshl_b32 s59, s47, 1
s_mul_i32 s66, s43, 9
s_add_u32 s66, s66, s47
s_add_u32 s66, s66, s45
s_lshl_b32 s66, s66, 10
s_add_u32 s66, s66, 16777216
s_xor_b32 s67, s59, 0
s_add_u32 s67, s67, s58
s_mul_i32 s100, s67, 147456
s_add_u32 s100, s100, s66
s_xor_b32 s67, s59, 1
s_add_u32 s67, s67, s58
s_mul_i32 s101, s67, 147456
s_add_u32 s101, s101, s66
s_xor_b32 s67, s59, 2
s_add_u32 s67, s67, s58
s_mul_i32 s3, s67, 147456
s_add_u32 s3, s3, s66
s_xor_b32 s67, s59, 3
s_add_u32 s67, s67, s58
s_mul_i32 s15, s67, 147456
s_add_u32 s15, s15, s66
s_lshl_b32 s99, s47, 10
s_mul_i32 s58, s45, 9216
s_add_u32 s99, s99, s58
s_lshl_b32 s56, s40, 2
s_add_u32 s56, s56, s41
s_lshl_b32 s56, s56, 7
s_add_u32 s56, s56, 62980096
s_lshl_b32 s58, s42, 2
s_add_u32 s58, s58, s14
s_lshl_b32 s58, s58, 3
s_add_u32 s57, s56, s58
s_cmp_ge_u32 s2, 112
s_cselect_b32 s62, 0, 2146435072
v_mov_b32 v214, 2146435072
s_mov_b32 s61, 2146435072
v_add_u32 v185, 0, v1
v_mul_u32_u24 v186, 3641, v185
v_lshrrev_b32 v186, 16, v186
v_mul_u32_u24 v192, 864, v186
v_lshl_add_u32 v192, v185, 4, v192
v_add_u32 v185, 64, v1
v_mul_u32_u24 v186, 3641, v185
v_lshrrev_b32 v186, 16, v186
v_mul_u32_u24 v193, 864, v186
v_lshl_add_u32 v193, v185, 4, v193
v_subrev_u32 v193, 1024, v193
v_add_u32 v185, 128, v1
v_mul_u32_u24 v186, 3641, v185
v_lshrrev_b32 v186, 16, v186
v_mul_u32_u24 v194, 864, v186
v_lshl_add_u32 v194, v185, 4, v194
v_subrev_u32 v194, 2048, v194
v_add_u32 v185, 192, v1
v_mul_u32_u24 v186, 3641, v185
v_lshrrev_b32 v186, 16, v186
v_mul_u32_u24 v195, 864, v186
v_lshl_add_u32 v195, v185, 4, v195
v_subrev_u32 v195, 3072, v195
v_add_u32 v185, 256, v1
v_mul_u32_u24 v186, 3641, v185
v_lshrrev_b32 v186, 16, v186
v_mul_u32_u24 v196, 864, v186
v_lshl_add_u32 v196, v185, 4, v196
v_add_u32 v185, 320, v1
v_mul_u32_u24 v186, 3641, v185
v_lshrrev_b32 v186, 16, v186
v_mul_u32_u24 v197, 864, v186
v_lshl_add_u32 v197, v185, 4, v197
v_subrev_u32 v197, 1024, v197
v_add_u32 v185, 384, v1
v_mul_u32_u24 v186, 3641, v185
v_lshrrev_b32 v186, 16, v186
v_mul_u32_u24 v198, 864, v186
v_lshl_add_u32 v198, v185, 4, v198
v_subrev_u32 v198, 2048, v198
v_add_u32 v185, 448, v1
v_mul_u32_u24 v186, 3641, v185
v_lshrrev_b32 v186, 16, v186
v_mul_u32_u24 v199, 864, v186
v_lshl_add_u32 v199, v185, 4, v199
v_subrev_u32 v199, 3072, v199
v_add_u32 v185, 512, v1
v_mul_u32_u24 v186, 3641, v185
v_lshrrev_b32 v186, 16, v186
v_mul_u32_u24 v200, 864, v186
v_lshl_add_u32 v200, v185, 4, v200
v_and_b32 v185, 15, v1
v_lshrrev_b32 v186, 4, v1
s_mul_i32 s50, s14, 4160
s_add_u32 s50, s50, 73728
s_mul_i32 s51, s14, 9280
s_add_u32 s51, s51, 107264
v_lshrrev_b32 v202, 5, v1
v_mul_u32_u24 v201, 16768, v202
v_and_b32 v203, 31, v1
v_lshl_add_u32 v201, v203, 1, v201
v_add_u32 v201, s50, v201
v_mul_u32_u24 v202, 4640, v202
v_lshl_add_u32 v202, v203, 4, v202
v_add_u32 v202, s51, v202
v_lshl_add_u32 v203, v186, 2, v185
v_add_u32 v203, 1, v203
v_and_b32 v204, 1, v203
v_sub_u32 v203, v203, v204
v_lshlrev_b32 v203, 2, v203
v_mul_u32_u24 v204, 16768, v204
v_add_u32 v203, v203, v204
v_add_u32 v203, s50, v203
v_and_b32 v206, 1, v185
v_lshrrev_b32 v185, 1, v185
v_lshlrev_b32 v185, 6, v185
v_lshlrev_b32 v186, 4, v186
v_add_u32 v205, v185, v186
v_lshl_add_u32 v205, v206, 3, v205
v_xor_b32 v206, 1, v206
v_mul_u32_u24 v206, 4640, v206
v_add_u32 v206, s51, v206
v_sub_u32 v206, v206, v185
v_add_u32 v204, v206, v186
v_add_u32 v204, 448, v204
v_sub_u32 v206, v206, v186
v_add_u32 v206, 496, v206
v_bfe_u32 v219, v1, 3, 2
s_and_b32 s59, s42, 1
s_add_u32 s59, s59, 4
v_add_u32 v219, s59, v219
v_lshrrev_b32 v207, 5, v1
v_mul_u32_u24 v207, 144, v207
v_add_u32 v207, v207, v219
v_lshlrev_b32 v207, 10, v207
v_and_b32 v219, 7, v1
v_lshl_add_u32 v207, v219, 7, v207
v_and_b32 v219, 31, v1
v_cmp_gt_u32 vcc, 16, v219
v_mov_b32 v219, 2146435072
s_nop 0
v_cndmask_b32 v207, v219, v207, vcc
v_bfe_u32 v219, v1, 3, 2
s_and_b32 s59, s42, 1
s_add_u32 s59, s59, 6
v_add_u32 v219, s59, v219
v_cmp_lt_u32 vcc, 8, v219
v_subrev_u32 v208, 9, v219
s_nop 0
v_cndmask_b32 v219, v219, v208, vcc
v_lshrrev_b32 v208, 5, v1
v_mul_u32_u24 v208, 144, v208
v_add_u32 v208, v208, v219
v_lshlrev_b32 v208, 10, v208
v_and_b32 v219, 7, v1
v_lshl_add_u32 v208, v219, 7, v208
v_and_b32 v219, 31, v1
v_cmp_gt_u32 vcc, 24, v219
v_mov_b32 v219, 2146435072
s_nop 0
v_cndmask_b32 v208, v219, v208, vcc
v_bfe_u32 v219, v1, 3, 2
s_and_b32 s59, s42, 1
s_add_u32 s59, s59, 0
v_add_u32 v219, s59, v219
v_lshrrev_b32 v16, 5, v1
v_mul_u32_u24 v16, 144, v16
v_add_u32 v16, v16, v219
v_lshlrev_b32 v16, 10, v16
v_and_b32 v219, 7, v1
v_lshl_add_u32 v16, v219, 7, v16
v_add_u32 v28, 4096, v7
v_add_u32 v29, 8192, v7
v_add_u32 v30, 12288, v7
v_add_u32 v31, 16384, v7
v_mov_b32 v25, 0
v_lshlrev_b32 v20, 3, v1
s_lshl_b32 s59, s47, 9
v_add_u32 v17, s59, v20
v_add_u32 v20, 8192, v20
v_and_b32 v19, 15, v1
v_lshlrev_b32 v19, 3, v19
v_and_b32 v18, 7, v1
v_lshlrev_b32 v18, 3, v18
s_lshl_b32 s58, s40, 3
s_lshl_b32 s59, s14, 1
s_add_u32 s58, s58, s59
s_mul_i32 s58, s58, 144
s_mul_i32 s59, s43, 9
s_add_u32 s58, s58, s59
s_lshl_b32 s58, s58, 10
s_add_u32 s48, s58, 16777216
s_lshl_b32 s58, s40, 3
s_lshl_b32 s59, s46, 2
s_add_u32 s58, s58, s59
s_lshl_b32 s59, s47, 1
s_mul_i32 s50, s41, 36
s_mul_i32 s51, s47, 18
s_add_u32 s50, s50, s51
s_lshl_b32 s50, s50, 10
s_add_u32 s50, s50, 16777216
s_xor_b32 s51, s59, 0
s_add_u32 s51, s51, s58
s_mul_i32 s52, s51, 147456
s_add_u32 s52, s52, s50
s_xor_b32 s51, s59, 1
s_add_u32 s51, s51, s58
s_mul_i32 s53, s51, 147456
s_add_u32 s53, s53, s50
s_xor_b32 s51, s59, 2
s_add_u32 s51, s51, s58
s_mul_i32 s54, s51, 147456
s_add_u32 s54, s54, s50
s_xor_b32 s51, s59, 3
s_add_u32 s51, s51, s58
s_mul_i32 s55, s51, 147456
s_add_u32 s55, s55, s50
s_waitcnt vmcnt(0)
s_add_u32 s44, s94, 0xfffff830
s_mov_b32 s98, 0
s_branch NONCE_CHK
SLOWL_NONCE:
buffer_load_dwordx2 v[216:217], v218, s[28:31], 0 offen sc1
s_waitcnt vmcnt(0)
NONCE_CHK:
v_readfirstlane_b32 s94, v216
v_readfirstlane_b32 s95, v217
s_add_u32 s98, s98, 1
s_cmp_gt_u32 s98, 524288
s_cbranch_scc1 BACK_NONCE
s_cmp_eq_u32 s94, 0
s_cbranch_scc1 SLOWL_NONCE
s_cmp_eq_u32 s95, 0
s_cbranch_scc1 SLOWL_NONCE
s_sub_u32 s58, s94, s44
s_cmp_lt_i32 s58, 0
s_cbranch_scc1 SLOWL_NONCE
BACK_NONCE:
buffer_store_dwordx2 v[216:217], v218, s[32:35], s1 offen sc1
s_cmp_lt_u32 s2, 72
s_cbranch_scc1 KV_LOADS
s_cmp_ge_u32 s2, 112
s_cbranch_scc1 KV_ISSUED
buffer_load_dword v213, v61, s[8:11], 0 offen offset:128
buffer_load_dword v213, v62, s[8:11], 0 offen offset:128
buffer_load_dword v213, v61, s[8:11], 0 offen offset:256
buffer_load_dword v213, v62, s[8:11], 0 offen offset:256
KV_ISSUED:
s_mov_b32 s28, s78
s_mov_b32 s29, s79
s_mov_b32 s30, 1152
s_mov_b32 s31, 0x20000
s_lshl_b32 s58, s2, 2
s_add_u32 s58, s58, s14
s_lshl_b32 s58, s58, 1
s_sub_u32 s58, s58, 896
s_or_b32 s58, s58, s62
buffer_load_ushort v21, v218, s[28:31], s58 offen
s_add_u32 s66, s64, 0
s_add_u32 m0, s65, 0
s_nop 0
buffer_load_dwordx4 v2, s[16:19], s66 offen offset:0 lds
buffer_load_dwordx4 v2, s[20:23], s66 offen offset:1024 lds
buffer_load_dwordx4 v3, s[16:19], s66 offen offset:2048 lds
buffer_load_dwordx4 v3, s[20:23], s66 offen offset:3072 lds
s_add_u32 s66, s64, 589824
s_add_u32 m0, s65, 4096
s_nop 0
buffer_load_dwordx4 v2, s[16:19], s66 offen offset:0 lds
buffer_load_dwordx4 v2, s[20:23], s66 offen offset:1024 lds
s_add_u32 s66, s64, 884736
s_add_u32 m0, s65, 24576
s_nop 0
buffer_load_dwordx4 v2, s[16:19], s66 offen offset:0 lds
buffer_load_dwordx4 v2, s[20:23], s66 offen offset:1024 lds
buffer_load_dwordx4 v3, s[16:19], s66 offen offset:2048 lds
buffer_load_dwordx4 v3, s[20:23], s66 offen offset:3072 lds
s_add_u32 s66, s64, 1474560
s_add_u32 m0, s65, 28672
s_nop 0
buffer_load_dwordx4 v2, s[16:19], s66 offen offset:0 lds
buffer_load_dwordx4 v2, s[20:23], s66 offen offset:1024 lds
s_add_u32 s66, s64, 1769472
s_add_u32 m0, s65, 49152
s_nop 0
buffer_load_dwordx4 v2, s[16:19], s66 offen offset:0 lds
buffer_load_dwordx4 v2, s[20:23], s66 offen offset:1024 lds
buffer_load_dwordx4 v3, s[16:19], s66 offen offset:2048 lds
buffer_load_dwordx4 v3, s[20:23], s66 offen offset:3072 lds
s_add_u32 s66, s64, 2359296
s_add_u32 m0, s65, 53248
s_nop 0
buffer_load_dwordx4 v2, s[16:19], s66 offen offset:0 lds
buffer_load_dwordx4 v2, s[20:23], s66 offen offset:1024 lds
WALK_GO:
s_mov_b64 exec, 0
s_cmp_eq_u32 s14, 0
s_cbranch_scc1 WALK_0
s_cmp_eq_u32 s14, 1
s_cbranch_scc1 WALK_1
s_cmp_eq_u32 s14, 2
s_cbranch_scc1 WALK_2
s_branch WALK_3
WALK_DONE:
s_mov_b64 exec, -1
s_cmp_lt_u32 s2, 72
s_cbranch_scc1 KV_WAIT
s_mov_b32 s98, 0
buffer_load_dwordx2 v[58:59], v63, s[32:35], s0 offen sc1
s_branch PE_F1
PL_F1:
buffer_load_dwordx2 v[58:59], v63, s[32:35], s0 offen sc1
PE_F1:
s_add_u32 s98, s98, 1
s_waitcnt vmcnt(0)
v_cmp_ne_u64 vcc, s[94:95], v[58:59]
s_cmp_gt_u32 s98, 524288
s_cbranch_scc1 PD_F1
s_cmp_lg_u64 vcc, 0
s_cbranch_scc1 PL_F1
PD_F1:
s_mov_b32 s67, 0
s_add_u32 m0, s60, 73728
s_nop 0
buffer_load_dwordx4 v6, s[24:27], s67 offen offset:0 sc1 lds
s_mov_b32 s67, 8192
buffer_load_dwordx4 v6, s[24:27], s67 offen offset:1024 sc1 lds
s_mov_b32 s67, 16384
buffer_load_dwordx4 v6, s[24:27], s67 offen offset:2048 sc1 lds
s_mov_b32 s67, 24576
buffer_load_dwordx4 v6, s[24:27], s67 offen offset:3072 sc1 lds
s_mov_b32 s67, 128
s_add_u32 m0, s60, 90112
s_nop 0
buffer_load_dwordx4 v6, s[24:27], s67 offen offset:0 sc1 lds
s_mov_b32 s67, 8320
buffer_load_dwordx4 v6, s[24:27], s67 offen offset:1024 sc1 lds
s_mov_b32 s67, 16512
buffer_load_dwordx4 v6, s[24:27], s67 offen offset:2048 sc1 lds
s_mov_b32 s67, 24704
buffer_load_dwordx4 v6, s[24:27], s67 offen offset:3072 sc1 lds
s_mov_b32 s67, 256
s_add_u32 m0, s60, 106496
s_nop 0
buffer_load_dwordx4 v6, s[24:27], s67 offen offset:0 sc1 lds
s_mov_b32 s67, 8448
buffer_load_dwordx4 v6, s[24:27], s67 offen offset:1024 sc1 lds
s_mov_b32 s67, 16640
buffer_load_dwordx4 v6, s[24:27], s67 offen offset:2048 sc1 lds
s_mov_b32 s67, 24832
buffer_load_dwordx4 v6, s[24:27], s67 offen offset:3072 sc1 lds
s_waitcnt vmcnt(4)
KV_BACK:
s_mov_b32 s1, s5
s_barrier
ds_read_b128 v[224:227], v14 offset:0
ds_read_b128 v[228:231], v14 offset:2048
ds_read_b128 v[232:235], v15 offset:0
ds_read_b128 v[236:239], v15 offset:2048
ds_read_b128 v[240:243], v56 offset:0
ds_read_b128 v[244:247], v56 offset:2048
ds_read_b128 v[248:251], v57 offset:0
ds_read_b128 v[252:255], v57 offset:2048
ds_read_b128 a[0:3], v14 offset:16384
ds_read_b128 a[4:7], v14 offset:18432
ds_read_b128 a[8:11], v15 offset:16384
ds_read_b128 a[12:15], v15 offset:18432
ds_read_b64_tr_b16 v[32:33], v8 offset:0
ds_read_b64_tr_b16 v[34:35], v8 offset:512
ds_read_b64_tr_b16 v[36:37], v8 offset:2048
ds_read_b64_tr_b16 v[38:39], v8 offset:2560
ds_read_b64_tr_b16 v[40:41], v8 offset:4096
ds_read_b64_tr_b16 v[42:43], v8 offset:4608
ds_read_b128 a[16:19], v56 offset:16384
ds_read_b128 a[20:23], v56 offset:18432
ds_read_b128 a[24:27], v57 offset:16384
ds_read_b128 a[28:31], v57 offset:18432
s_waitcnt lgkmcnt(4)
v_mfma_f32_16x16x32_bf16 v[64:67], v[32:35], v[224:227], 0
ds_read_b64_tr_b16 v[44:45], v8 offset:1024
v_mfma_f32_16x16x32_bf16 v[64:67], v[36:39], v[240:243], v[64:67]
ds_read_b64_tr_b16 v[46:47], v8 offset:1536
v_mfma_f32_16x16x32_bf16 v[64:67], v[40:43], a[0:3], v[64:67]
ds_read_b64_tr_b16 v[48:49], v8 offset:3072
v_mfma_f32_16x16x32_bf16 v[68:71], v[40:43], a[4:7], 0
ds_read_b64_tr_b16 v[50:51], v8 offset:3584
v_mfma_f32_16x16x32_bf16 v[68:71], v[36:39], v[244:247], v[68:71]
ds_read_b64_tr_b16 v[52:53], v8 offset:5120
v_mfma_f32_16x16x32_bf16 v[68:71], v[32:35], v[228:231], v[68:71]
ds_read_b64_tr_b16 v[54:55], v8 offset:5632
v_mfma_f32_16x16x32_bf16 v[72:75], v[32:35], v[232:235], 0
s_mov_b32 s67, 384
s_add_u32 m0, s60, 122880
v_mfma_f32_16x16x32_bf16 v[72:75], v[36:39], v[248:251], v[72:75]
buffer_load_dwordx4 v6, s[24:27], s67 offen offset:0 sc1 lds
s_mov_b32 s67, 8576
v_mfma_f32_16x16x32_bf16 v[72:75], v[40:43], a[8:11], v[72:75]
buffer_load_dwordx4 v6, s[24:27], s67 offen offset:1024 sc1 lds
s_mov_b32 s67, 16768
v_mfma_f32_16x16x32_bf16 v[76:79], v[40:43], a[12:15], 0
v_mfma_f32_16x16x32_bf16 v[76:79], v[36:39], v[252:255], v[76:79]
buffer_load_dwordx4 v6, s[24:27], s67 offen offset:2048 sc1 lds
v_mfma_f32_16x16x32_bf16 v[76:79], v[32:35], v[236:239], v[76:79]
s_waitcnt lgkmcnt(0)
v_mfma_f32_16x16x32_bf16 v[96:99], v[44:47], v[224:227], 0
ds_read_b64_tr_b16 v[32:33], v9 offset:0
s_mov_b32 s67, 24960
v_mfma_f32_16x16x32_bf16 v[96:99], v[48:51], v[240:243], v[96:99]
ds_read_b64_tr_b16 v[34:35], v9 offset:512
v_mfma_f32_16x16x32_bf16 v[96:99], v[52:55], a[0:3], v[96:99]
ds_read_b64_tr_b16 v[36:37], v9 offset:2048
buffer_load_dwordx4 v6, s[24:27], s67 offen offset:3072 sc1 lds
v_mfma_f32_16x16x32_bf16 v[100:103], v[52:55], a[4:7], 0
ds_read_b64_tr_b16 v[38:39], v9 offset:2560
v_mfma_f32_16x16x32_bf16 v[100:103], v[48:51], v[244:247], v[100:103]
ds_read_b64_tr_b16 v[40:41], v9 offset:4096
v_mfma_f32_16x16x32_bf16 v[100:103], v[44:47], v[228:231], v[100:103]
ds_read_b64_tr_b16 v[42:43], v9 offset:4608
v_mfma_f32_16x16x32_bf16 v[104:107], v[44:47], v[232:235], 0
s_mov_b32 s67, 512
s_add_u32 m0, s60, 139264
v_mfma_f32_16x16x32_bf16 v[104:107], v[48:51], v[248:251], v[104:107]
buffer_load_dwordx4 v6, s[24:27], s67 offen offset:0 sc1 lds
v_mfma_f32_16x16x32_bf16 v[104:107], v[52:55], a[8:11], v[104:107]
v_mfma_f32_16x16x32_bf16 v[108:111], v[52:55], a[12:15], 0
s_mov_b32 s67, 8704
v_mfma_f32_16x16x32_bf16 v[108:111], v[48:51], v[252:255], v[108:111]
v_mfma_f32_16x16x32_bf16 v[108:111], v[44:47], v[236:239], v[108:111]
buffer_load_dwordx4 v6, s[24:27], s67 offen offset:1024 sc1 lds
s_waitcnt lgkmcnt(0)
v_mfma_f32_16x16x32_bf16 v[80:83], v[32:35], v[224:227], 0
ds_read_b64_tr_b16 v[44:45], v9 offset:1024
v_mfma_f32_16x16x32_bf16 v[80:83], v[36:39], v[240:243], v[80:83]
ds_read_b64_tr_b16 v[46:47], v9 offset:1536
s_mov_b32 s67, 16896
v_mfma_f32_16x16x32_bf16 v[80:83], v[40:43], a[0:3], v[80:83]
ds_read_b64_tr_b16 v[48:49], v9 offset:3072
v_mfma_f32_16x16x32_bf16 v[84:87], v[40:43], a[4:7], 0
ds_read_b64_tr_b16 v[50:51], v9 offset:3584
buffer_load_dwordx4 v6, s[24:27], s67 offen offset:2048 sc1 lds
v_mfma_f32_16x16x32_bf16 v[84:87], v[36:39], v[244:247], v[84:87]
ds_read_b64_tr_b16 v[52:53], v9 offset:5120
v_mfma_f32_16x16x32_bf16 v[84:87], v[32:35], v[228:231], v[84:87]
ds_read_b64_tr_b16 v[54:55], v9 offset:5632
s_mov_b32 s67, 25088
v_mfma_f32_16x16x32_bf16 v[88:91], v[32:35], v[232:235], 0
v_mfma_f32_16x16x32_bf16 v[88:91], v[36:39], v[248:251], v[88:91]
buffer_load_dwordx4 v6, s[24:27], s67 offen offset:3072 sc1 lds
v_mfma_f32_16x16x32_bf16 v[88:91], v[40:43], a[8:11], v[88:91]
v_mfma_f32_16x16x32_bf16 v[92:95], v[40:43], a[12:15], 0
v_mfma_f32_16x16x32_bf16 v[92:95], v[36:39], v[252:255], v[92:95]
v_mfma_f32_16x16x32_bf16 v[92:95], v[32:35], v[236:239], v[92:95]
s_waitcnt lgkmcnt(0)
v_mfma_f32_16x16x32_bf16 v[112:115], v[44:47], v[224:227], 0
s_waitcnt lgkmcnt(0)
s_waitcnt vmcnt(8)
s_barrier
v_mfma_f32_16x16x32_bf16 v[112:115], v[48:51], v[240:243], v[112:115]
ds_read_b64_tr_b16 v[32:33], v8 offset:24576
ds_read_b128 a[32:35], v14 offset:32768
v_mfma_f32_16x16x32_bf16 v[112:115], v[52:55], a[0:3], v[112:115]
ds_read_b64_tr_b16 v[34:35], v8 offset:25088
ds_read_b128 a[36:39], v14 offset:34816
v_mfma_f32_16x16x32_bf16 v[116:119], v[52:55], a[4:7], 0
ds_read_b64_tr_b16 v[36:37], v8 offset:26624
ds_read_b128 a[40:43], v15 offset:32768
v_mfma_f32_16x16x32_bf16 v[116:119], v[48:51], v[244:247], v[116:119]
ds_read_b64_tr_b16 v[38:39], v8 offset:27136
ds_read_b128 a[44:47], v15 offset:34816
v_mfma_f32_16x16x32_bf16 v[116:119], v[44:47], v[228:231], v[116:119]
ds_read_b64_tr_b16 v[40:41], v8 offset:28672
v_mfma_f32_16x16x32_bf16 v[120:123], v[44:47], v[232:235], 0
ds_read_b64_tr_b16 v[42:43], v8 offset:29184
v_mfma_f32_16x16x32_bf16 v[120:123], v[48:51], v[248:251], v[120:123]
s_mov_b32 s67, 640
s_add_u32 m0, s60, 73728
v_mfma_f32_16x16x32_bf16 v[120:123], v[52:55], a[8:11], v[120:123]
buffer_load_dwordx4 v6, s[24:27], s67 offen offset:0 sc1 lds
s_mov_b32 s67, 8832
v_mfma_f32_16x16x32_bf16 v[124:127], v[52:55], a[12:15], 0
buffer_load_dwordx4 v6, s[24:27], s67 offen offset:1024 sc1 lds
s_mov_b32 s67, 17024
v_mfma_f32_16x16x32_bf16 v[124:127], v[48:51], v[252:255], v[124:127]
buffer_load_dwordx4 v6, s[24:27], s67 offen offset:2048 sc1 lds
s_mov_b32 s67, 25216
v_mfma_f32_16x16x32_bf16 v[124:127], v[44:47], v[236:239], v[124:127]
buffer_load_dwordx4 v6, s[24:27], s67 offen offset:3072 sc1 lds
ds_read_b128 a[48:51], v56 offset:32768
ds_read_b128 a[52:55], v56 offset:34816
ds_read_b128 a[56:59], v57 offset:32768
ds_read_b128 a[60:63], v57 offset:34816
s_waitcnt lgkmcnt(0)
v_mfma_f32_16x16x32_bf16 v[64:67], v[32:35], a[16:19], v[64:67]
ds_read_b64_tr_b16 v[44:45], v8 offset:25600
v_mfma_f32_16x16x32_bf16 v[64:67], v[36:39], a[32:35], v[64:67]
ds_read_b64_tr_b16 v[46:47], v8 offset:26112
v_mfma_f32_16x16x32_bf16 v[64:67], v[40:43], a[48:51], v[64:67]
ds_read_b64_tr_b16 v[48:49], v8 offset:27648
v_mfma_f32_16x16x32_bf16 v[68:71], v[40:43], a[52:55], v[68:71]
ds_read_b64_tr_b16 v[50:51], v8 offset:28160
v_mfma_f32_16x16x32_bf16 v[68:71], v[36:39], a[36:39], v[68:71]
ds_read_b64_tr_b16 v[52:53], v8 offset:29696
v_mfma_f32_16x16x32_bf16 v[68:71], v[32:35], a[20:23], v[68:71]
ds_read_b64_tr_b16 v[54:55], v8 offset:30208
v_mfma_f32_16x16x32_bf16 v[72:75], v[32:35], a[24:27], v[72:75]
s_mov_b32 s67, 768
s_add_u32 m0, s60, 90112
v_mfma_f32_16x16x32_bf16 v[72:75], v[36:39], a[40:43], v[72:75]
buffer_load_dwordx4 v6, s[24:27], s67 offen offset:0 sc1 lds
s_mov_b32 s67, 8960
v_mfma_f32_16x16x32_bf16 v[72:75], v[40:43], a[56:59], v[72:75]
buffer_load_dwordx4 v6, s[24:27], s67 offen offset:1024 sc1 lds
v_mfma_f32_16x16x32_bf16 v[76:79], v[40:43], a[60:63], v[76:79]
v_mfma_f32_16x16x32_bf16 v[76:79], v[36:39], a[44:47], v[76:79]
v_mfma_f32_16x16x32_bf16 v[76:79], v[32:35], a[28:31], v[76:79]
s_mov_b32 s67, 17152
s_waitcnt lgkmcnt(0)
v_mfma_f32_16x16x32_bf16 v[96:99], v[44:47], a[16:19], v[96:99]
ds_read_b64_tr_b16 v[32:33], v9 offset:24576
v_mfma_f32_16x16x32_bf16 v[96:99], v[48:51], a[32:35], v[96:99]
ds_read_b64_tr_b16 v[34:35], v9 offset:25088
v_mfma_f32_16x16x32_bf16 v[96:99], v[52:55], a[48:51], v[96:99]
ds_read_b64_tr_b16 v[36:37], v9 offset:26624
buffer_load_dwordx4 v6, s[24:27], s67 offen offset:2048 sc1 lds
v_mfma_f32_16x16x32_bf16 v[100:103], v[52:55], a[52:55], v[100:103]
ds_read_b64_tr_b16 v[38:39], v9 offset:27136
v_mfma_f32_16x16x32_bf16 v[100:103], v[48:51], a[36:39], v[100:103]
ds_read_b64_tr_b16 v[40:41], v9 offset:28672
v_mfma_f32_16x16x32_bf16 v[100:103], v[44:47], a[20:23], v[100:103]
ds_read_b64_tr_b16 v[42:43], v9 offset:29184
s_mov_b32 s67, 25344
v_mfma_f32_16x16x32_bf16 v[104:107], v[44:47], a[24:27], v[104:107]
v_mfma_f32_16x16x32_bf16 v[104:107], v[48:51], a[40:43], v[104:107]
v_mfma_f32_16x16x32_bf16 v[104:107], v[52:55], a[56:59], v[104:107]
buffer_load_dwordx4 v6, s[24:27], s67 offen offset:3072 sc1 lds
v_mfma_f32_16x16x32_bf16 v[108:111], v[52:55], a[60:63], v[108:111]
v_mfma_f32_16x16x32_bf16 v[108:111], v[48:51], a[44:47], v[108:111]
v_mfma_f32_16x16x32_bf16 v[108:111], v[44:47], a[28:31], v[108:111]
s_add_u32 s66, s64, 2654208
s_add_u32 m0, s65, 0
s_waitcnt lgkmcnt(0)
v_mfma_f32_16x16x32_bf16 v[80:83], v[32:35], a[16:19], v[80:83]
ds_read_b64_tr_b16 v[44:45], v9 offset:25600
v_mfma_f32_16x16x32_bf16 v[80:83], v[36:39], a[32:35], v[80:83]
ds_read_b64_tr_b16 v[46:47], v9 offset:26112
buffer_load_dwordx4 v2, s[16:19], s66 offen offset:0 lds
v_mfma_f32_16x16x32_bf16 v[80:83], v[40:43], a[48:51], v[80:83]
ds_read_b64_tr_b16 v[48:49], v9 offset:27648
v_mfma_f32_16x16x32_bf16 v[84:87], v[40:43], a[52:55], v[84:87]
ds_read_b64_tr_b16 v[50:51], v9 offset:28160
v_mfma_f32_16x16x32_bf16 v[84:87], v[36:39], a[36:39], v[84:87]
ds_read_b64_tr_b16 v[52:53], v9 offset:29696
buffer_load_dwordx4 v2, s[20:23], s66 offen offset:1024 lds
v_mfma_f32_16x16x32_bf16 v[84:87], v[32:35], a[20:23], v[84:87]
ds_read_b64_tr_b16 v[54:55], v9 offset:30208
v_mfma_f32_16x16x32_bf16 v[88:91], v[32:35], a[24:27], v[88:91]
v_mfma_f32_16x16x32_bf16 v[88:91], v[36:39], a[40:43], v[88:91]
buffer_load_dwordx4 v3, s[16:19], s66 offen offset:2048 lds
v_mfma_f32_16x16x32_bf16 v[88:91], v[40:43], a[56:59], v[88:91]
v_mfma_f32_16x16x32_bf16 v[92:95], v[40:43], a[60:63], v[92:95]
v_mfma_f32_16x16x32_bf16 v[92:95], v[36:39], a[44:47], v[92:95]
buffer_load_dwordx4 v3, s[20:23], s66 offen offset:3072 lds
v_mfma_f32_16x16x32_bf16 v[92:95], v[32:35], a[28:31], v[92:95]
s_waitcnt lgkmcnt(0)
v_mfma_f32_16x16x32_bf16 v[112:115], v[44:47], a[16:19], v[112:115]
s_waitcnt lgkmcnt(0)
s_waitcnt vmcnt(12)
s_barrier
v_mfma_f32_16x16x32_bf16 v[112:115], v[48:51], a[32:35], v[112:115]
ds_read_b64_tr_b16 v[32:33], v10 offset:0
ds_read_b128 a[64:67], v14 offset:49152
s_add_u32 s66, s64, 3244032
s_add_u32 m0, s65, 4096
v_mfma_f32_16x16x32_bf16 v[112:115], v[52:55], a[48:51], v[112:115]
ds_read_b64_tr_b16 v[34:35], v10 offset:512
ds_read_b128 a[68:71], v14 offset:51200
v_mfma_f32_16x16x32_bf16 v[116:119], v[52:55], a[52:55], v[116:119]
ds_read_b64_tr_b16 v[36:37], v10 offset:2048
ds_read_b128 a[72:75], v15 offset:49152
v_mfma_f32_16x16x32_bf16 v[116:119], v[48:51], a[36:39], v[116:119]
ds_read_b64_tr_b16 v[38:39], v10 offset:2560
ds_read_b128 a[76:79], v15 offset:51200
buffer_load_dwordx4 v2, s[16:19], s66 offen offset:0 lds
v_mfma_f32_16x16x32_bf16 v[116:119], v[44:47], a[20:23], v[116:119]
ds_read_b64_tr_b16 v[40:41], v10 offset:4096
ds_read_b128 a[80:83], v56 offset:49152
v_mfma_f32_16x16x32_bf16 v[120:123], v[44:47], a[24:27], v[120:123]
ds_read_b64_tr_b16 v[42:43], v10 offset:4608
ds_read_b128 a[84:87], v56 offset:51200
v_mfma_f32_16x16x32_bf16 v[120:123], v[48:51], a[40:43], v[120:123]
ds_read_b128 a[88:91], v57 offset:49152
ds_read_b128 a[92:95], v57 offset:51200
buffer_load_dwordx4 v2, s[20:23], s66 offen offset:1024 lds
v_mfma_f32_16x16x32_bf16 v[120:123], v[52:55], a[56:59], v[120:123]
v_add_u32 v14, 0x10000, v14
v_add_u32 v15, 0x10000, v15
v_mfma_f32_16x16x32_bf16 v[124:127], v[52:55], a[60:63], v[124:127]
v_add_u32 v56, 0x10000, v56
v_add_u32 v57, 0x10000, v57
v_mfma_f32_16x16x32_bf16 v[124:127], v[48:51], a[44:47], v[124:127]
ds_read_b128 a[96:99], v14 offset:0
ds_read_b128 a[100:103], v14 offset:2048
v_mfma_f32_16x16x32_bf16 v[124:127], v[44:47], a[28:31], v[124:127]
ds_read_b128 a[104:107], v15 offset:0
ds_read_b128 a[108:111], v15 offset:2048
ds_read_b128 a[112:115], v56 offset:0
ds_read_b128 a[116:119], v56 offset:2048
ds_read_b128 a[120:123], v57 offset:0
ds_read_b128 a[124:127], v57 offset:2048
v_subrev_u32 v14, 0x10000, v14
v_subrev_u32 v15, 0x10000, v15
v_subrev_u32 v56, 0x10000, v56
v_subrev_u32 v57, 0x10000, v57
s_waitcnt lgkmcnt(4)
v_mfma_f32_16x16x32_bf16 v[64:67], v[32:35], a[64:67], v[64:67]
ds_read_b64_tr_b16 v[44:45], v10 offset:1024
v_mfma_f32_16x16x32_bf16 v[64:67], v[36:39], a[80:83], v[64:67]
ds_read_b64_tr_b16 v[46:47], v10 offset:1536
v_mfma_f32_16x16x32_bf16 v[64:67], v[40:43], a[96:99], v[64:67]
ds_read_b64_tr_b16 v[48:49], v10 offset:3072
v_mfma_f32_16x16x32_bf16 v[68:71], v[40:43], a[100:103], v[68:71]
ds_read_b64_tr_b16 v[50:51], v10 offset:3584
v_mfma_f32_16x16x32_bf16 v[68:71], v[36:39], a[84:87], v[68:71]
ds_read_b64_tr_b16 v[52:53], v10 offset:5120
v_mfma_f32_16x16x32_bf16 v[68:71], v[32:35], a[68:71], v[68:71]
ds_read_b64_tr_b16 v[54:55], v10 offset:5632
v_mfma_f32_16x16x32_bf16 v[72:75], v[32:35], a[72:75], v[72:75]
s_mov_b32 s67, 896
s_add_u32 m0, s60, 106496
v_mfma_f32_16x16x32_bf16 v[72:75], v[36:39], a[88:91], v[72:75]
buffer_load_dwordx4 v6, s[24:27], s67 offen offset:0 sc1 lds
s_mov_b32 s67, 9088
v_mfma_f32_16x16x32_bf16 v[72:75], v[40:43], a[104:107], v[72:75]
buffer_load_dwordx4 v6, s[24:27], s67 offen offset:1024 sc1 lds
v_mfma_f32_16x16x32_bf16 v[76:79], v[40:43], a[108:111], v[76:79]
v_mfma_f32_16x16x32_bf16 v[76:79], v[36:39], a[92:95], v[76:79]
v_mfma_f32_16x16x32_bf16 v[76:79], v[32:35], a[76:79], v[76:79]
s_mov_b32 s67, 17280
s_waitcnt lgkmcnt(0)
v_mfma_f32_16x16x32_bf16 v[96:99], v[44:47], a[64:67], v[96:99]
ds_read_b64_tr_b16 v[32:33], v11 offset:0
v_mfma_f32_16x16x32_bf16 v[96:99], v[48:51], a[80:83], v[96:99]
ds_read_b64_tr_b16 v[34:35], v11 offset:512
v_mfma_f32_16x16x32_bf16 v[96:99], v[52:55], a[96:99], v[96:99]
ds_read_b64_tr_b16 v[36:37], v11 offset:2048
buffer_load_dwordx4 v6, s[24:27], s67 offen offset:2048 sc1 lds
v_mfma_f32_16x16x32_bf16 v[100:103], v[52:55], a[100:103], v[100:103]
ds_read_b64_tr_b16 v[38:39], v11 offset:2560
v_mfma_f32_16x16x32_bf16 v[100:103], v[48:51], a[84:87], v[100:103]
ds_read_b64_tr_b16 v[40:41], v11 offset:4096
v_mfma_f32_16x16x32_bf16 v[100:103], v[44:47], a[68:71], v[100:103]
ds_read_b64_tr_b16 v[42:43], v11 offset:4608
s_mov_b32 s67, 25472
v_mfma_f32_16x16x32_bf16 v[104:107], v[44:47], a[72:75], v[104:107]
v_mfma_f32_16x16x32_bf16 v[104:107], v[48:51], a[88:91], v[104:107]
v_mfma_f32_16x16x32_bf16 v[104:107], v[52:55], a[104:107], v[104:107]
buffer_load_dwordx4 v6, s[24:27], s67 offen offset:3072 sc1 lds
v_mfma_f32_16x16x32_bf16 v[108:111], v[52:55], a[108:111], v[108:111]
v_mfma_f32_16x16x32_bf16 v[108:111], v[48:51], a[92:95], v[108:111]
v_mfma_f32_16x16x32_bf16 v[108:111], v[44:47], a[76:79], v[108:111]
s_add_u32 s66, s64, 3538944
s_add_u32 m0, s65, 24576
s_waitcnt lgkmcnt(0)
v_mfma_f32_16x16x32_bf16 v[80:83], v[32:35], a[64:67], v[80:83]
ds_read_b64_tr_b16 v[44:45], v11 offset:1024
v_mfma_f32_16x16x32_bf16 v[80:83], v[36:39], a[80:83], v[80:83]
ds_read_b64_tr_b16 v[46:47], v11 offset:1536
buffer_load_dwordx4 v2, s[16:19], s66 offen offset:0 lds
v_mfma_f32_16x16x32_bf16 v[80:83], v[40:43], a[96:99], v[80:83]
ds_read_b64_tr_b16 v[48:49], v11 offset:3072
v_mfma_f32_16x16x32_bf16 v[84:87], v[40:43], a[100:103], v[84:87]
ds_read_b64_tr_b16 v[50:51], v11 offset:3584
v_mfma_f32_16x16x32_bf16 v[84:87], v[36:39], a[84:87], v[84:87]
ds_read_b64_tr_b16 v[52:53], v11 offset:5120
buffer_load_dwordx4 v2, s[20:23], s66 offen offset:1024 lds
v_mfma_f32_16x16x32_bf16 v[84:87], v[32:35], a[68:71], v[84:87]
ds_read_b64_tr_b16 v[54:55], v11 offset:5632
v_mfma_f32_16x16x32_bf16 v[88:91], v[32:35], a[72:75], v[88:91]
v_mfma_f32_16x16x32_bf16 v[88:91], v[36:39], a[88:91], v[88:91]
buffer_load_dwordx4 v3, s[16:19], s66 offen offset:2048 lds
v_mfma_f32_16x16x32_bf16 v[88:91], v[40:43], a[104:107], v[88:91]
v_mfma_f32_16x16x32_bf16 v[92:95], v[40:43], a[108:111], v[92:95]
v_mfma_f32_16x16x32_bf16 v[92:95], v[36:39], a[92:95], v[92:95]
buffer_load_dwordx4 v3, s[20:23], s66 offen offset:3072 lds
v_mfma_f32_16x16x32_bf16 v[92:95], v[32:35], a[76:79], v[92:95]
s_waitcnt lgkmcnt(0)
v_mfma_f32_16x16x32_bf16 v[112:115], v[44:47], a[64:67], v[112:115]
s_waitcnt lgkmcnt(0)
s_waitcnt vmcnt(8)
s_barrier
v_mfma_f32_16x16x32_bf16 v[112:115], v[48:51], a[80:83], v[112:115]
ds_read_b64_tr_b16 v[32:33], v8 offset:0
ds_read_b128 a[128:131], v14 offset:0
v_mfma_f32_16x16x32_bf16 v[112:115], v[52:55], a[96:99], v[112:115]
ds_read_b64_tr_b16 v[34:35], v8 offset:512
ds_read_b128 a[132:135], v14 offset:2048
v_mfma_f32_16x16x32_bf16 v[116:119], v[52:55], a[100:103], v[116:119]
ds_read_b64_tr_b16 v[36:37], v8 offset:2048
ds_read_b128 a[136:139], v15 offset:0
v_mfma_f32_16x16x32_bf16 v[116:119], v[48:51], a[84:87], v[116:119]
ds_read_b64_tr_b16 v[38:39], v8 offset:2560
v_mfma_f32_16x16x32_bf16 v[116:119], v[44:47], a[68:71], v[116:119]
ds_read_b64_tr_b16 v[40:41], v8 offset:4096
ds_read_b128 a[140:143], v15 offset:2048
v_mfma_f32_16x16x32_bf16 v[120:123], v[44:47], a[72:75], v[120:123]
ds_read_b64_tr_b16 v[42:43], v8 offset:4608
ds_read_b128 a[144:147], v56 offset:0
v_mfma_f32_16x16x32_bf16 v[120:123], v[48:51], a[88:91], v[120:123]
ds_read_b128 a[148:151], v56 offset:2048
v_mfma_f32_16x16x32_bf16 v[120:123], v[52:55], a[104:107], v[120:123]
s_add_u32 s66, s64, 4128768
s_add_u32 m0, s65, 28672
v_mfma_f32_16x16x32_bf16 v[124:127], v[52:55], a[108:111], v[124:127]
ds_read_b128 a[152:155], v57 offset:0
buffer_load_dwordx4 v2, s[16:19], s66 offen offset:0 lds
buffer_load_dwordx4 v2, s[20:23], s66 offen offset:1024 lds
v_mfma_f32_16x16x32_bf16 v[124:127], v[48:51], a[92:95], v[124:127]
ds_read_b128 a[156:159], v57 offset:2048
v_mfma_f32_16x16x32_bf16 v[124:127], v[44:47], a[76:79], v[124:127]
s_waitcnt lgkmcnt(0)
v_mfma_f32_16x16x32_bf16 v[64:67], v[32:35], a[112:115], v[64:67]
ds_read_b64_tr_b16 v[44:45], v8 offset:1024
v_mfma_f32_16x16x32_bf16 v[64:67], v[36:39], a[128:131], v[64:67]
ds_read_b64_tr_b16 v[46:47], v8 offset:1536
v_mfma_f32_16x16x32_bf16 v[64:67], v[40:43], a[144:147], v[64:67]
ds_read_b64_tr_b16 v[48:49], v8 offset:3072
v_mfma_f32_16x16x32_bf16 v[68:71], v[40:43], a[148:151], v[68:71]
ds_read_b64_tr_b16 v[50:51], v8 offset:3584
v_mfma_f32_16x16x32_bf16 v[68:71], v[36:39], a[132:135], v[68:71]
ds_read_b64_tr_b16 v[52:53], v8 offset:5120
v_mfma_f32_16x16x32_bf16 v[68:71], v[32:35], a[116:119], v[68:71]
ds_read_b64_tr_b16 v[54:55], v8 offset:5632
v_mfma_f32_16x16x32_bf16 v[72:75], v[32:35], a[120:123], v[72:75]
s_mov_b32 s67, 1024
s_add_u32 m0, s60, 122880
v_mfma_f32_16x16x32_bf16 v[72:75], v[36:39], a[136:139], v[72:75]
buffer_load_dwordx4 v6, s[24:27], s67 offen offset:0 sc1 lds
s_mov_b32 s67, 9216
v_mfma_f32_16x16x32_bf16 v[72:75], v[40:43], a[152:155], v[72:75]
buffer_load_dwordx4 v6, s[24:27], s67 offen offset:1024 sc1 lds
v_mfma_f32_16x16x32_bf16 v[76:79], v[40:43], a[156:159], v[76:79]
v_mfma_f32_16x16x32_bf16 v[76:79], v[36:39], a[140:143], v[76:79]
v_mfma_f32_16x16x32_bf16 v[76:79], v[32:35], a[124:127], v[76:79]
s_mov_b32 s67, 17408
s_waitcnt lgkmcnt(0)
v_mfma_f32_16x16x32_bf16 v[96:99], v[44:47], a[112:115], v[96:99]
ds_read_b64_tr_b16 v[32:33], v9 offset:0
v_mfma_f32_16x16x32_bf16 v[96:99], v[48:51], a[128:131], v[96:99]
ds_read_b64_tr_b16 v[34:35], v9 offset:512
v_mfma_f32_16x16x32_bf16 v[96:99], v[52:55], a[144:147], v[96:99]
ds_read_b64_tr_b16 v[36:37], v9 offset:2048
buffer_load_dwordx4 v6, s[24:27], s67 offen offset:2048 sc1 lds
v_mfma_f32_16x16x32_bf16 v[100:103], v[52:55], a[148:151], v[100:103]
ds_read_b64_tr_b16 v[38:39], v9 offset:2560
v_mfma_f32_16x16x32_bf16 v[100:103], v[48:51], a[132:135], v[100:103]
ds_read_b64_tr_b16 v[40:41], v9 offset:4096
v_mfma_f32_16x16x32_bf16 v[100:103], v[44:47], a[116:119], v[100:103]
ds_read_b64_tr_b16 v[42:43], v9 offset:4608
s_mov_b32 s67, 25600
v_mfma_f32_16x16x32_bf16 v[104:107], v[44:47], a[120:123], v[104:107]
v_mfma_f32_16x16x32_bf16 v[104:107], v[48:51], a[136:139], v[104:107]
v_mfma_f32_16x16x32_bf16 v[104:107], v[52:55], a[152:155], v[104:107]
buffer_load_dwordx4 v6, s[24:27], s67 offen offset:3072 sc1 lds
v_mfma_f32_16x16x32_bf16 v[108:111], v[52:55], a[156:159], v[108:111]
v_mfma_f32_16x16x32_bf16 v[108:111], v[48:51], a[140:143], v[108:111]
v_mfma_f32_16x16x32_bf16 v[108:111], v[44:47], a[124:127], v[108:111]
s_add_u32 s66, s64, 4423680
s_add_u32 m0, s65, 49152
s_waitcnt lgkmcnt(0)
v_mfma_f32_16x16x32_bf16 v[80:83], v[32:35], a[112:115], v[80:83]
ds_read_b64_tr_b16 v[44:45], v9 offset:1024
v_mfma_f32_16x16x32_bf16 v[80:83], v[36:39], a[128:131], v[80:83]
ds_read_b64_tr_b16 v[46:47], v9 offset:1536
buffer_load_dwordx4 v2, s[16:19], s66 offen offset:0 lds
v_mfma_f32_16x16x32_bf16 v[80:83], v[40:43], a[144:147], v[80:83]
ds_read_b64_tr_b16 v[48:49], v9 offset:3072
v_mfma_f32_16x16x32_bf16 v[84:87], v[40:43], a[148:151], v[84:87]
ds_read_b64_tr_b16 v[50:51], v9 offset:3584
v_mfma_f32_16x16x32_bf16 v[84:87], v[36:39], a[132:135], v[84:87]
ds_read_b64_tr_b16 v[52:53], v9 offset:5120
buffer_load_dwordx4 v2, s[20:23], s66 offen offset:1024 lds
v_mfma_f32_16x16x32_bf16 v[84:87], v[32:35], a[116:119], v[84:87]
ds_read_b64_tr_b16 v[54:55], v9 offset:5632
v_mfma_f32_16x16x32_bf16 v[88:91], v[32:35], a[120:123], v[88:91]
v_mfma_f32_16x16x32_bf16 v[88:91], v[36:39], a[136:139], v[88:91]
buffer_load_dwordx4 v3, s[16:19], s66 offen offset:2048 lds
v_mfma_f32_16x16x32_bf16 v[88:91], v[40:43], a[152:155], v[88:91]
v_mfma_f32_16x16x32_bf16 v[92:95], v[40:43], a[156:159], v[92:95]
v_mfma_f32_16x16x32_bf16 v[92:95], v[36:39], a[140:143], v[92:95]
buffer_load_dwordx4 v3, s[20:23], s66 offen offset:3072 lds
v_mfma_f32_16x16x32_bf16 v[92:95], v[32:35], a[124:127], v[92:95]
s_waitcnt lgkmcnt(0)
v_mfma_f32_16x16x32_bf16 v[112:115], v[44:47], a[112:115], v[112:115]
s_waitcnt lgkmcnt(0)
s_waitcnt vmcnt(8)
s_barrier
v_mfma_f32_16x16x32_bf16 v[112:115], v[48:51], a[128:131], v[112:115]
STUB_g0:
s_cbranch_execz NEXT_g0
ds_read_b64_tr_b16 v[32:33], v8 offset:24576
ds_read_b128 a[160:163], v14 offset:16384
s_add_u32 s66, s64, 5013504
s_add_u32 m0, s65, 53248
v_mfma_f32_16x16x32_bf16 v[112:115], v[52:55], a[144:147], v[112:115]
ds_read_b64_tr_b16 v[34:35], v8 offset:25088
ds_read_b128 a[164:167], v14 offset:18432
v_mfma_f32_16x16x32_bf16 v[116:119], v[52:55], a[148:151], v[116:119]
ds_read_b64_tr_b16 v[36:37], v8 offset:26624
ds_read_b128 a[168:171], v15 offset:16384
v_mfma_f32_16x16x32_bf16 v[116:119], v[48:51], a[132:135], v[116:119]
ds_read_b64_tr_b16 v[38:39], v8 offset:27136
ds_read_b128 a[172:175], v15 offset:18432
buffer_load_dwordx4 v2, s[16:19], s66 offen offset:0 lds
v_mfma_f32_16x16x32_bf16 v[116:119], v[44:47], a[116:119], v[116:119]
ds_read_b64_tr_b16 v[40:41], v8 offset:28672
ds_read_b128 a[176:179], v56 offset:16384
v_mfma_f32_16x16x32_bf16 v[120:123], v[44:47], a[120:123], v[120:123]
ds_read_b64_tr_b16 v[42:43], v8 offset:29184
ds_read_b128 a[180:183], v56 offset:18432
v_mfma_f32_16x16x32_bf16 v[120:123], v[48:51], a[136:139], v[120:123]
ds_read_b128 a[184:187], v57 offset:16384
ds_read_b128 a[188:191], v57 offset:18432
buffer_load_dwordx4 v2, s[20:23], s66 offen offset:1024 lds
v_mfma_f32_16x16x32_bf16 v[120:123], v[52:55], a[152:155], v[120:123]
ds_read_b128 a[192:195], v14 offset:32768
ds_read_b128 a[196:199], v14 offset:34816
v_mfma_f32_16x16x32_bf16 v[124:127], v[52:55], a[156:159], v[124:127]
ds_read_b128 a[200:203], v15 offset:32768
ds_read_b128 a[204:207], v15 offset:34816
v_mfma_f32_16x16x32_bf16 v[124:127], v[48:51], a[140:143], v[124:127]
ds_read_b128 a[208:211], v56 offset:32768
ds_read_b128 a[212:215], v56 offset:34816
v_mfma_f32_16x16x32_bf16 v[124:127], v[44:47], a[124:127], v[124:127]
ds_read_b128 a[216:219], v57 offset:32768
ds_read_b128 a[220:223], v57 offset:34816
s_waitcnt lgkmcnt(4)
v_mfma_f32_16x16x32_bf16 v[64:67], v[32:35], a[160:163], v[64:67]
ds_read_b64_tr_b16 v[44:45], v8 offset:25600
v_mfma_f32_16x16x32_bf16 v[64:67], v[36:39], a[176:179], v[64:67]
ds_read_b64_tr_b16 v[46:47], v8 offset:26112
v_mfma_f32_16x16x32_bf16 v[64:67], v[40:43], a[192:195], v[64:67]
ds_read_b64_tr_b16 v[48:49], v8 offset:27648
v_mfma_f32_16x16x32_bf16 v[68:71], v[40:43], a[196:199], v[68:71]
ds_read_b64_tr_b16 v[50:51], v8 offset:28160
v_mfma_f32_16x16x32_bf16 v[68:71], v[36:39], a[180:183], v[68:71]
ds_read_b64_tr_b16 v[52:53], v8 offset:29696
v_mfma_f32_16x16x32_bf16 v[68:71], v[32:35], a[164:167], v[68:71]
ds_read_b64_tr_b16 v[54:55], v8 offset:30208
v_mfma_f32_16x16x32_bf16 v[72:75], v[32:35], a[168:171], v[72:75]
s_add_u32 s66, s64, 128
s_add_u32 m0, s65, 0
v_mfma_f32_16x16x32_bf16 v[72:75], v[36:39], a[184:187], v[72:75]
buffer_load_dwordx4 v2, s[16:19], s66 offen offset:0 lds
v_mfma_f32_16x16x32_bf16 v[72:75], v[40:43], a[200:203], v[72:75]
v_mfma_f32_16x16x32_bf16 v[76:79], v[40:43], a[204:207], v[76:79]
v_mfma_f32_16x16x32_bf16 v[76:79], v[36:39], a[188:191], v[76:79]
v_mfma_f32_16x16x32_bf16 v[76:79], v[32:35], a[172:175], v[76:79]
buffer_load_dwordx4 v2, s[20:23], s66 offen offset:1024 lds
s_waitcnt lgkmcnt(0)
v_mfma_f32_16x16x32_bf16 v[96:99], v[44:47], a[160:163], v[96:99]
ds_read_b64_tr_b16 v[32:33], v9 offset:24576
v_mfma_f32_16x16x32_bf16 v[96:99], v[48:51], a[176:179], v[96:99]
ds_read_b64_tr_b16 v[34:35], v9 offset:25088
v_mfma_f32_16x16x32_bf16 v[96:99], v[52:55], a[192:195], v[96:99]
ds_read_b64_tr_b16 v[36:37], v9 offset:26624
v_mfma_f32_16x16x32_bf16 v[100:103], v[52:55], a[196:199], v[100:103]
ds_read_b64_tr_b16 v[38:39], v9 offset:27136
v_mfma_f32_16x16x32_bf16 v[100:103], v[48:51], a[180:183], v[100:103]
ds_read_b64_tr_b16 v[40:41], v9 offset:28672
v_mfma_f32_16x16x32_bf16 v[100:103], v[44:47], a[164:167], v[100:103]
ds_read_b64_tr_b16 v[42:43], v9 offset:29184
buffer_load_dwordx4 v3, s[16:19], s66 offen offset:2048 lds
v_mfma_f32_16x16x32_bf16 v[104:107], v[44:47], a[168:171], v[104:107]
v_mfma_f32_16x16x32_bf16 v[104:107], v[48:51], a[184:187], v[104:107]
v_mfma_f32_16x16x32_bf16 v[104:107], v[52:55], a[200:203], v[104:107]
v_mfma_f32_16x16x32_bf16 v[108:111], v[52:55], a[204:207], v[108:111]
v_mfma_f32_16x16x32_bf16 v[108:111], v[48:51], a[188:191], v[108:111]
v_mfma_f32_16x16x32_bf16 v[108:111], v[44:47], a[172:175], v[108:111]
buffer_load_dwordx4 v3, s[20:23], s66 offen offset:3072 lds
s_waitcnt lgkmcnt(0)
v_mfma_f32_16x16x32_bf16 v[80:83], v[32:35], a[160:163], v[80:83]
ds_read_b64_tr_b16 v[44:45], v9 offset:25600
v_mfma_f32_16x16x32_bf16 v[80:83], v[36:39], a[176:179], v[80:83]
ds_read_b64_tr_b16 v[46:47], v9 offset:26112
v_mfma_f32_16x16x32_bf16 v[80:83], v[40:43], a[192:195], v[80:83]
ds_read_b64_tr_b16 v[48:49], v9 offset:27648
v_mfma_f32_16x16x32_bf16 v[84:87], v[40:43], a[196:199], v[84:87]
ds_read_b64_tr_b16 v[50:51], v9 offset:28160
v_mfma_f32_16x16x32_bf16 v[84:87], v[36:39], a[180:183], v[84:87]
ds_read_b64_tr_b16 v[52:53], v9 offset:29696
v_mfma_f32_16x16x32_bf16 v[84:87], v[32:35], a[164:167], v[84:87]
ds_read_b64_tr_b16 v[54:55], v9 offset:30208
v_mfma_f32_16x16x32_bf16 v[88:91], v[32:35], a[168:171], v[88:91]
s_add_u32 s66, s64, 589952
s_add_u32 m0, s65, 4096
v_mfma_f32_16x16x32_bf16 v[88:91], v[36:39], a[184:187], v[88:91]
v_mfma_f32_16x16x32_bf16 v[88:91], v[40:43], a[200:203], v[88:91]
v_mfma_f32_16x16x32_bf16 v[92:95], v[40:43], a[204:207], v[92:95]
v_mfma_f32_16x16x32_bf16 v[92:95], v[36:39], a[188:191], v[92:95]
buffer_load_dwordx4 v2, s[16:19], s66 offen offset:0 lds
v_mfma_f32_16x16x32_bf16 v[92:95], v[32:35], a[172:175], v[92:95]
s_waitcnt lgkmcnt(0)
v_mfma_f32_16x16x32_bf16 v[112:115], v[44:47], a[160:163], v[112:115]
s_waitcnt lgkmcnt(0)
s_waitcnt vmcnt(5)
s_barrier
v_mfma_f32_16x16x32_bf16 v[112:115], v[48:51], a[176:179], v[112:115]
ds_read_b64_tr_b16 v[32:33], v10 offset:0
ds_read_b128 a[224:227], v14 offset:49152
v_mfma_f32_16x16x32_bf16 v[112:115], v[52:55], a[192:195], v[112:115]
ds_read_b64_tr_b16 v[34:35], v10 offset:512
ds_read_b128 a[228:231], v14 offset:51200
v_mfma_f32_16x16x32_bf16 v[116:119], v[52:55], a[196:199], v[116:119]
ds_read_b64_tr_b16 v[36:37], v10 offset:2048
ds_read_b128 a[232:235], v15 offset:49152
v_mfma_f32_16x16x32_bf16 v[116:119], v[48:51], a[180:183], v[116:119]
ds_read_b64_tr_b16 v[38:39], v10 offset:2560
buffer_load_dwordx4 v2, s[20:23], s66 offen offset:1024 lds
v_mfma_f32_16x16x32_bf16 v[116:119], v[44:47], a[164:167], v[116:119]
ds_read_b64_tr_b16 v[40:41], v10 offset:4096
ds_read_b128 a[236:239], v15 offset:51200
v_mfma_f32_16x16x32_bf16 v[120:123], v[44:47], a[168:171], v[120:123]
ds_read_b64_tr_b16 v[42:43], v10 offset:4608
ds_read_b128 a[240:243], v56 offset:49152
v_mfma_f32_16x16x32_bf16 v[120:123], v[48:51], a[184:187], v[120:123]
ds_read_b128 a[244:247], v56 offset:51200
v_mfma_f32_16x16x32_bf16 v[120:123], v[52:55], a[200:203], v[120:123]
v_mfma_f32_16x16x32_bf16 v[124:127], v[52:55], a[204:207], v[124:127]
ds_read_b128 a[248:251], v57 offset:49152
v_mfma_f32_16x16x32_bf16 v[124:127], v[48:51], a[188:191], v[124:127]
ds_read_b128 a[252:255], v57 offset:51200
v_mfma_f32_16x16x32_bf16 v[124:127], v[44:47], a[172:175], v[124:127]
s_waitcnt lgkmcnt(0)
v_mfma_f32_16x16x32_bf16 v[64:67], v[32:35], a[208:211], v[64:67]
ds_read_b64_tr_b16 v[44:45], v10 offset:1024
v_mfma_f32_16x16x32_bf16 v[64:67], v[36:39], a[224:227], v[64:67]
ds_read_b64_tr_b16 v[46:47], v10 offset:1536
v_mfma_f32_16x16x32_bf16 v[64:67], v[40:43], a[240:243], v[64:67]
ds_read_b64_tr_b16 v[48:49], v10 offset:3072
v_mfma_f32_16x16x32_bf16 v[68:71], v[40:43], a[244:247], v[68:71]
ds_read_b64_tr_b16 v[50:51], v10 offset:3584
v_mfma_f32_16x16x32_bf16 v[68:71], v[36:39], a[228:231], v[68:71]
ds_read_b64_tr_b16 v[52:53], v10 offset:5120
v_mfma_f32_16x16x32_bf16 v[68:71], v[32:35], a[212:215], v[68:71]
ds_read_b64_tr_b16 v[54:55], v10 offset:5632
v_mfma_f32_16x16x32_bf16 v[72:75], v[32:35], a[216:219], v[72:75]
s_add_u32 s66, s64, 884864
s_add_u32 m0, s65, 24576
v_mfma_f32_16x16x32_bf16 v[72:75], v[36:39], a[232:235], v[72:75]
buffer_load_dwordx4 v2, s[16:19], s66 offen offset:0 lds
v_mfma_f32_16x16x32_bf16 v[72:75], v[40:43], a[248:251], v[72:75]
v_mfma_f32_16x16x32_bf16 v[76:79], v[40:43], a[252:255], v[76:79]
v_mfma_f32_16x16x32_bf16 v[76:79], v[36:39], a[236:239], v[76:79]
v_mfma_f32_16x16x32_bf16 v[76:79], v[32:35], a[220:223], v[76:79]
buffer_load_dwordx4 v2, s[20:23], s66 offen offset:1024 lds
s_waitcnt lgkmcnt(0)
v_mfma_f32_16x16x32_bf16 v[96:99], v[44:47], a[208:211], v[96:99]
ds_read_b64_tr_b16 v[32:33], v11 offset:0
v_mfma_f32_16x16x32_bf16 v[96:99], v[48:51], a[224:227], v[96:99]
ds_read_b64_tr_b16 v[34:35], v11 offset:512
v_mfma_f32_16x16x32_bf16 v[96:99], v[52:55], a[240:243], v[96:99]
ds_read_b64_tr_b16 v[36:37], v11 offset:2048
v_mfma_f32_16x16x32_bf16 v[100:103], v[52:55], a[244:247], v[100:103]
ds_read_b64_tr_b16 v[38:39], v11 offset:2560
v_mfma_f32_16x16x32_bf16 v[100:103], v[48:51], a[228:231], v[100:103]
ds_read_b64_tr_b16 v[40:41], v11 offset:4096
v_mfma_f32_16x16x32_bf16 v[100:103], v[44:47], a[212:215], v[100:103]
ds_read_b64_tr_b16 v[42:43], v11 offset:4608
buffer_load_dwordx4 v3, s[16:19], s66 offen offset:2048 lds
v_mfma_f32_16x16x32_bf16 v[104:107], v[44:47], a[216:219], v[104:107]
v_mfma_f32_16x16x32_bf16 v[104:107], v[48:51], a[232:235], v[104:107]
v_mfma_f32_16x16x32_bf16 v[104:107], v[52:55], a[248:251], v[104:107]
v_mfma_f32_16x16x32_bf16 v[108:111], v[52:55], a[252:255], v[108:111]
v_mfma_f32_16x16x32_bf16 v[108:111], v[48:51], a[236:239], v[108:111]
v_mfma_f32_16x16x32_bf16 v[108:111], v[44:47], a[220:223], v[108:111]
buffer_load_dwordx4 v3, s[20:23], s66 offen offset:3072 lds
s_waitcnt lgkmcnt(0)
v_mfma_f32_16x16x32_bf16 v[80:83], v[32:35], a[208:211], v[80:83]
ds_read_b64_tr_b16 v[44:45], v11 offset:1024
v_mfma_f32_16x16x32_bf16 v[80:83], v[36:39], a[224:227], v[80:83]
ds_read_b64_tr_b16 v[46:47], v11 offset:1536
v_mfma_f32_16x16x32_bf16 v[80:83], v[40:43], a[240:243], v[80:83]
ds_read_b64_tr_b16 v[48:49], v11 offset:3072
v_mfma_f32_16x16x32_bf16 v[84:87], v[40:43], a[244:247], v[84:87]
ds_read_b64_tr_b16 v[50:51], v11 offset:3584
v_mfma_f32_16x16x32_bf16 v[84:87], v[36:39], a[228:231], v[84:87]
ds_read_b64_tr_b16 v[52:53], v11 offset:5120
v_mfma_f32_16x16x32_bf16 v[84:87], v[32:35], a[212:215], v[84:87]
ds_read_b64_tr_b16 v[54:55], v11 offset:5632
v_mfma_f32_16x16x32_bf16 v[88:91], v[32:35], a[216:219], v[88:91]
s_add_u32 s66, s64, 1474688
s_add_u32 m0, s65, 28672
v_mfma_f32_16x16x32_bf16 v[88:91], v[36:39], a[232:235], v[88:91]
v_mfma_f32_16x16x32_bf16 v[88:91], v[40:43], a[248:251], v[88:91]
v_mfma_f32_16x16x32_bf16 v[92:95], v[40:43], a[252:255], v[92:95]
v_mfma_f32_16x16x32_bf16 v[92:95], v[36:39], a[236:239], v[92:95]
buffer_load_dwordx4 v2, s[16:19], s66 offen offset:0 lds
v_mfma_f32_16x16x32_bf16 v[92:95], v[32:35], a[220:223], v[92:95]
s_waitcnt lgkmcnt(0)
v_mfma_f32_16x16x32_bf16 v[112:115], v[44:47], a[208:211], v[112:115]
s_waitcnt lgkmcnt(0)
s_waitcnt vmcnt(5)
s_barrier
v_mfma_f32_16x16x32_bf16 v[112:115], v[48:51], a[224:227], v[112:115]
ds_read_b64_tr_b16 v[32:33], v8 offset:0
v_mfma_f32_16x16x32_bf16 v[112:115], v[52:55], a[240:243], v[112:115]
ds_read_b64_tr_b16 v[34:35], v8 offset:512
v_mfma_f32_16x16x32_bf16 v[116:119], v[52:55], a[244:247], v[116:119]
ds_read_b64_tr_b16 v[36:37], v8 offset:2048
v_mfma_f32_16x16x32_bf16 v[116:119], v[48:51], a[228:231], v[116:119]
ds_read_b64_tr_b16 v[38:39], v8 offset:2560
buffer_load_dwordx4 v2, s[20:23], s66 offen offset:1024 lds
v_mfma_f32_16x16x32_bf16 v[116:119], v[44:47], a[212:215], v[116:119]
ds_read_b64_tr_b16 v[40:41], v8 offset:4096
v_mfma_f32_16x16x32_bf16 v[120:123], v[44:47], a[216:219], v[120:123]
ds_read_b64_tr_b16 v[42:43], v8 offset:4608
v_mfma_f32_16x16x32_bf16 v[120:123], v[48:51], a[232:235], v[120:123]
v_mfma_f32_16x16x32_bf16 v[120:123], v[52:55], a[248:251], v[120:123]
v_mfma_f32_16x16x32_bf16 v[124:127], v[52:55], a[252:255], v[124:127]
v_mfma_f32_16x16x32_bf16 v[124:127], v[48:51], a[236:239], v[124:127]
v_mfma_f32_16x16x32_bf16 v[124:127], v[44:47], a[220:223], v[124:127]
s_waitcnt lgkmcnt(0)
v_mfma_f32_16x16x32_bf16 v[128:131], v[32:35], v[224:227], 0
ds_read_b64_tr_b16 v[44:45], v8 offset:1024
v_mfma_f32_16x16x32_bf16 v[128:131], v[36:39], v[240:243], v[128:131]
ds_read_b64_tr_b16 v[46:47], v8 offset:1536
v_mfma_f32_16x16x32_bf16 v[128:131], v[40:43], a[0:3], v[128:131]
ds_read_b64_tr_b16 v[48:49], v8 offset:3072
v_mfma_f32_16x16x32_bf16 v[132:135], v[40:43], a[4:7], 0
ds_read_b64_tr_b16 v[50:51], v8 offset:3584
v_mfma_f32_16x16x32_bf16 v[132:135], v[36:39], v[244:247], v[132:135]
ds_read_b64_tr_b16 v[52:53], v8 offset:5120
v_mfma_f32_16x16x32_bf16 v[132:135], v[32:35], v[228:231], v[132:135]
ds_read_b64_tr_b16 v[54:55], v8 offset:5632
v_mfma_f32_16x16x32_bf16 v[136:139], v[32:35], v[232:235], 0
s_add_u32 s66, s64, 1769600
s_add_u32 m0, s65, 49152
v_mfma_f32_16x16x32_bf16 v[136:139], v[36:39], v[248:251], v[136:139]
buffer_load_dwordx4 v2, s[16:19], s66 offen offset:0 lds
buffer_load_dwordx4 v2, s[20:23], s66 offen offset:1024 lds
v_mfma_f32_16x16x32_bf16 v[136:139], v[40:43], a[8:11], v[136:139]
buffer_load_dwordx4 v3, s[16:19], s66 offen offset:2048 lds
v_mfma_f32_16x16x32_bf16 v[140:143], v[40:43], a[12:15], 0
v_mfma_f32_16x16x32_bf16 v[140:143], v[36:39], v[252:255], v[140:143]
v_mul_f32 v64, v64, v96
v_mfma_f32_16x16x32_bf16 v[140:143], v[32:35], v[236:239], v[140:143]
buffer_load_dwordx4 v3, s[20:23], s66 offen offset:3072 lds
v_mul_f32 v65, v65, v97
s_waitcnt lgkmcnt(0)
v_mfma_f32_16x16x32_bf16 v[160:163], v[44:47], v[224:227], 0
ds_read_b64_tr_b16 v[32:33], v9 offset:0
v_mfma_f32_16x16x32_bf16 v[160:163], v[48:51], v[240:243], v[160:163]
ds_read_b64_tr_b16 v[34:35], v9 offset:512
v_mul_f32 v66, v66, v98
v_mfma_f32_16x16x32_bf16 v[160:163], v[52:55], a[0:3], v[160:163]
ds_read_b64_tr_b16 v[36:37], v9 offset:2048
v_mul_f32 v67, v67, v99
v_mfma_f32_16x16x32_bf16 v[164:167], v[52:55], a[4:7], 0
ds_read_b64_tr_b16 v[38:39], v9 offset:2560
v_mfma_f32_16x16x32_bf16 v[164:167], v[48:51], v[244:247], v[164:167]
ds_read_b64_tr_b16 v[40:41], v9 offset:4096
v_cvt_pk_bf16_f32 v64, v64, v65
v_mfma_f32_16x16x32_bf16 v[164:167], v[44:47], v[228:231], v[164:167]
ds_read_b64_tr_b16 v[42:43], v9 offset:4608
v_cvt_pk_bf16_f32 v65, v66, v67
v_mfma_f32_16x16x32_bf16 v[168:171], v[44:47], v[232:235], 0
s_add_u32 s66, s64, 2359424
s_add_u32 m0, s65, 53248
v_mfma_f32_16x16x32_bf16 v[168:171], v[48:51], v[248:251], v[168:171]
buffer_load_dwordx4 v2, s[16:19], s66 offen offset:0 lds
v_mul_f32 v80, v80, v112
v_mfma_f32_16x16x32_bf16 v[168:171], v[52:55], a[8:11], v[168:171]
buffer_load_dwordx4 v2, s[20:23], s66 offen offset:1024 lds
v_mfma_f32_16x16x32_bf16 v[172:175], v[52:55], a[12:15], 0
v_mul_f32 v81, v81, v113
v_mfma_f32_16x16x32_bf16 v[172:175], v[48:51], v[252:255], v[172:175]
v_mul_f32 v82, v82, v114
v_mfma_f32_16x16x32_bf16 v[172:175], v[44:47], v[236:239], v[172:175]
s_add_u32 s66, s64, 2654336
s_add_u32 m0, s65, 73728
s_waitcnt lgkmcnt(0)
v_mfma_f32_16x16x32_bf16 v[144:147], v[32:35], v[224:227], 0
ds_read_b64_tr_b16 v[44:45], v9 offset:1024
v_mul_f32 v83, v83, v115
v_mfma_f32_16x16x32_bf16 v[144:147], v[36:39], v[240:243], v[144:147]
ds_read_b64_tr_b16 v[46:47], v9 offset:1536
buffer_load_dwordx4 v2, s[16:19], s66 offen offset:0 lds
v_mfma_f32_16x16x32_bf16 v[144:147], v[40:43], a[0:3], v[144:147]
ds_read_b64_tr_b16 v[48:49], v9 offset:3072
v_cvt_pk_bf16_f32 v66, v80, v81
v_mfma_f32_16x16x32_bf16 v[148:151], v[40:43], a[4:7], 0
ds_read_b64_tr_b16 v[50:51], v9 offset:3584
v_cvt_pk_bf16_f32 v67, v82, v83
v_mfma_f32_16x16x32_bf16 v[148:151], v[36:39], v[244:247], v[148:151]
ds_read_b64_tr_b16 v[52:53], v9 offset:5120
buffer_load_dwordx4 v2, s[20:23], s66 offen offset:1024 lds
v_mfma_f32_16x16x32_bf16 v[148:151], v[32:35], v[228:231], v[148:151]
ds_read_b64_tr_b16 v[54:55], v9 offset:5632
v_mul_f32 v68, v68, v100
v_mfma_f32_16x16x32_bf16 v[152:155], v[32:35], v[232:235], 0
v_mul_f32 v69, v69, v101
v_mfma_f32_16x16x32_bf16 v[152:155], v[36:39], v[248:251], v[152:155]
buffer_load_dwordx4 v3, s[16:19], s66 offen offset:2048 lds
v_mfma_f32_16x16x32_bf16 v[152:155], v[40:43], a[8:11], v[152:155]
v_mul_f32 v70, v70, v102
v_mfma_f32_16x16x32_bf16 v[156:159], v[40:43], a[12:15], 0
v_mul_f32 v71, v71, v103
v_mfma_f32_16x16x32_bf16 v[156:159], v[36:39], v[252:255], v[156:159]
buffer_load_dwordx4 v3, s[20:23], s66 offen offset:3072 lds
v_mfma_f32_16x16x32_bf16 v[156:159], v[32:35], v[236:239], v[156:159]
v_cvt_pk_bf16_f32 v68, v68, v69
s_waitcnt lgkmcnt(0)
v_mfma_f32_16x16x32_bf16 v[176:179], v[44:47], v[224:227], 0
s_waitcnt vmcnt(10)
s_barrier
v_mfma_f32_16x16x32_bf16 v[176:179], v[48:51], v[240:243], v[176:179]
ds_read_b64_tr_b16 v[32:33], v8 offset:24576
v_cvt_pk_bf16_f32 v69, v70, v71
v_mfma_f32_16x16x32_bf16 v[176:179], v[52:55], a[0:3], v[176:179]
ds_read_b64_tr_b16 v[34:35], v8 offset:25088
v_mul_f32 v84, v84, v116
v_mfma_f32_16x16x32_bf16 v[180:183], v[52:55], a[4:7], 0
ds_read_b64_tr_b16 v[36:37], v8 offset:26624
v_mfma_f32_16x16x32_bf16 v[180:183], v[48:51], v[244:247], v[180:183]
ds_read_b64_tr_b16 v[38:39], v8 offset:27136
v_mul_f32 v85, v85, v117
v_mfma_f32_16x16x32_bf16 v[180:183], v[44:47], v[228:231], v[180:183]
ds_read_b64_tr_b16 v[40:41], v8 offset:28672
v_mul_f32 v86, v86, v118
v_mfma_f32_16x16x32_bf16 v[184:187], v[44:47], v[232:235], 0
ds_read_b64_tr_b16 v[42:43], v8 offset:29184
v_mfma_f32_16x16x32_bf16 v[184:187], v[48:51], v[248:251], v[184:187]
s_add_u32 s66, s64, 3244160
s_add_u32 m0, s65, 77824
v_mfma_f32_16x16x32_bf16 v[184:187], v[52:55], a[8:11], v[184:187]
buffer_load_dwordx4 v2, s[16:19], s66 offen offset:0 lds
buffer_load_dwordx4 v2, s[20:23], s66 offen offset:1024 lds
v_mfma_f32_16x16x32_bf16 v[188:191], v[52:55], a[12:15], 0
v_mul_f32 v87, v87, v119
v_cvt_pk_bf16_f32 v70, v84, v85
v_mfma_f32_16x16x32_bf16 v[188:191], v[48:51], v[252:255], v[188:191]
v_cvt_pk_bf16_f32 v71, v86, v87
v_mfma_f32_16x16x32_bf16 v[188:191], v[44:47], v[236:239], v[188:191]
s_waitcnt lgkmcnt(0)
v_mfma_f32_16x16x32_bf16 v[128:131], v[32:35], a[16:19], v[128:131]
ds_read_b64_tr_b16 v[44:45], v8 offset:25600
v_mul_f32 v72, v72, v104
v_mfma_f32_16x16x32_bf16 v[128:131], v[36:39], a[32:35], v[128:131]
ds_read_b64_tr_b16 v[46:47], v8 offset:26112
v_mfma_f32_16x16x32_bf16 v[128:131], v[40:43], a[48:51], v[128:131]
ds_read_b64_tr_b16 v[48:49], v8 offset:27648
v_mul_f32 v73, v73, v105
v_mfma_f32_16x16x32_bf16 v[132:135], v[40:43], a[52:55], v[132:135]
ds_read_b64_tr_b16 v[50:51], v8 offset:28160
v_mfma_f32_16x16x32_bf16 v[132:135], v[36:39], a[36:39], v[132:135]
ds_read_b64_tr_b16 v[52:53], v8 offset:29696
v_mul_f32 v74, v74, v106
v_mfma_f32_16x16x32_bf16 v[132:135], v[32:35], a[20:23], v[132:135]
ds_read_b64_tr_b16 v[54:55], v8 offset:30208
v_mfma_f32_16x16x32_bf16 v[136:139], v[32:35], a[24:27], v[136:139]
s_add_u32 s66, s64, 3539072
s_add_u32 m0, s65, 98304
v_mfma_f32_16x16x32_bf16 v[136:139], v[36:39], a[40:43], v[136:139]
buffer_load_dwordx4 v2, s[16:19], s66 offen offset:0 lds
buffer_load_dwordx4 v2, s[20:23], s66 offen offset:1024 lds
v_mfma_f32_16x16x32_bf16 v[136:139], v[40:43], a[56:59], v[136:139]
buffer_load_dwordx4 v3, s[16:19], s66 offen offset:2048 lds
v_mul_f32 v75, v75, v107
v_mfma_f32_16x16x32_bf16 v[140:143], v[40:43], a[60:63], v[140:143]
v_cvt_pk_bf16_f32 v72, v72, v73
v_mfma_f32_16x16x32_bf16 v[140:143], v[36:39], a[44:47], v[140:143]
v_cvt_pk_bf16_f32 v73, v74, v75
v_mfma_f32_16x16x32_bf16 v[140:143], v[32:35], a[28:31], v[140:143]
buffer_load_dwordx4 v3, s[20:23], s66 offen offset:3072 lds
s_waitcnt lgkmcnt(0)
v_mfma_f32_16x16x32_bf16 v[160:163], v[44:47], a[16:19], v[160:163]
ds_read_b64_tr_b16 v[32:33], v9 offset:24576
v_mul_f32 v88, v88, v120
v_mfma_f32_16x16x32_bf16 v[160:163], v[48:51], a[32:35], v[160:163]
ds_read_b64_tr_b16 v[34:35], v9 offset:25088
v_mfma_f32_16x16x32_bf16 v[160:163], v[52:55], a[48:51], v[160:163]
ds_read_b64_tr_b16 v[36:37], v9 offset:26624
v_mul_f32 v89, v89, v121
v_mfma_f32_16x16x32_bf16 v[164:167], v[52:55], a[52:55], v[164:167]
ds_read_b64_tr_b16 v[38:39], v9 offset:27136
v_mfma_f32_16x16x32_bf16 v[164:167], v[48:51], a[36:39], v[164:167]
ds_read_b64_tr_b16 v[40:41], v9 offset:28672
v_mul_f32 v90, v90, v122
v_mfma_f32_16x16x32_bf16 v[164:167], v[44:47], a[20:23], v[164:167]
ds_read_b64_tr_b16 v[42:43], v9 offset:29184
v_mfma_f32_16x16x32_bf16 v[168:171], v[44:47], a[24:27], v[168:171]
s_add_u32 s66, s64, 4128896
s_add_u32 m0, s65, 102400
v_mfma_f32_16x16x32_bf16 v[168:171], v[48:51], a[40:43], v[168:171]
buffer_load_dwordx4 v2, s[16:19], s66 offen offset:0 lds
v_mul_f32 v91, v91, v123
v_mfma_f32_16x16x32_bf16 v[168:171], v[52:55], a[56:59], v[168:171]
buffer_load_dwordx4 v2, s[20:23], s66 offen offset:1024 lds
v_cvt_pk_bf16_f32 v74, v88, v89
v_mfma_f32_16x16x32_bf16 v[172:175], v[52:55], a[60:63], v[172:175]
v_mfma_f32_16x16x32_bf16 v[172:175], v[48:51], a[44:47], v[172:175]
v_cvt_pk_bf16_f32 v75, v90, v91
v_mfma_f32_16x16x32_bf16 v[172:175], v[44:47], a[28:31], v[172:175]
s_add_u32 s66, s64, 4423808
s_add_u32 m0, s65, 122880
s_waitcnt lgkmcnt(0)
v_mfma_f32_16x16x32_bf16 v[144:147], v[32:35], a[16:19], v[144:147]
ds_read_b64_tr_b16 v[44:45], v9 offset:25600
v_mul_f32 v76, v76, v108
v_mfma_f32_16x16x32_bf16 v[144:147], v[36:39], a[32:35], v[144:147]
ds_read_b64_tr_b16 v[46:47], v9 offset:26112
buffer_load_dwordx4 v2, s[16:19], s66 offen offset:0 lds
v_mfma_f32_16x16x32_bf16 v[144:147], v[40:43], a[48:51], v[144:147]
ds_read_b64_tr_b16 v[48:49], v9 offset:27648
v_mul_f32 v77, v77, v109
v_mfma_f32_16x16x32_bf16 v[148:151], v[40:43], a[52:55], v[148:151]
ds_read_b64_tr_b16 v[50:51], v9 offset:28160
v_mfma_f32_16x16x32_bf16 v[148:151], v[36:39], a[36:39], v[148:151]
ds_read_b64_tr_b16 v[52:53], v9 offset:29696
buffer_load_dwordx4 v2, s[20:23], s66 offen offset:1024 lds
v_mfma_f32_16x16x32_bf16 v[148:151], v[32:35], a[20:23], v[148:151]
ds_read_b64_tr_b16 v[54:55], v9 offset:30208
v_mul_f32 v78, v78, v110
v_mfma_f32_16x16x32_bf16 v[152:155], v[32:35], a[24:27], v[152:155]
v_mul_f32 v79, v79, v111
v_mfma_f32_16x16x32_bf16 v[152:155], v[36:39], a[40:43], v[152:155]
buffer_load_dwordx4 v3, s[16:19], s66 offen offset:2048 lds
v_mfma_f32_16x16x32_bf16 v[152:155], v[40:43], a[56:59], v[152:155]
v_cvt_pk_bf16_f32 v76, v76, v77
v_mfma_f32_16x16x32_bf16 v[156:159], v[40:43], a[60:63], v[156:159]
v_mfma_f32_16x16x32_bf16 v[156:159], v[36:39], a[44:47], v[156:159]
buffer_load_dwordx4 v3, s[20:23], s66 offen offset:3072 lds
v_cvt_pk_bf16_f32 v77, v78, v79
v_mfma_f32_16x16x32_bf16 v[156:159], v[32:35], a[28:31], v[156:159]
s_waitcnt lgkmcnt(0)
v_mfma_f32_16x16x32_bf16 v[176:179], v[44:47], a[16:19], v[176:179]
s_waitcnt vmcnt(16)
s_barrier
v_mfma_f32_16x16x32_bf16 v[176:179], v[48:51], a[32:35], v[176:179]
ds_read_b64_tr_b16 v[32:33], v10 offset:0
v_mul_f32 v92, v92, v124
v_mfma_f32_16x16x32_bf16 v[176:179], v[52:55], a[48:51], v[176:179]
ds_read_b64_tr_b16 v[34:35], v10 offset:512
v_mul_f32 v93, v93, v125
v_mfma_f32_16x16x32_bf16 v[180:183], v[52:55], a[52:55], v[180:183]
ds_read_b64_tr_b16 v[36:37], v10 offset:2048
v_mfma_f32_16x16x32_bf16 v[180:183], v[48:51], a[36:39], v[180:183]
ds_read_b64_tr_b16 v[38:39], v10 offset:2560
v_mul_f32 v94, v94, v126
v_mfma_f32_16x16x32_bf16 v[180:183], v[44:47], a[20:23], v[180:183]
ds_read_b64_tr_b16 v[40:41], v10 offset:4096
v_mfma_f32_16x16x32_bf16 v[184:187], v[44:47], a[24:27], v[184:187]
ds_read_b64_tr_b16 v[42:43], v10 offset:4608
v_mul_f32 v95, v95, v127
v_mfma_f32_16x16x32_bf16 v[184:187], v[48:51], a[40:43], v[184:187]
s_add_u32 s66, s64, 5013632
s_add_u32 m0, s65, 126976
v_mfma_f32_16x16x32_bf16 v[184:187], v[52:55], a[56:59], v[184:187]
buffer_load_dwordx4 v2, s[16:19], s66 offen offset:0 lds
buffer_load_dwordx4 v2, s[20:23], s66 offen offset:1024 lds
v_mfma_f32_16x16x32_bf16 v[188:191], v[52:55], a[60:63], v[188:191]
v_cvt_pk_bf16_f32 v78, v92, v93
v_mfma_f32_16x16x32_bf16 v[188:191], v[48:51], a[44:47], v[188:191]
v_cvt_pk_bf16_f32 v79, v94, v95
v_mfma_f32_16x16x32_bf16 v[188:191], v[44:47], a[28:31], v[188:191]
s_waitcnt lgkmcnt(0)
v_mfma_f32_16x16x32_bf16 v[128:131], v[32:35], a[64:67], v[128:131]
ds_read_b64_tr_b16 v[44:45], v10 offset:1024
v_mfma_f32_16x16x32_bf16 v[128:131], v[36:39], a[80:83], v[128:131]
ds_read_b64_tr_b16 v[46:47], v10 offset:1536
v_mfma_f32_16x16x32_bf16 v[128:131], v[40:43], a[96:99], v[128:131]
ds_read_b64_tr_b16 v[48:49], v10 offset:3072
v_mfma_f32_16x16x32_bf16 v[132:135], v[40:43], a[100:103], v[132:135]
ds_read_b64_tr_b16 v[50:51], v10 offset:3584
v_mfma_f32_16x16x32_bf16 v[132:135], v[36:39], a[84:87], v[132:135]
ds_read_b64_tr_b16 v[52:53], v10 offset:5120
v_mfma_f32_16x16x32_bf16 v[132:135], v[32:35], a[68:71], v[132:135]
ds_read_b64_tr_b16 v[54:55], v10 offset:5632
v_mfma_f32_16x16x32_bf16 v[136:139], v[32:35], a[72:75], v[136:139]
s_add_u32 s66, s64, 256
s_add_u32 m0, s65, 0
v_mfma_f32_16x16x32_bf16 v[136:139], v[36:39], a[88:91], v[136:139]
buffer_load_dwordx4 v2, s[16:19], s66 offen offset:0 lds
v_mfma_f32_16x16x32_bf16 v[136:139], v[40:43], a[104:107], v[136:139]
v_mfma_f32_16x16x32_bf16 v[140:143], v[40:43], a[108:111], v[140:143]
v_mfma_f32_16x16x32_bf16 v[140:143], v[36:39], a[92:95], v[140:143]
v_mfma_f32_16x16x32_bf16 v[140:143], v[32:35], a[76:79], v[140:143]
buffer_load_dwordx4 v2, s[20:23], s66 offen offset:1024 lds
s_waitcnt lgkmcnt(0)
v_mfma_f32_16x16x32_bf16 v[160:163], v[44:47], a[64:67], v[160:163]
ds_read_b64_tr_b16 v[32:33], v11 offset:0
v_mfma_f32_16x16x32_bf16 v[160:163], v[48:51], a[80:83], v[160:163]
ds_read_b64_tr_b16 v[34:35], v11 offset:512
v_mfma_f32_16x16x32_bf16 v[160:163], v[52:55], a[96:99], v[160:163]
ds_read_b64_tr_b16 v[36:37], v11 offset:2048
v_mfma_f32_16x16x32_bf16 v[164:167], v[52:55], a[100:103], v[164:167]
ds_read_b64_tr_b16 v[38:39], v11 offset:2560
v_mfma_f32_16x16x32_bf16 v[164:167], v[48:51], a[84:87], v[164:167]
ds_read_b64_tr_b16 v[40:41], v11 offset:4096
v_mfma_f32_16x16x32_bf16 v[164:167], v[44:47], a[68:71], v[164:167]
ds_read_b64_tr_b16 v[42:43], v11 offset:4608
buffer_load_dwordx4 v3, s[16:19], s66 offen offset:2048 lds
v_mfma_f32_16x16x32_bf16 v[168:171], v[44:47], a[72:75], v[168:171]
v_mfma_f32_16x16x32_bf16 v[168:171], v[48:51], a[88:91], v[168:171]
v_mfma_f32_16x16x32_bf16 v[168:171], v[52:55], a[104:107], v[168:171]
v_mfma_f32_16x16x32_bf16 v[172:175], v[52:55], a[108:111], v[172:175]
v_mfma_f32_16x16x32_bf16 v[172:175], v[48:51], a[92:95], v[172:175]
v_mfma_f32_16x16x32_bf16 v[172:175], v[44:47], a[76:79], v[172:175]
buffer_load_dwordx4 v3, s[20:23], s66 offen offset:3072 lds
s_waitcnt lgkmcnt(0)
v_mfma_f32_16x16x32_bf16 v[144:147], v[32:35], a[64:67], v[144:147]
ds_read_b64_tr_b16 v[44:45], v11 offset:1024
v_mfma_f32_16x16x32_bf16 v[144:147], v[36:39], a[80:83], v[144:147]
ds_read_b64_tr_b16 v[46:47], v11 offset:1536
v_mfma_f32_16x16x32_bf16 v[144:147], v[40:43], a[96:99], v[144:147]
ds_read_b64_tr_b16 v[48:49], v11 offset:3072
v_mfma_f32_16x16x32_bf16 v[148:151], v[40:43], a[100:103], v[148:151]
ds_read_b64_tr_b16 v[50:51], v11 offset:3584
v_mfma_f32_16x16x32_bf16 v[148:151], v[36:39], a[84:87], v[148:151]
ds_read_b64_tr_b16 v[52:53], v11 offset:5120
v_mfma_f32_16x16x32_bf16 v[148:151], v[32:35], a[68:71], v[148:151]
ds_read_b64_tr_b16 v[54:55], v11 offset:5632
v_mfma_f32_16x16x32_bf16 v[152:155], v[32:35], a[72:75], v[152:155]
s_add_u32 s66, s64, 590080
s_add_u32 m0, s65, 4096
v_mfma_f32_16x16x32_bf16 v[152:155], v[36:39], a[88:91], v[152:155]
v_mfma_f32_16x16x32_bf16 v[152:155], v[40:43], a[104:107], v[152:155]
v_mfma_f32_16x16x32_bf16 v[156:159], v[40:43], a[108:111], v[156:159]
v_mfma_f32_16x16x32_bf16 v[156:159], v[36:39], a[92:95], v[156:159]
v_mfma_f32_16x16x32_bf16 v[156:159], v[32:35], a[76:79], v[156:159]
buffer_load_dwordx4 v2, s[16:19], s66 offen offset:0 lds
s_waitcnt lgkmcnt(0)
v_mfma_f32_16x16x32_bf16 v[176:179], v[44:47], a[64:67], v[176:179]
s_waitcnt vmcnt(17)
s_barrier
v_mfma_f32_16x16x32_bf16 v[176:179], v[48:51], a[80:83], v[176:179]
ds_read_b64_tr_b16 v[32:33], v10 offset:24576
v_mfma_f32_16x16x32_bf16 v[176:179], v[52:55], a[96:99], v[176:179]
ds_read_b64_tr_b16 v[34:35], v10 offset:25088
v_mfma_f32_16x16x32_bf16 v[180:183], v[52:55], a[100:103], v[180:183]
ds_read_b64_tr_b16 v[36:37], v10 offset:26624
v_mfma_f32_16x16x32_bf16 v[180:183], v[48:51], a[84:87], v[180:183]
ds_read_b64_tr_b16 v[38:39], v10 offset:27136
v_mfma_f32_16x16x32_bf16 v[180:183], v[44:47], a[68:71], v[180:183]
STUB_g1:
s_cbranch_execz NEXT_g1
ds_read_b64_tr_b16 v[40:41], v10 offset:28672
buffer_load_dwordx4 v2, s[20:23], s66 offen offset:1024 lds
v_mfma_f32_16x16x32_bf16 v[184:187], v[44:47], a[72:75], v[184:187]
ds_read_b64_tr_b16 v[42:43], v10 offset:29184
v_mfma_f32_16x16x32_bf16 v[184:187], v[48:51], a[88:91], v[184:187]
v_mfma_f32_16x16x32_bf16 v[184:187], v[52:55], a[104:107], v[184:187]
v_mfma_f32_16x16x32_bf16 v[188:191], v[52:55], a[108:111], v[188:191]
v_mfma_f32_16x16x32_bf16 v[188:191], v[48:51], a[92:95], v[188:191]
v_mfma_f32_16x16x32_bf16 v[188:191], v[44:47], a[76:79], v[188:191]
buffer_load_dword v213, v212, s[8:11], 0 offen offset:384
buffer_load_dword v213, v215, s[8:11], 0 offen offset:384
s_mul_i32 s58, s49, 9
v_add_u32 v212, s58, v1
v_and_b32 v219, 7, v212
v_lshrrev_b32 v212, 3, v212
v_mul_u32_u24 v212, 9216, v212
v_mul_u32_u24 v219, 1152, v219
v_add_u32 v212, v212, v219
v_cmp_gt_u32 vcc, 9, v1
v_mov_b32 v219, 2146435072
s_nop 0
v_cndmask_b32 v212, v219, v212, vcc
buffer_load_dword v213, v212, s[8:11], 0 offen offset:512
s_mov_b32 s4, s76
s_mov_b32 s5, s77
s_mov_b32 s6, 2359296
s_lshl_b32 s58, s2, 2
s_add_u32 s58, s58, s14
s_mul_i32 s60, s58, 2304
v_lshlrev_b32 v212, 7, v1
v_cmp_gt_u32 vcc, 18, v1
v_mov_b32 v219, 2146435072
s_nop 0
v_cndmask_b32 v212, v219, v212, vcc
buffer_load_dword v213, v212, s[4:7], s60 offen
s_waitcnt lgkmcnt(0)
v_mfma_f32_16x16x32_bf16 v[128:131], v[32:35], a[112:115], v[128:131]
ds_read_b64_tr_b16 v[44:45], v10 offset:25600
v_mfma_f32_16x16x32_bf16 v[128:131], v[36:39], a[128:131], v[128:131]
ds_read_b64_tr_b16 v[46:47], v10 offset:26112
v_mfma_f32_16x16x32_bf16 v[128:131], v[40:43], a[144:147], v[128:131]
ds_read_b64_tr_b16 v[48:49], v10 offset:27648
v_mfma_f32_16x16x32_bf16 v[132:135], v[40:43], a[148:151], v[132:135]
ds_read_b64_tr_b16 v[50:51], v10 offset:28160
v_mfma_f32_16x16x32_bf16 v[132:135], v[36:39], a[132:135], v[132:135]
ds_read_b64_tr_b16 v[52:53], v10 offset:29696
v_mfma_f32_16x16x32_bf16 v[132:135], v[32:35], a[116:119], v[132:135]
ds_read_b64_tr_b16 v[54:55], v10 offset:30208
v_mfma_f32_16x16x32_bf16 v[136:139], v[32:35], a[120:123], v[136:139]
v_mfma_f32_16x16x32_bf16 v[136:139], v[36:39], a[136:139], v[136:139]
v_mfma_f32_16x16x32_bf16 v[136:139], v[40:43], a[152:155], v[136:139]
v_mfma_f32_16x16x32_bf16 v[140:143], v[40:43], a[156:159], v[140:143]
v_mfma_f32_16x16x32_bf16 v[140:143], v[36:39], a[140:143], v[140:143]
v_mfma_f32_16x16x32_bf16 v[140:143], v[32:35], a[124:127], v[140:143]
s_waitcnt lgkmcnt(0)
v_mfma_f32_16x16x32_bf16 v[160:163], v[44:47], a[112:115], v[160:163]
ds_read_b64_tr_b16 v[32:33], v11 offset:24576
v_mfma_f32_16x16x32_bf16 v[160:163], v[48:51], a[128:131], v[160:163]
ds_read_b64_tr_b16 v[34:35], v11 offset:25088
v_mfma_f32_16x16x32_bf16 v[160:163], v[52:55], a[144:147], v[160:163]
ds_read_b64_tr_b16 v[36:37], v11 offset:26624
v_mfma_f32_16x16x32_bf16 v[164:167], v[52:55], a[148:151], v[164:167]
ds_read_b64_tr_b16 v[38:39], v11 offset:27136
v_mfma_f32_16x16x32_bf16 v[164:167], v[48:51], a[132:135], v[164:167]
ds_read_b64_tr_b16 v[40:41], v11 offset:28672
v_mfma_f32_16x16x32_bf16 v[164:167], v[44:47], a[116:119], v[164:167]
ds_read_b64_tr_b16 v[42:43], v11 offset:29184
v_mfma_f32_16x16x32_bf16 v[168:171], v[44:47], a[120:123], v[168:171]
v_mfma_f32_16x16x32_bf16 v[168:171], v[48:51], a[136:139], v[168:171]
v_mfma_f32_16x16x32_bf16 v[168:171], v[52:55], a[152:155], v[168:171]
v_mfma_f32_16x16x32_bf16 v[172:175], v[52:55], a[156:159], v[172:175]
v_mfma_f32_16x16x32_bf16 v[172:175], v[48:51], a[140:143], v[172:175]
v_mfma_f32_16x16x32_bf16 v[172:175], v[44:47], a[124:127], v[172:175]
s_waitcnt lgkmcnt(0)
v_mfma_f32_16x16x32_bf16 v[144:147], v[32:35], a[112:115], v[144:147]
ds_read_b64_tr_b16 v[44:45], v11 offset:25600
v_mfma_f32_16x16x32_bf16 v[144:147], v[36:39], a[128:131], v[144:147]
ds_read_b64_tr_b16 v[46:47], v11 offset:26112
v_mfma_f32_16x16x32_bf16 v[144:147], v[40:43], a[144:147], v[144:147]
ds_read_b64_tr_b16 v[48:49], v11 offset:27648
v_mfma_f32_16x16x32_bf16 v[148:151], v[40:43], a[148:151], v[148:151]
ds_read_b64_tr_b16 v[50:51], v11 offset:28160
v_mfma_f32_16x16x32_bf16 v[148:151], v[36:39], a[132:135], v[148:151]
ds_read_b64_tr_b16 v[52:53], v11 offset:29696
v_mfma_f32_16x16x32_bf16 v[148:151], v[32:35], a[116:119], v[148:151]
ds_read_b64_tr_b16 v[54:55], v11 offset:30208
v_mfma_f32_16x16x32_bf16 v[152:155], v[32:35], a[120:123], v[152:155]
v_mfma_f32_16x16x32_bf16 v[152:155], v[36:39], a[136:139], v[152:155]
v_mfma_f32_16x16x32_bf16 v[152:155], v[40:43], a[152:155], v[152:155]
v_mfma_f32_16x16x32_bf16 v[156:159], v[40:43], a[156:159], v[156:159]
v_mfma_f32_16x16x32_bf16 v[156:159], v[36:39], a[140:143], v[156:159]
v_mfma_f32_16x16x32_bf16 v[156:159], v[32:35], a[124:127], v[156:159]
s_waitcnt lgkmcnt(0)
v_mfma_f32_16x16x32_bf16 v[176:179], v[44:47], a[112:115], v[176:179]
s_waitcnt vmcnt(16)
s_barrier
v_mfma_f32_16x16x32_bf16 v[176:179], v[48:51], a[128:131], v[176:179]
ds_read_b64_tr_b16 v[32:33], v12 offset:0
v_mfma_f32_16x16x32_bf16 v[176:179], v[52:55], a[144:147], v[176:179]
ds_read_b64_tr_b16 v[34:35], v12 offset:512
v_mfma_f32_16x16x32_bf16 v[180:183], v[52:55], a[148:151], v[180:183]
ds_read_b64_tr_b16 v[36:37], v12 offset:2048
v_mfma_f32_16x16x32_bf16 v[180:183], v[48:51], a[132:135], v[180:183]
ds_read_b64_tr_b16 v[38:39], v12 offset:2560
v_mfma_f32_16x16x32_bf16 v[180:183], v[44:47], a[116:119], v[180:183]
ds_read_b64_tr_b16 v[40:41], v12 offset:4096
v_mfma_f32_16x16x32_bf16 v[184:187], v[44:47], a[120:123], v[184:187]
ds_read_b64_tr_b16 v[42:43], v12 offset:4608
v_mfma_f32_16x16x32_bf16 v[184:187], v[48:51], a[136:139], v[184:187]
v_mfma_f32_16x16x32_bf16 v[184:187], v[52:55], a[152:155], v[184:187]
v_mfma_f32_16x16x32_bf16 v[188:191], v[52:55], a[156:159], v[188:191]
v_mfma_f32_16x16x32_bf16 v[188:191], v[48:51], a[140:143], v[188:191]
v_mfma_f32_16x16x32_bf16 v[188:191], v[44:47], a[124:127], v[188:191]
s_waitcnt lgkmcnt(0)
v_mfma_f32_16x16x32_bf16 v[128:131], v[32:35], a[160:163], v[128:131]
ds_read_b64_tr_b16 v[44:45], v12 offset:1024
v_mfma_f32_16x16x32_bf16 v[128:131], v[36:39], a[176:179], v[128:131]
ds_read_b64_tr_b16 v[46:47], v12 offset:1536
v_mfma_f32_16x16x32_bf16 v[128:131], v[40:43], a[192:195], v[128:131]
ds_read_b64_tr_b16 v[48:49], v12 offset:3072
v_mfma_f32_16x16x32_bf16 v[132:135], v[40:43], a[196:199], v[132:135]
ds_read_b64_tr_b16 v[50:51], v12 offset:3584
v_mfma_f32_16x16x32_bf16 v[132:135], v[36:39], a[180:183], v[132:135]
ds_read_b64_tr_b16 v[52:53], v12 offset:5120
v_mfma_f32_16x16x32_bf16 v[132:135], v[32:35], a[164:167], v[132:135]
ds_read_b64_tr_b16 v[54:55], v12 offset:5632
v_mfma_f32_16x16x32_bf16 v[136:139], v[32:35], a[168:171], v[136:139]
s_add_u32 s66, s64, 884992
s_add_u32 m0, s65, 24576
v_mfma_f32_16x16x32_bf16 v[136:139], v[36:39], a[184:187], v[136:139]
buffer_load_dwordx4 v2, s[16:19], s66 offen offset:0 lds
buffer_load_dwordx4 v2, s[20:23], s66 offen offset:1024 lds
v_mfma_f32_16x16x32_bf16 v[136:139], v[40:43], a[200:203], v[136:139]
v_mfma_f32_16x16x32_bf16 v[140:143], v[40:43], a[204:207], v[140:143]
v_mfma_f32_16x16x32_bf16 v[140:143], v[36:39], a[188:191], v[140:143]
buffer_load_dwordx4 v3, s[16:19], s66 offen offset:2048 lds
v_mfma_f32_16x16x32_bf16 v[140:143], v[32:35], a[172:175], v[140:143]
s_waitcnt lgkmcnt(0)
v_mfma_f32_16x16x32_bf16 v[160:163], v[44:47], a[160:163], v[160:163]
ds_read_b64_tr_b16 v[32:33], v13 offset:0
v_mfma_f32_16x16x32_bf16 v[160:163], v[48:51], a[176:179], v[160:163]
ds_read_b64_tr_b16 v[34:35], v13 offset:512
v_mfma_f32_16x16x32_bf16 v[160:163], v[52:55], a[192:195], v[160:163]
ds_read_b64_tr_b16 v[36:37], v13 offset:2048
buffer_load_dwordx4 v3, s[20:23], s66 offen offset:3072 lds
v_mfma_f32_16x16x32_bf16 v[164:167], v[52:55], a[196:199], v[164:167]
ds_read_b64_tr_b16 v[38:39], v13 offset:2560
v_mfma_f32_16x16x32_bf16 v[164:167], v[48:51], a[180:183], v[164:167]
ds_read_b64_tr_b16 v[40:41], v13 offset:4096
v_mfma_f32_16x16x32_bf16 v[164:167], v[44:47], a[164:167], v[164:167]
ds_read_b64_tr_b16 v[42:43], v13 offset:4608
v_mfma_f32_16x16x32_bf16 v[168:171], v[44:47], a[168:171], v[168:171]
s_add_u32 s66, s64, 1474816
s_add_u32 m0, s65, 28672
v_mfma_f32_16x16x32_bf16 v[168:171], v[48:51], a[184:187], v[168:171]
v_mfma_f32_16x16x32_bf16 v[168:171], v[52:55], a[200:203], v[168:171]
v_mfma_f32_16x16x32_bf16 v[172:175], v[52:55], a[204:207], v[172:175]
buffer_load_dwordx4 v2, s[16:19], s66 offen offset:0 lds
v_mfma_f32_16x16x32_bf16 v[172:175], v[48:51], a[188:191], v[172:175]
v_mfma_f32_16x16x32_bf16 v[172:175], v[44:47], a[172:175], v[172:175]
s_waitcnt lgkmcnt(0)
v_mfma_f32_16x16x32_bf16 v[144:147], v[32:35], a[160:163], v[144:147]
ds_read_b64_tr_b16 v[44:45], v13 offset:1024
v_mfma_f32_16x16x32_bf16 v[144:147], v[36:39], a[176:179], v[144:147]
ds_read_b64_tr_b16 v[46:47], v13 offset:1536
buffer_load_dwordx4 v2, s[20:23], s66 offen offset:1024 lds
v_mfma_f32_16x16x32_bf16 v[144:147], v[40:43], a[192:195], v[144:147]
ds_read_b64_tr_b16 v[48:49], v13 offset:3072
v_mfma_f32_16x16x32_bf16 v[148:151], v[40:43], a[196:199], v[148:151]
ds_read_b64_tr_b16 v[50:51], v13 offset:3584
v_mfma_f32_16x16x32_bf16 v[148:151], v[36:39], a[180:183], v[148:151]
ds_read_b64_tr_b16 v[52:53], v13 offset:5120
v_mfma_f32_16x16x32_bf16 v[148:151], v[32:35], a[164:167], v[148:151]
ds_read_b64_tr_b16 v[54:55], v13 offset:5632
v_mfma_f32_16x16x32_bf16 v[152:155], v[32:35], a[168:171], v[152:155]
s_add_u32 s66, s64, 1769728
s_add_u32 m0, s65, 49152
v_mfma_f32_16x16x32_bf16 v[152:155], v[36:39], a[184:187], v[152:155]
v_mfma_f32_16x16x32_bf16 v[152:155], v[40:43], a[200:203], v[152:155]
buffer_load_dwordx4 v2, s[16:19], s66 offen offset:0 lds
v_mfma_f32_16x16x32_bf16 v[156:159], v[40:43], a[204:207], v[156:159]
v_mfma_f32_16x16x32_bf16 v[156:159], v[36:39], a[188:191], v[156:159]
v_mfma_f32_16x16x32_bf16 v[156:159], v[32:35], a[172:175], v[156:159]
s_waitcnt lgkmcnt(0)
v_mfma_f32_16x16x32_bf16 v[176:179], v[44:47], a[160:163], v[176:179]
s_waitcnt vmcnt(17)
s_barrier
v_mfma_f32_16x16x32_bf16 v[176:179], v[48:51], a[176:179], v[176:179]
ds_read_b64_tr_b16 v[32:33], v12 offset:24576
buffer_load_dwordx4 v2, s[20:23], s66 offen offset:1024 lds
v_mfma_f32_16x16x32_bf16 v[176:179], v[52:55], a[192:195], v[176:179]
ds_read_b64_tr_b16 v[34:35], v12 offset:25088
v_mfma_f32_16x16x32_bf16 v[180:183], v[52:55], a[196:199], v[180:183]
ds_read_b64_tr_b16 v[36:37], v12 offset:26624
buffer_load_dwordx4 v3, s[16:19], s66 offen offset:2048 lds
v_mfma_f32_16x16x32_bf16 v[180:183], v[48:51], a[180:183], v[180:183]
ds_read_b64_tr_b16 v[38:39], v12 offset:27136
v_mfma_f32_16x16x32_bf16 v[180:183], v[44:47], a[164:167], v[180:183]
ds_read_b64_tr_b16 v[40:41], v12 offset:28672
v_mfma_f32_16x16x32_bf16 v[184:187], v[44:47], a[168:171], v[184:187]
ds_read_b64_tr_b16 v[42:43], v12 offset:29184
v_mfma_f32_16x16x32_bf16 v[184:187], v[48:51], a[184:187], v[184:187]
buffer_load_dwordx4 v3, s[20:23], s66 offen offset:3072 lds
v_mfma_f32_16x16x32_bf16 v[184:187], v[52:55], a[200:203], v[184:187]
v_mfma_f32_16x16x32_bf16 v[188:191], v[52:55], a[204:207], v[188:191]
v_mfma_f32_16x16x32_bf16 v[188:191], v[48:51], a[188:191], v[188:191]
v_mfma_f32_16x16x32_bf16 v[188:191], v[44:47], a[172:175], v[188:191]
s_waitcnt lgkmcnt(0)
v_mfma_f32_16x16x32_bf16 v[128:131], v[32:35], a[208:211], v[128:131]
ds_read_b64_tr_b16 v[44:45], v12 offset:25600
v_mfma_f32_16x16x32_bf16 v[128:131], v[36:39], a[224:227], v[128:131]
ds_read_b64_tr_b16 v[46:47], v12 offset:26112
v_mfma_f32_16x16x32_bf16 v[128:131], v[40:43], a[240:243], v[128:131]
ds_read_b64_tr_b16 v[48:49], v12 offset:27648
v_mfma_f32_16x16x32_bf16 v[132:135], v[40:43], a[244:247], v[132:135]
ds_read_b64_tr_b16 v[50:51], v12 offset:28160
v_mfma_f32_16x16x32_bf16 v[132:135], v[36:39], a[228:231], v[132:135]
ds_read_b64_tr_b16 v[52:53], v12 offset:29696
v_mfma_f32_16x16x32_bf16 v[132:135], v[32:35], a[212:215], v[132:135]
ds_read_b64_tr_b16 v[54:55], v12 offset:30208
v_mfma_f32_16x16x32_bf16 v[136:139], v[32:35], a[216:219], v[136:139]
s_cmp_ge_u32 s61, 2146435072
s_cbranch_scc1 F2_SKIP
buffer_store_dwordx2 v[216:217], v218, s[32:35], s61 offen sc1
F2_SKIP:
v_mfma_f32_16x16x32_bf16 v[136:139], v[36:39], a[232:235], v[136:139]
buffer_store_dwordx4 v[64:67], v7, s[32:35], s100 offen offset:0 sc1
buffer_store_dwordx4 v[68:71], v7, s[32:35], s101 offen offset:0 sc1
v_mfma_f32_16x16x32_bf16 v[136:139], v[40:43], a[248:251], v[136:139]
s_add_u32 s66, s64, 2359552
s_add_u32 m0, s65, 53248
v_mfma_f32_16x16x32_bf16 v[140:143], v[40:43], a[252:255], v[140:143]
buffer_store_dwordx4 v[72:75], v7, s[32:35], s3 offen offset:0 sc1
buffer_load_dwordx4 v2, s[16:19], s66 offen offset:0 lds
v_mfma_f32_16x16x32_bf16 v[140:143], v[36:39], a[236:239], v[140:143]
buffer_load_dwordx4 v2, s[20:23], s66 offen offset:1024 lds
v_mfma_f32_16x16x32_bf16 v[140:143], v[32:35], a[220:223], v[140:143]
s_waitcnt lgkmcnt(0)
v_mfma_f32_16x16x32_bf16 v[160:163], v[44:47], a[208:211], v[160:163]
ds_read_b64_tr_b16 v[32:33], v13 offset:24576
buffer_store_dwordx4 v[76:79], v7, s[32:35], s15 offen offset:0 sc1
v_mfma_f32_16x16x32_bf16 v[160:163], v[48:51], a[224:227], v[160:163]
ds_read_b64_tr_b16 v[34:35], v13 offset:25088
v_mfma_f32_16x16x32_bf16 v[160:163], v[52:55], a[240:243], v[160:163]
ds_read_b64_tr_b16 v[36:37], v13 offset:26624
v_mfma_f32_16x16x32_bf16 v[164:167], v[52:55], a[244:247], v[164:167]
ds_read_b64_tr_b16 v[38:39], v13 offset:27136
v_mfma_f32_16x16x32_bf16 v[164:167], v[48:51], a[228:231], v[164:167]
ds_read_b64_tr_b16 v[40:41], v13 offset:28672
v_mfma_f32_16x16x32_bf16 v[164:167], v[44:47], a[212:215], v[164:167]
ds_read_b64_tr_b16 v[42:43], v13 offset:29184
v_mfma_f32_16x16x32_bf16 v[168:171], v[44:47], a[216:219], v[168:171]
s_add_u32 s66, s64, 2654464
s_add_u32 m0, s65, 73728
v_mfma_f32_16x16x32_bf16 v[168:171], v[48:51], a[232:235], v[168:171]
buffer_load_dwordx4 v2, s[16:19], s66 offen offset:0 lds
v_mfma_f32_16x16x32_bf16 v[168:171], v[52:55], a[248:251], v[168:171]
v_mfma_f32_16x16x32_bf16 v[172:175], v[52:55], a[252:255], v[172:175]
buffer_load_dwordx4 v2, s[20:23], s66 offen offset:1024 lds
v_mfma_f32_16x16x32_bf16 v[172:175], v[48:51], a[236:239], v[172:175]
v_mfma_f32_16x16x32_bf16 v[172:175], v[44:47], a[220:223], v[172:175]
s_waitcnt lgkmcnt(0)
v_mfma_f32_16x16x32_bf16 v[144:147], v[32:35], a[208:211], v[144:147]
ds_read_b64_tr_b16 v[44:45], v13 offset:25600
v_mfma_f32_16x16x32_bf16 v[144:147], v[36:39], a[224:227], v[144:147]
ds_read_b64_tr_b16 v[46:47], v13 offset:26112
buffer_load_dwordx4 v3, s[16:19], s66 offen offset:2048 lds
v_mfma_f32_16x16x32_bf16 v[144:147], v[40:43], a[240:243], v[144:147]
ds_read_b64_tr_b16 v[48:49], v13 offset:27648
v_mfma_f32_16x16x32_bf16 v[148:151], v[40:43], a[244:247], v[148:151]
ds_read_b64_tr_b16 v[50:51], v13 offset:28160
v_mfma_f32_16x16x32_bf16 v[148:151], v[36:39], a[228:231], v[148:151]
ds_read_b64_tr_b16 v[52:53], v13 offset:29696
v_mfma_f32_16x16x32_bf16 v[148:151], v[32:35], a[212:215], v[148:151]
ds_read_b64_tr_b16 v[54:55], v13 offset:30208
buffer_load_dwordx4 v3, s[20:23], s66 offen offset:3072 lds
v_mfma_f32_16x16x32_bf16 v[152:155], v[32:35], a[216:219], v[152:155]
v_mfma_f32_16x16x32_bf16 v[152:155], v[36:39], a[232:235], v[152:155]
v_mfma_f32_16x16x32_bf16 v[152:155], v[40:43], a[248:251], v[152:155]
v_mfma_f32_16x16x32_bf16 v[156:159], v[40:43], a[252:255], v[156:159]
v_mfma_f32_16x16x32_bf16 v[156:159], v[36:39], a[236:239], v[156:159]
s_add_u32 s66, s64, 3244288
s_add_u32 m0, s65, 77824
v_mfma_f32_16x16x32_bf16 v[156:159], v[32:35], a[220:223], v[156:159]
s_waitcnt lgkmcnt(0)
v_mfma_f32_16x16x32_bf16 v[176:179], v[44:47], a[208:211], v[176:179]
s_waitcnt vmcnt(24)
s_barrier
v_mfma_f32_16x16x32_bf16 v[176:179], v[48:51], a[224:227], v[176:179]
ds_read_b64_tr_b16 v[32:33], v8 offset:0
v_mfma_f32_16x16x32_bf16 v[176:179], v[52:55], a[240:243], v[176:179]
ds_read_b64_tr_b16 v[34:35], v8 offset:512
buffer_load_dwordx4 v2, s[16:19], s66 offen offset:0 lds
v_mfma_f32_16x16x32_bf16 v[180:183], v[52:55], a[244:247], v[180:183]
ds_read_b64_tr_b16 v[36:37], v8 offset:2048
v_mfma_f32_16x16x32_bf16 v[180:183], v[48:51], a[228:231], v[180:183]
ds_read_b64_tr_b16 v[38:39], v8 offset:2560
v_mfma_f32_16x16x32_bf16 v[180:183], v[44:47], a[212:215], v[180:183]
ds_read_b64_tr_b16 v[40:41], v8 offset:4096
v_mfma_f32_16x16x32_bf16 v[184:187], v[44:47], a[216:219], v[184:187]
ds_read_b64_tr_b16 v[42:43], v8 offset:4608
buffer_load_dwordx4 v2, s[20:23], s66 offen offset:1024 lds
v_mfma_f32_16x16x32_bf16 v[184:187], v[48:51], a[232:235], v[184:187]
v_mfma_f32_16x16x32_bf16 v[184:187], v[52:55], a[248:251], v[184:187]
v_mfma_f32_16x16x32_bf16 v[188:191], v[52:55], a[252:255], v[188:191]
v_mfma_f32_16x16x32_bf16 v[188:191], v[48:51], a[236:239], v[188:191]
v_mfma_f32_16x16x32_bf16 v[188:191], v[44:47], a[220:223], v[188:191]
s_waitcnt lgkmcnt(0)
v_mfma_f32_16x16x32_bf16 v[64:67], v[32:35], v[224:227], 0
ds_read_b64_tr_b16 v[44:45], v8 offset:1024
v_mfma_f32_16x16x32_bf16 v[64:67], v[36:39], v[240:243], v[64:67]
ds_read_b64_tr_b16 v[46:47], v8 offset:1536
v_mfma_f32_16x16x32_bf16 v[64:67], v[40:43], a[0:3], v[64:67]
ds_read_b64_tr_b16 v[48:49], v8 offset:3072
v_mfma_f32_16x16x32_bf16 v[68:71], v[40:43], a[4:7], 0
ds_read_b64_tr_b16 v[50:51], v8 offset:3584
v_mfma_f32_16x16x32_bf16 v[68:71], v[36:39], v[244:247], v[68:71]
ds_read_b64_tr_b16 v[52:53], v8 offset:5120
v_mfma_f32_16x16x32_bf16 v[68:71], v[32:35], v[228:231], v[68:71]
ds_read_b64_tr_b16 v[54:55], v8 offset:5632
v_mfma_f32_16x16x32_bf16 v[72:75], v[32:35], v[232:235], 0
s_add_u32 s66, s64, 3539200
s_add_u32 m0, s65, 98304
v_mfma_f32_16x16x32_bf16 v[72:75], v[36:39], v[248:251], v[72:75]
buffer_load_dwordx4 v2, s[16:19], s66 offen offset:0 lds
v_mfma_f32_16x16x32_bf16 v[72:75], v[40:43], a[8:11], v[72:75]
v_mfma_f32_16x16x32_bf16 v[76:79], v[40:43], a[12:15], 0
v_mfma_f32_16x16x32_bf16 v[76:79], v[36:39], v[252:255], v[76:79]
v_mul_f32 v128, v128, v160
v_mfma_f32_16x16x32_bf16 v[76:79], v[32:35], v[236:239], v[76:79]
buffer_load_dwordx4 v2, s[20:23], s66 offen offset:1024 lds
v_mul_f32 v129, v129, v161
s_waitcnt lgkmcnt(0)
v_mfma_f32_16x16x32_bf16 v[96:99], v[44:47], v[224:227], 0
ds_read_b64_tr_b16 v[32:33], v9 offset:0
v_mfma_f32_16x16x32_bf16 v[96:99], v[48:51], v[240:243], v[96:99]
ds_read_b64_tr_b16 v[34:35], v9 offset:512
v_mul_f32 v130, v130, v162
v_mfma_f32_16x16x32_bf16 v[96:99], v[52:55], a[0:3], v[96:99]
ds_read_b64_tr_b16 v[36:37], v9 offset:2048
v_mul_f32 v131, v131, v163
v_mfma_f32_16x16x32_bf16 v[100:103], v[52:55], a[4:7], 0
ds_read_b64_tr_b16 v[38:39], v9 offset:2560
v_mfma_f32_16x16x32_bf16 v[100:103], v[48:51], v[244:247], v[100:103]
ds_read_b64_tr_b16 v[40:41], v9 offset:4096
v_cvt_pk_bf16_f32 v128, v128, v129
v_mfma_f32_16x16x32_bf16 v[100:103], v[44:47], v[228:231], v[100:103]
ds_read_b64_tr_b16 v[42:43], v9 offset:4608
buffer_load_dwordx4 v3, s[16:19], s66 offen offset:2048 lds
v_mfma_f32_16x16x32_bf16 v[104:107], v[44:47], v[232:235], 0
v_cvt_pk_bf16_f32 v129, v130, v131
v_mfma_f32_16x16x32_bf16 v[104:107], v[48:51], v[248:251], v[104:107]
v_mul_f32 v144, v144, v176
v_mfma_f32_16x16x32_bf16 v[104:107], v[52:55], a[8:11], v[104:107]
v_mfma_f32_16x16x32_bf16 v[108:111], v[52:55], a[12:15], 0
v_mul_f32 v145, v145, v177
v_mfma_f32_16x16x32_bf16 v[108:111], v[48:51], v[252:255], v[108:111]
v_mul_f32 v146, v146, v178
v_mfma_f32_16x16x32_bf16 v[108:111], v[44:47], v[236:239], v[108:111]
buffer_load_dwordx4 v3, s[20:23], s66 offen offset:3072 lds
s_waitcnt lgkmcnt(0)
v_mfma_f32_16x16x32_bf16 v[80:83], v[32:35], v[224:227], 0
ds_read_b64_tr_b16 v[44:45], v9 offset:1024
v_mul_f32 v147, v147, v179
v_mfma_f32_16x16x32_bf16 v[80:83], v[36:39], v[240:243], v[80:83]
ds_read_b64_tr_b16 v[46:47], v9 offset:1536
v_cvt_pk_bf16_f32 v130, v144, v145
v_mfma_f32_16x16x32_bf16 v[80:83], v[40:43], a[0:3], v[80:83]
ds_read_b64_tr_b16 v[48:49], v9 offset:3072
v_mfma_f32_16x16x32_bf16 v[84:87], v[40:43], a[4:7], 0
ds_read_b64_tr_b16 v[50:51], v9 offset:3584
v_cvt_pk_bf16_f32 v131, v146, v147
v_mfma_f32_16x16x32_bf16 v[84:87], v[36:39], v[244:247], v[84:87]
ds_read_b64_tr_b16 v[52:53], v9 offset:5120
v_mfma_f32_16x16x32_bf16 v[84:87], v[32:35], v[228:231], v[84:87]
ds_read_b64_tr_b16 v[54:55], v9 offset:5632
v_mul_f32 v132, v132, v164
v_mfma_f32_16x16x32_bf16 v[88:91], v[32:35], v[232:235], 0
s_add_u32 s66, s64, 4129024
s_add_u32 m0, s65, 102400
v_mfma_f32_16x16x32_bf16 v[88:91], v[36:39], v[248:251], v[88:91]
v_mul_f32 v133, v133, v165
v_mfma_f32_16x16x32_bf16 v[88:91], v[40:43], a[8:11], v[88:91]
v_mul_f32 v134, v134, v166
v_mfma_f32_16x16x32_bf16 v[92:95], v[40:43], a[12:15], 0
v_mul_f32 v135, v135, v167
v_mfma_f32_16x16x32_bf16 v[92:95], v[36:39], v[252:255], v[92:95]
v_mfma_f32_16x16x32_bf16 v[92:95], v[32:35], v[236:239], v[92:95]
buffer_load_dwordx4 v2, s[16:19], s66 offen offset:0 lds
v_cvt_pk_bf16_f32 v132, v132, v133
s_waitcnt lgkmcnt(0)
v_mfma_f32_16x16x32_bf16 v[112:115], v[44:47], v[224:227], 0
s_waitcnt vmcnt(21)
s_barrier
v_mfma_f32_16x16x32_bf16 v[112:115], v[48:51], v[240:243], v[112:115]
ds_read_b64_tr_b16 v[32:33], v8 offset:24576
v_cvt_pk_bf16_f32 v133, v134, v135
v_mfma_f32_16x16x32_bf16 v[112:115], v[52:55], a[0:3], v[112:115]
ds_read_b64_tr_b16 v[34:35], v8 offset:25088
v_mul_f32 v148, v148, v180
v_mfma_f32_16x16x32_bf16 v[116:119], v[52:55], a[4:7], 0
ds_read_b64_tr_b16 v[36:37], v8 offset:26624
v_mfma_f32_16x16x32_bf16 v[116:119], v[48:51], v[244:247], v[116:119]
ds_read_b64_tr_b16 v[38:39], v8 offset:27136
v_mul_f32 v149, v149, v181
v_mfma_f32_16x16x32_bf16 v[116:119], v[44:47], v[228:231], v[116:119]
ds_read_b64_tr_b16 v[40:41], v8 offset:28672
buffer_load_dwordx4 v2, s[20:23], s66 offen offset:1024 lds
v_mfma_f32_16x16x32_bf16 v[120:123], v[44:47], v[232:235], 0
ds_read_b64_tr_b16 v[42:43], v8 offset:29184
v_mul_f32 v150, v150, v182
v_mfma_f32_16x16x32_bf16 v[120:123], v[48:51], v[248:251], v[120:123]
v_mul_f32 v151, v151, v183
v_mfma_f32_16x16x32_bf16 v[120:123], v[52:55], a[8:11], v[120:123]
v_cvt_pk_bf16_f32 v134, v148, v149
v_mfma_f32_16x16x32_bf16 v[124:127], v[52:55], a[12:15], 0
v_mfma_f32_16x16x32_bf16 v[124:127], v[48:51], v[252:255], v[124:127]
v_cvt_pk_bf16_f32 v135, v150, v151
v_mfma_f32_16x16x32_bf16 v[124:127], v[44:47], v[236:239], v[124:127]
s_mov_b32 s4, s86
s_mov_b32 s5, s87
s_mov_b32 s6, 5308416
s_lshl_b32 s58, s2, 2
s_add_u32 s58, s58, s14
s_mul_i32 s60, s58, 5184
v_lshlrev_b32 v212, 7, v1
v_cmp_gt_u32 vcc, 21, v1
v_mov_b32 v219, 2146435072
s_nop 0
v_cndmask_b32 v212, v219, v212, vcc
buffer_load_dword v213, v212, s[4:7], s60 offen
buffer_load_dword v213, v212, s[4:7], s60 offen offset:2560
s_waitcnt lgkmcnt(0)
v_mfma_f32_16x16x32_bf16 v[64:67], v[32:35], a[16:19], v[64:67]
ds_read_b64_tr_b16 v[44:45], v8 offset:25600
v_mul_f32 v136, v136, v168
v_mfma_f32_16x16x32_bf16 v[64:67], v[36:39], a[32:35], v[64:67]
ds_read_b64_tr_b16 v[46:47], v8 offset:26112
v_mfma_f32_16x16x32_bf16 v[64:67], v[40:43], a[48:51], v[64:67]
ds_read_b64_tr_b16 v[48:49], v8 offset:27648
v_mul_f32 v137, v137, v169
v_mfma_f32_16x16x32_bf16 v[68:71], v[40:43], a[52:55], v[68:71]
ds_read_b64_tr_b16 v[50:51], v8 offset:28160
v_mfma_f32_16x16x32_bf16 v[68:71], v[36:39], a[36:39], v[68:71]
ds_read_b64_tr_b16 v[52:53], v8 offset:29696
v_mul_f32 v138, v138, v170
v_mfma_f32_16x16x32_bf16 v[68:71], v[32:35], a[20:23], v[68:71]
ds_read_b64_tr_b16 v[54:55], v8 offset:30208
v_mfma_f32_16x16x32_bf16 v[72:75], v[32:35], a[24:27], v[72:75]
v_mul_f32 v139, v139, v171
v_mfma_f32_16x16x32_bf16 v[72:75], v[36:39], a[40:43], v[72:75]
v_mfma_f32_16x16x32_bf16 v[72:75], v[40:43], a[56:59], v[72:75]
v_cvt_pk_bf16_f32 v136, v136, v137
v_mfma_f32_16x16x32_bf16 v[76:79], v[40:43], a[60:63], v[76:79]
v_mfma_f32_16x16x32_bf16 v[76:79], v[36:39], a[44:47], v[76:79]
v_cvt_pk_bf16_f32 v137, v138, v139
v_mfma_f32_16x16x32_bf16 v[76:79], v[32:35], a[28:31], v[76:79]
s_waitcnt lgkmcnt(0)
v_mfma_f32_16x16x32_bf16 v[96:99], v[44:47], a[16:19], v[96:99]
ds_read_b64_tr_b16 v[32:33], v9 offset:24576
v_mul_f32 v152, v152, v184
v_mfma_f32_16x16x32_bf16 v[96:99], v[48:51], a[32:35], v[96:99]
ds_read_b64_tr_b16 v[34:35], v9 offset:25088
v_mfma_f32_16x16x32_bf16 v[96:99], v[52:55], a[48:51], v[96:99]
ds_read_b64_tr_b16 v[36:37], v9 offset:26624
v_mul_f32 v153, v153, v185
v_mfma_f32_16x16x32_bf16 v[100:103], v[52:55], a[52:55], v[100:103]
ds_read_b64_tr_b16 v[38:39], v9 offset:27136
v_mfma_f32_16x16x32_bf16 v[100:103], v[48:51], a[36:39], v[100:103]
ds_read_b64_tr_b16 v[40:41], v9 offset:28672
v_mul_f32 v154, v154, v186
v_mfma_f32_16x16x32_bf16 v[100:103], v[44:47], a[20:23], v[100:103]
ds_read_b64_tr_b16 v[42:43], v9 offset:29184
v_mfma_f32_16x16x32_bf16 v[104:107], v[44:47], a[24:27], v[104:107]
v_mul_f32 v155, v155, v187
v_mfma_f32_16x16x32_bf16 v[104:107], v[48:51], a[40:43], v[104:107]
v_mfma_f32_16x16x32_bf16 v[104:107], v[52:55], a[56:59], v[104:107]
v_cvt_pk_bf16_f32 v138, v152, v153
v_mfma_f32_16x16x32_bf16 v[108:111], v[52:55], a[60:63], v[108:111]
v_mfma_f32_16x16x32_bf16 v[108:111], v[48:51], a[44:47], v[108:111]
v_cvt_pk_bf16_f32 v139, v154, v155
v_mfma_f32_16x16x32_bf16 v[108:111], v[44:47], a[28:31], v[108:111]
s_waitcnt lgkmcnt(0)
v_mfma_f32_16x16x32_bf16 v[80:83], v[32:35], a[16:19], v[80:83]
ds_read_b64_tr_b16 v[44:45], v9 offset:25600
v_mul_f32 v140, v140, v172
v_mfma_f32_16x16x32_bf16 v[80:83], v[36:39], a[32:35], v[80:83]
ds_read_b64_tr_b16 v[46:47], v9 offset:26112
v_mfma_f32_16x16x32_bf16 v[80:83], v[40:43], a[48:51], v[80:83]
ds_read_b64_tr_b16 v[48:49], v9 offset:27648
v_mul_f32 v141, v141, v173
v_mfma_f32_16x16x32_bf16 v[84:87], v[40:43], a[52:55], v[84:87]
ds_read_b64_tr_b16 v[50:51], v9 offset:28160
v_mfma_f32_16x16x32_bf16 v[84:87], v[36:39], a[36:39], v[84:87]
ds_read_b64_tr_b16 v[52:53], v9 offset:29696
v_mul_f32 v142, v142, v174
v_mfma_f32_16x16x32_bf16 v[84:87], v[32:35], a[20:23], v[84:87]
ds_read_b64_tr_b16 v[54:55], v9 offset:30208
v_mfma_f32_16x16x32_bf16 v[88:91], v[32:35], a[24:27], v[88:91]
v_mul_f32 v143, v143, v175
v_mfma_f32_16x16x32_bf16 v[88:91], v[36:39], a[40:43], v[88:91]
v_mfma_f32_16x16x32_bf16 v[88:91], v[40:43], a[56:59], v[88:91]
v_cvt_pk_bf16_f32 v140, v140, v141
v_mfma_f32_16x16x32_bf16 v[92:95], v[40:43], a[60:63], v[92:95]
v_mfma_f32_16x16x32_bf16 v[92:95], v[36:39], a[44:47], v[92:95]
v_cvt_pk_bf16_f32 v141, v142, v143
v_mfma_f32_16x16x32_bf16 v[92:95], v[32:35], a[28:31], v[92:95]
s_waitcnt lgkmcnt(0)
v_mfma_f32_16x16x32_bf16 v[112:115], v[44:47], a[16:19], v[112:115]
s_waitcnt vmcnt(15)
s_barrier
v_mfma_f32_16x16x32_bf16 v[112:115], v[48:51], a[32:35], v[112:115]
ds_read_b64_tr_b16 v[32:33], v10 offset:0
v_mul_f32 v156, v156, v188
v_mfma_f32_16x16x32_bf16 v[112:115], v[52:55], a[48:51], v[112:115]
ds_read_b64_tr_b16 v[34:35], v10 offset:512
v_mul_f32 v157, v157, v189
v_mfma_f32_16x16x32_bf16 v[116:119], v[52:55], a[52:55], v[116:119]
ds_read_b64_tr_b16 v[36:37], v10 offset:2048
v_mfma_f32_16x16x32_bf16 v[116:119], v[48:51], a[36:39], v[116:119]
ds_read_b64_tr_b16 v[38:39], v10 offset:2560
v_mul_f32 v158, v158, v190
v_mfma_f32_16x16x32_bf16 v[116:119], v[44:47], a[20:23], v[116:119]
ds_read_b64_tr_b16 v[40:41], v10 offset:4096
v_mfma_f32_16x16x32_bf16 v[120:123], v[44:47], a[24:27], v[120:123]
ds_read_b64_tr_b16 v[42:43], v10 offset:4608
v_mul_f32 v159, v159, v191
v_mfma_f32_16x16x32_bf16 v[120:123], v[48:51], a[40:43], v[120:123]
v_mfma_f32_16x16x32_bf16 v[120:123], v[52:55], a[56:59], v[120:123]
v_cvt_pk_bf16_f32 v142, v156, v157
v_mfma_f32_16x16x32_bf16 v[124:127], v[52:55], a[60:63], v[124:127]
v_mfma_f32_16x16x32_bf16 v[124:127], v[48:51], a[44:47], v[124:127]
v_cvt_pk_bf16_f32 v143, v158, v159
v_mfma_f32_16x16x32_bf16 v[124:127], v[44:47], a[28:31], v[124:127]
s_waitcnt lgkmcnt(0)
v_mfma_f32_16x16x32_bf16 v[64:67], v[32:35], a[64:67], v[64:67]
ds_read_b64_tr_b16 v[44:45], v10 offset:1024
v_mfma_f32_16x16x32_bf16 v[64:67], v[36:39], a[80:83], v[64:67]
ds_read_b64_tr_b16 v[46:47], v10 offset:1536
v_mfma_f32_16x16x32_bf16 v[64:67], v[40:43], a[96:99], v[64:67]
ds_read_b64_tr_b16 v[48:49], v10 offset:3072
v_mfma_f32_16x16x32_bf16 v[68:71], v[40:43], a[100:103], v[68:71]
ds_read_b64_tr_b16 v[50:51], v10 offset:3584
v_mfma_f32_16x16x32_bf16 v[68:71], v[36:39], a[84:87], v[68:71]
ds_read_b64_tr_b16 v[52:53], v10 offset:5120
v_mfma_f32_16x16x32_bf16 v[68:71], v[32:35], a[68:71], v[68:71]
ds_read_b64_tr_b16 v[54:55], v10 offset:5632
v_mfma_f32_16x16x32_bf16 v[72:75], v[32:35], a[72:75], v[72:75]
s_add_u32 s66, s64, 4423936
s_add_u32 m0, s65, 122880
v_mfma_f32_16x16x32_bf16 v[72:75], v[36:39], a[88:91], v[72:75]
buffer_load_dwordx4 v2, s[16:19], s66 offen offset:0 lds
buffer_load_dwordx4 v2, s[20:23], s66 offen offset:1024 lds
v_mfma_f32_16x16x32_bf16 v[72:75], v[40:43], a[104:107], v[72:75]
v_mfma_f32_16x16x32_bf16 v[76:79], v[40:43], a[108:111], v[76:79]
v_mfma_f32_16x16x32_bf16 v[76:79], v[36:39], a[92:95], v[76:79]
STUB_g2:
s_cbranch_execz NEXT_g2
buffer_load_dwordx4 v3, s[16:19], s66 offen offset:2048 lds
v_mfma_f32_16x16x32_bf16 v[76:79], v[32:35], a[76:79], v[76:79]
s_waitcnt lgkmcnt(0)
v_mfma_f32_16x16x32_bf16 v[96:99], v[44:47], a[64:67], v[96:99]
ds_read_b64_tr_b16 v[32:33], v11 offset:0
v_mfma_f32_16x16x32_bf16 v[96:99], v[48:51], a[80:83], v[96:99]
ds_read_b64_tr_b16 v[34:35], v11 offset:512
v_mfma_f32_16x16x32_bf16 v[96:99], v[52:55], a[96:99], v[96:99]
ds_read_b64_tr_b16 v[36:37], v11 offset:2048
buffer_load_dwordx4 v3, s[20:23], s66 offen offset:3072 lds
v_mfma_f32_16x16x32_bf16 v[100:103], v[52:55], a[100:103], v[100:103]
ds_read_b64_tr_b16 v[38:39], v11 offset:2560
v_mfma_f32_16x16x32_bf16 v[100:103], v[48:51], a[84:87], v[100:103]
ds_read_b64_tr_b16 v[40:41], v11 offset:4096
v_mfma_f32_16x16x32_bf16 v[100:103], v[44:47], a[68:71], v[100:103]
ds_read_b64_tr_b16 v[42:43], v11 offset:4608
v_mfma_f32_16x16x32_bf16 v[104:107], v[44:47], a[72:75], v[104:107]
s_add_u32 s66, s64, 5013760
s_add_u32 m0, s65, 126976
v_mfma_f32_16x16x32_bf16 v[104:107], v[48:51], a[88:91], v[104:107]
v_mfma_f32_16x16x32_bf16 v[104:107], v[52:55], a[104:107], v[104:107]
v_mfma_f32_16x16x32_bf16 v[108:111], v[52:55], a[108:111], v[108:111]
buffer_load_dwordx4 v2, s[16:19], s66 offen offset:0 lds
v_mfma_f32_16x16x32_bf16 v[108:111], v[48:51], a[92:95], v[108:111]
v_mfma_f32_16x16x32_bf16 v[108:111], v[44:47], a[76:79], v[108:111]
s_waitcnt lgkmcnt(0)
v_mfma_f32_16x16x32_bf16 v[80:83], v[32:35], a[64:67], v[80:83]
ds_read_b64_tr_b16 v[44:45], v11 offset:1024
v_mfma_f32_16x16x32_bf16 v[80:83], v[36:39], a[80:83], v[80:83]
ds_read_b64_tr_b16 v[46:47], v11 offset:1536
buffer_load_dwordx4 v2, s[20:23], s66 offen offset:1024 lds
v_mfma_f32_16x16x32_bf16 v[80:83], v[40:43], a[96:99], v[80:83]
ds_read_b64_tr_b16 v[48:49], v11 offset:3072
v_mfma_f32_16x16x32_bf16 v[84:87], v[40:43], a[100:103], v[84:87]
ds_read_b64_tr_b16 v[50:51], v11 offset:3584
v_mfma_f32_16x16x32_bf16 v[84:87], v[36:39], a[84:87], v[84:87]
ds_read_b64_tr_b16 v[52:53], v11 offset:5120
v_mfma_f32_16x16x32_bf16 v[84:87], v[32:35], a[68:71], v[84:87]
ds_read_b64_tr_b16 v[54:55], v11 offset:5632
v_mfma_f32_16x16x32_bf16 v[88:91], v[32:35], a[72:75], v[88:91]
s_add_u32 s66, s64, 384
s_add_u32 m0, s65, 0
v_mfma_f32_16x16x32_bf16 v[88:91], v[36:39], a[88:91], v[88:91]
v_mfma_f32_16x16x32_bf16 v[88:91], v[40:43], a[104:107], v[88:91]
buffer_load_dwordx4 v2, s[16:19], s66 offen offset:0 lds
v_mfma_f32_16x16x32_bf16 v[92:95], v[40:43], a[108:111], v[92:95]
v_mfma_f32_16x16x32_bf16 v[92:95], v[36:39], a[92:95], v[92:95]
v_mfma_f32_16x16x32_bf16 v[92:95], v[32:35], a[76:79], v[92:95]
s_waitcnt lgkmcnt(0)
v_mfma_f32_16x16x32_bf16 v[112:115], v[44:47], a[64:67], v[112:115]
s_waitcnt vmcnt(15)
s_barrier
v_mfma_f32_16x16x32_bf16 v[112:115], v[48:51], a[80:83], v[112:115]
ds_read_b64_tr_b16 v[32:33], v10 offset:24576
buffer_load_dwordx4 v2, s[20:23], s66 offen offset:1024 lds
v_mfma_f32_16x16x32_bf16 v[112:115], v[52:55], a[96:99], v[112:115]
ds_read_b64_tr_b16 v[34:35], v10 offset:25088
v_mfma_f32_16x16x32_bf16 v[116:119], v[52:55], a[100:103], v[116:119]
ds_read_b64_tr_b16 v[36:37], v10 offset:26624
buffer_load_dwordx4 v3, s[16:19], s66 offen offset:2048 lds
v_mfma_f32_16x16x32_bf16 v[116:119], v[48:51], a[84:87], v[116:119]
ds_read_b64_tr_b16 v[38:39], v10 offset:27136
v_mfma_f32_16x16x32_bf16 v[116:119], v[44:47], a[68:71], v[116:119]
ds_read_b64_tr_b16 v[40:41], v10 offset:28672
v_mfma_f32_16x16x32_bf16 v[120:123], v[44:47], a[72:75], v[120:123]
ds_read_b64_tr_b16 v[42:43], v10 offset:29184
v_mfma_f32_16x16x32_bf16 v[120:123], v[48:51], a[88:91], v[120:123]
buffer_load_dwordx4 v3, s[20:23], s66 offen offset:3072 lds
v_mfma_f32_16x16x32_bf16 v[120:123], v[52:55], a[104:107], v[120:123]
v_mfma_f32_16x16x32_bf16 v[124:127], v[52:55], a[108:111], v[124:127]
v_mfma_f32_16x16x32_bf16 v[124:127], v[48:51], a[92:95], v[124:127]
v_mfma_f32_16x16x32_bf16 v[124:127], v[44:47], a[76:79], v[124:127]
s_waitcnt lgkmcnt(0)
v_mfma_f32_16x16x32_bf16 v[64:67], v[32:35], a[112:115], v[64:67]
ds_read_b64_tr_b16 v[44:45], v10 offset:25600
v_mfma_f32_16x16x32_bf16 v[64:67], v[36:39], a[128:131], v[64:67]
ds_read_b64_tr_b16 v[46:47], v10 offset:26112
v_mfma_f32_16x16x32_bf16 v[64:67], v[40:43], a[144:147], v[64:67]
ds_read_b64_tr_b16 v[48:49], v10 offset:27648
v_mfma_f32_16x16x32_bf16 v[68:71], v[40:43], a[148:151], v[68:71]
ds_read_b64_tr_b16 v[50:51], v10 offset:28160
v_mfma_f32_16x16x32_bf16 v[68:71], v[36:39], a[132:135], v[68:71]
ds_read_b64_tr_b16 v[52:53], v10 offset:29696
v_mfma_f32_16x16x32_bf16 v[68:71], v[32:35], a[116:119], v[68:71]
ds_read_b64_tr_b16 v[54:55], v10 offset:30208
v_mfma_f32_16x16x32_bf16 v[72:75], v[32:35], a[120:123], v[72:75]
s_add_u32 s66, s64, 590208
s_add_u32 m0, s65, 4096
v_mfma_f32_16x16x32_bf16 v[72:75], v[36:39], a[136:139], v[72:75]
buffer_load_dwordx4 v2, s[16:19], s66 offen offset:0 lds
v_mfma_f32_16x16x32_bf16 v[72:75], v[40:43], a[152:155], v[72:75]
buffer_load_dwordx4 v2, s[20:23], s66 offen offset:1024 lds
v_mfma_f32_16x16x32_bf16 v[76:79], v[40:43], a[156:159], v[76:79]
v_mfma_f32_16x16x32_bf16 v[76:79], v[36:39], a[140:143], v[76:79]
v_mfma_f32_16x16x32_bf16 v[76:79], v[32:35], a[124:127], v[76:79]
s_waitcnt lgkmcnt(0)
v_mfma_f32_16x16x32_bf16 v[96:99], v[44:47], a[112:115], v[96:99]
ds_read_b64_tr_b16 v[32:33], v11 offset:24576
v_mfma_f32_16x16x32_bf16 v[96:99], v[48:51], a[128:131], v[96:99]
ds_read_b64_tr_b16 v[34:35], v11 offset:25088
v_mfma_f32_16x16x32_bf16 v[96:99], v[52:55], a[144:147], v[96:99]
ds_read_b64_tr_b16 v[36:37], v11 offset:26624
v_mfma_f32_16x16x32_bf16 v[100:103], v[52:55], a[148:151], v[100:103]
ds_read_b64_tr_b16 v[38:39], v11 offset:27136
v_mfma_f32_16x16x32_bf16 v[100:103], v[48:51], a[132:135], v[100:103]
ds_read_b64_tr_b16 v[40:41], v11 offset:28672
v_mfma_f32_16x16x32_bf16 v[100:103], v[44:47], a[116:119], v[100:103]
ds_read_b64_tr_b16 v[42:43], v11 offset:29184
v_mfma_f32_16x16x32_bf16 v[104:107], v[44:47], a[120:123], v[104:107]
s_add_u32 s66, s64, 885120
s_add_u32 m0, s65, 24576
v_mfma_f32_16x16x32_bf16 v[104:107], v[48:51], a[136:139], v[104:107]
buffer_load_dwordx4 v2, s[16:19], s66 offen offset:0 lds
v_mfma_f32_16x16x32_bf16 v[104:107], v[52:55], a[152:155], v[104:107]
v_mfma_f32_16x16x32_bf16 v[108:111], v[52:55], a[156:159], v[108:111]
buffer_load_dwordx4 v2, s[20:23], s66 offen offset:1024 lds
v_mfma_f32_16x16x32_bf16 v[108:111], v[48:51], a[140:143], v[108:111]
v_mfma_f32_16x16x32_bf16 v[108:111], v[44:47], a[124:127], v[108:111]
s_waitcnt lgkmcnt(0)
v_mfma_f32_16x16x32_bf16 v[80:83], v[32:35], a[112:115], v[80:83]
ds_read_b64_tr_b16 v[44:45], v11 offset:25600
v_mfma_f32_16x16x32_bf16 v[80:83], v[36:39], a[128:131], v[80:83]
ds_read_b64_tr_b16 v[46:47], v11 offset:26112
buffer_load_dwordx4 v3, s[16:19], s66 offen offset:2048 lds
v_mfma_f32_16x16x32_bf16 v[80:83], v[40:43], a[144:147], v[80:83]
ds_read_b64_tr_b16 v[48:49], v11 offset:27648
v_mfma_f32_16x16x32_bf16 v[84:87], v[40:43], a[148:151], v[84:87]
ds_read_b64_tr_b16 v[50:51], v11 offset:28160
v_mfma_f32_16x16x32_bf16 v[84:87], v[36:39], a[132:135], v[84:87]
ds_read_b64_tr_b16 v[52:53], v11 offset:29696
v_mfma_f32_16x16x32_bf16 v[84:87], v[32:35], a[116:119], v[84:87]
ds_read_b64_tr_b16 v[54:55], v11 offset:30208
buffer_load_dwordx4 v3, s[20:23], s66 offen offset:3072 lds
v_mfma_f32_16x16x32_bf16 v[88:91], v[32:35], a[120:123], v[88:91]
v_mfma_f32_16x16x32_bf16 v[88:91], v[36:39], a[136:139], v[88:91]
v_mfma_f32_16x16x32_bf16 v[88:91], v[40:43], a[152:155], v[88:91]
v_mfma_f32_16x16x32_bf16 v[92:95], v[40:43], a[156:159], v[92:95]
v_mfma_f32_16x16x32_bf16 v[92:95], v[36:39], a[140:143], v[92:95]
s_add_u32 s66, s64, 1474944
s_add_u32 m0, s65, 28672
v_mfma_f32_16x16x32_bf16 v[92:95], v[32:35], a[124:127], v[92:95]
s_waitcnt lgkmcnt(0)
v_mfma_f32_16x16x32_bf16 v[112:115], v[44:47], a[112:115], v[112:115]
s_waitcnt vmcnt(18)
s_barrier
v_mfma_f32_16x16x32_bf16 v[112:115], v[48:51], a[128:131], v[112:115]
ds_read_b64_tr_b16 v[32:33], v12 offset:0
v_mfma_f32_16x16x32_bf16 v[112:115], v[52:55], a[144:147], v[112:115]
ds_read_b64_tr_b16 v[34:35], v12 offset:512
buffer_load_dwordx4 v2, s[16:19], s66 offen offset:0 lds
v_mfma_f32_16x16x32_bf16 v[116:119], v[52:55], a[148:151], v[116:119]
ds_read_b64_tr_b16 v[36:37], v12 offset:2048
v_mfma_f32_16x16x32_bf16 v[116:119], v[48:51], a[132:135], v[116:119]
ds_read_b64_tr_b16 v[38:39], v12 offset:2560
v_mfma_f32_16x16x32_bf16 v[116:119], v[44:47], a[116:119], v[116:119]
ds_read_b64_tr_b16 v[40:41], v12 offset:4096
v_mfma_f32_16x16x32_bf16 v[120:123], v[44:47], a[120:123], v[120:123]
ds_read_b64_tr_b16 v[42:43], v12 offset:4608
buffer_load_dwordx4 v2, s[20:23], s66 offen offset:1024 lds
v_mfma_f32_16x16x32_bf16 v[120:123], v[48:51], a[136:139], v[120:123]
v_mfma_f32_16x16x32_bf16 v[120:123], v[52:55], a[152:155], v[120:123]
v_mfma_f32_16x16x32_bf16 v[124:127], v[52:55], a[156:159], v[124:127]
v_mfma_f32_16x16x32_bf16 v[124:127], v[48:51], a[140:143], v[124:127]
v_mfma_f32_16x16x32_bf16 v[124:127], v[44:47], a[124:127], v[124:127]
s_waitcnt lgkmcnt(0)
v_mfma_f32_16x16x32_bf16 v[64:67], v[32:35], a[160:163], v[64:67]
ds_read_b64_tr_b16 v[44:45], v12 offset:1024
v_mfma_f32_16x16x32_bf16 v[64:67], v[36:39], a[176:179], v[64:67]
ds_read_b64_tr_b16 v[46:47], v12 offset:1536
v_mfma_f32_16x16x32_bf16 v[64:67], v[40:43], a[192:195], v[64:67]
ds_read_b64_tr_b16 v[48:49], v12 offset:3072
v_mfma_f32_16x16x32_bf16 v[68:71], v[40:43], a[196:199], v[68:71]
ds_read_b64_tr_b16 v[50:51], v12 offset:3584
v_mfma_f32_16x16x32_bf16 v[68:71], v[36:39], a[180:183], v[68:71]
ds_read_b64_tr_b16 v[52:53], v12 offset:5120
v_mfma_f32_16x16x32_bf16 v[68:71], v[32:35], a[164:167], v[68:71]
ds_read_b64_tr_b16 v[54:55], v12 offset:5632
v_mfma_f32_16x16x32_bf16 v[72:75], v[32:35], a[168:171], v[72:75]
s_add_u32 s66, s64, 1769856
s_add_u32 m0, s65, 49152
v_mfma_f32_16x16x32_bf16 v[72:75], v[36:39], a[184:187], v[72:75]
buffer_load_dwordx4 v2, s[16:19], s66 offen offset:0 lds
v_mfma_f32_16x16x32_bf16 v[72:75], v[40:43], a[200:203], v[72:75]
v_mfma_f32_16x16x32_bf16 v[76:79], v[40:43], a[204:207], v[76:79]
v_mfma_f32_16x16x32_bf16 v[76:79], v[36:39], a[188:191], v[76:79]
v_mfma_f32_16x16x32_bf16 v[76:79], v[32:35], a[172:175], v[76:79]
buffer_load_dwordx4 v2, s[20:23], s66 offen offset:1024 lds
s_waitcnt lgkmcnt(0)
v_mfma_f32_16x16x32_bf16 v[96:99], v[44:47], a[160:163], v[96:99]
ds_read_b64_tr_b16 v[32:33], v13 offset:0
v_mfma_f32_16x16x32_bf16 v[96:99], v[48:51], a[176:179], v[96:99]
ds_read_b64_tr_b16 v[34:35], v13 offset:512
v_mfma_f32_16x16x32_bf16 v[96:99], v[52:55], a[192:195], v[96:99]
ds_read_b64_tr_b16 v[36:37], v13 offset:2048
v_mfma_f32_16x16x32_bf16 v[100:103], v[52:55], a[196:199], v[100:103]
ds_read_b64_tr_b16 v[38:39], v13 offset:2560
v_mfma_f32_16x16x32_bf16 v[100:103], v[48:51], a[180:183], v[100:103]
ds_read_b64_tr_b16 v[40:41], v13 offset:4096
v_mfma_f32_16x16x32_bf16 v[100:103], v[44:47], a[164:167], v[100:103]
ds_read_b64_tr_b16 v[42:43], v13 offset:4608
buffer_load_dwordx4 v3, s[16:19], s66 offen offset:2048 lds
v_mfma_f32_16x16x32_bf16 v[104:107], v[44:47], a[168:171], v[104:107]
v_mfma_f32_16x16x32_bf16 v[104:107], v[48:51], a[184:187], v[104:107]
v_mfma_f32_16x16x32_bf16 v[104:107], v[52:55], a[200:203], v[104:107]
v_mfma_f32_16x16x32_bf16 v[108:111], v[52:55], a[204:207], v[108:111]
v_mfma_f32_16x16x32_bf16 v[108:111], v[48:51], a[188:191], v[108:111]
v_mfma_f32_16x16x32_bf16 v[108:111], v[44:47], a[172:175], v[108:111]
buffer_load_dwordx4 v3, s[20:23], s66 offen offset:3072 lds
s_waitcnt lgkmcnt(0)
v_mfma_f32_16x16x32_bf16 v[80:83], v[32:35], a[160:163], v[80:83]
ds_read_b64_tr_b16 v[44:45], v13 offset:1024
v_mfma_f32_16x16x32_bf16 v[80:83], v[36:39], a[176:179], v[80:83]
ds_read_b64_tr_b16 v[46:47], v13 offset:1536
v_mfma_f32_16x16x32_bf16 v[80:83], v[40:43], a[192:195], v[80:83]
ds_read_b64_tr_b16 v[48:49], v13 offset:3072
v_mfma_f32_16x16x32_bf16 v[84:87], v[40:43], a[196:199], v[84:87]
ds_read_b64_tr_b16 v[50:51], v13 offset:3584
v_mfma_f32_16x16x32_bf16 v[84:87], v[36:39], a[180:183], v[84:87]
ds_read_b64_tr_b16 v[52:53], v13 offset:5120
v_mfma_f32_16x16x32_bf16 v[84:87], v[32:35], a[164:167], v[84:87]
ds_read_b64_tr_b16 v[54:55], v13 offset:5632
v_mfma_f32_16x16x32_bf16 v[88:91], v[32:35], a[168:171], v[88:91]
s_add_u32 s66, s64, 2359680
s_add_u32 m0, s65, 53248
v_mfma_f32_16x16x32_bf16 v[88:91], v[36:39], a[184:187], v[88:91]
v_mfma_f32_16x16x32_bf16 v[88:91], v[40:43], a[200:203], v[88:91]
v_mfma_f32_16x16x32_bf16 v[92:95], v[40:43], a[204:207], v[92:95]
v_mfma_f32_16x16x32_bf16 v[92:95], v[36:39], a[188:191], v[92:95]
v_mfma_f32_16x16x32_bf16 v[92:95], v[32:35], a[172:175], v[92:95]
buffer_load_dwordx4 v2, s[16:19], s66 offen offset:0 lds
s_waitcnt lgkmcnt(0)
v_mfma_f32_16x16x32_bf16 v[112:115], v[44:47], a[160:163], v[112:115]
s_waitcnt vmcnt(17)
s_barrier
v_mfma_f32_16x16x32_bf16 v[112:115], v[48:51], a[176:179], v[112:115]
ds_read_b64_tr_b16 v[32:33], v12 offset:24576
v_mfma_f32_16x16x32_bf16 v[112:115], v[52:55], a[192:195], v[112:115]
ds_read_b64_tr_b16 v[34:35], v12 offset:25088
v_mfma_f32_16x16x32_bf16 v[116:119], v[52:55], a[196:199], v[116:119]
ds_read_b64_tr_b16 v[36:37], v12 offset:26624
v_mfma_f32_16x16x32_bf16 v[116:119], v[48:51], a[180:183], v[116:119]
ds_read_b64_tr_b16 v[38:39], v12 offset:27136
v_mfma_f32_16x16x32_bf16 v[116:119], v[44:47], a[164:167], v[116:119]
ds_read_b64_tr_b16 v[40:41], v12 offset:28672
buffer_load_dwordx4 v2, s[20:23], s66 offen offset:1024 lds
v_mfma_f32_16x16x32_bf16 v[120:123], v[44:47], a[168:171], v[120:123]
ds_read_b64_tr_b16 v[42:43], v12 offset:29184
v_mfma_f32_16x16x32_bf16 v[120:123], v[48:51], a[184:187], v[120:123]
v_mfma_f32_16x16x32_bf16 v[120:123], v[52:55], a[200:203], v[120:123]
v_mfma_f32_16x16x32_bf16 v[124:127], v[52:55], a[204:207], v[124:127]
v_mfma_f32_16x16x32_bf16 v[124:127], v[48:51], a[188:191], v[124:127]
v_mfma_f32_16x16x32_bf16 v[124:127], v[44:47], a[172:175], v[124:127]
s_waitcnt lgkmcnt(0)
v_mfma_f32_16x16x32_bf16 v[64:67], v[32:35], a[208:211], v[64:67]
ds_read_b64_tr_b16 v[44:45], v12 offset:25600
buffer_store_dwordx4 v[128:131], v7, s[32:35], s100 offen offset:2048 sc1
v_mfma_f32_16x16x32_bf16 v[64:67], v[36:39], a[224:227], v[64:67]
ds_read_b64_tr_b16 v[46:47], v12 offset:26112
s_add_u32 s100, s100, 4096
v_mfma_f32_16x16x32_bf16 v[64:67], v[40:43], a[240:243], v[64:67]
ds_read_b64_tr_b16 v[48:49], v12 offset:27648
v_mfma_f32_16x16x32_bf16 v[68:71], v[40:43], a[244:247], v[68:71]
ds_read_b64_tr_b16 v[50:51], v12 offset:28160
buffer_store_dwordx4 v[132:135], v7, s[32:35], s101 offen offset:2048 sc1
v_mfma_f32_16x16x32_bf16 v[68:71], v[36:39], a[228:231], v[68:71]
ds_read_b64_tr_b16 v[52:53], v12 offset:29696
v_mfma_f32_16x16x32_bf16 v[68:71], v[32:35], a[212:215], v[68:71]
ds_read_b64_tr_b16 v[54:55], v12 offset:30208
s_add_u32 s101, s101, 4096
v_mfma_f32_16x16x32_bf16 v[72:75], v[32:35], a[216:219], v[72:75]
s_add_u32 s66, s64, 2654592
s_add_u32 m0, s65, 73728
v_mfma_f32_16x16x32_bf16 v[72:75], v[36:39], a[232:235], v[72:75]
buffer_store_dwordx4 v[136:139], v7, s[32:35], s3 offen offset:2048 sc1
buffer_load_dwordx4 v2, s[16:19], s66 offen offset:0 lds
v_mfma_f32_16x16x32_bf16 v[72:75], v[40:43], a[248:251], v[72:75]
v_mfma_f32_16x16x32_bf16 v[76:79], v[40:43], a[252:255], v[76:79]
s_add_u32 s3, s3, 4096
v_mfma_f32_16x16x32_bf16 v[76:79], v[36:39], a[236:239], v[76:79]
v_mfma_f32_16x16x32_bf16 v[76:79], v[32:35], a[220:223], v[76:79]
buffer_store_dwordx4 v[140:143], v7, s[32:35], s15 offen offset:2048 sc1
buffer_load_dwordx4 v2, s[20:23], s66 offen offset:1024 lds
s_waitcnt lgkmcnt(0)
v_mfma_f32_16x16x32_bf16 v[96:99], v[44:47], a[208:211], v[96:99]
ds_read_b64_tr_b16 v[32:33], v13 offset:24576
v_mfma_f32_16x16x32_bf16 v[96:99], v[48:51], a[224:227], v[96:99]
ds_read_b64_tr_b16 v[34:35], v13 offset:25088
s_add_u32 s15, s15, 4096
v_mfma_f32_16x16x32_bf16 v[96:99], v[52:55], a[240:243], v[96:99]
ds_read_b64_tr_b16 v[36:37], v13 offset:26624
v_mfma_f32_16x16x32_bf16 v[100:103], v[52:55], a[244:247], v[100:103]
ds_read_b64_tr_b16 v[38:39], v13 offset:27136
v_mfma_f32_16x16x32_bf16 v[100:103], v[48:51], a[228:231], v[100:103]
ds_read_b64_tr_b16 v[40:41], v13 offset:28672
v_mfma_f32_16x16x32_bf16 v[100:103], v[44:47], a[212:215], v[100:103]
ds_read_b64_tr_b16 v[42:43], v13 offset:29184
buffer_load_dwordx4 v3, s[16:19], s66 offen offset:2048 lds
v_mfma_f32_16x16x32_bf16 v[104:107], v[44:47], a[216:219], v[104:107]
v_mfma_f32_16x16x32_bf16 v[104:107], v[48:51], a[232:235], v[104:107]
v_mfma_f32_16x16x32_bf16 v[104:107], v[52:55], a[248:251], v[104:107]
v_mfma_f32_16x16x32_bf16 v[108:111], v[52:55], a[252:255], v[108:111]
v_mfma_f32_16x16x32_bf16 v[108:111], v[48:51], a[236:239], v[108:111]
v_mfma_f32_16x16x32_bf16 v[108:111], v[44:47], a[220:223], v[108:111]
buffer_load_dwordx4 v3, s[20:23], s66 offen offset:3072 lds
s_waitcnt lgkmcnt(0)
v_mfma_f32_16x16x32_bf16 v[80:83], v[32:35], a[208:211], v[80:83]
ds_read_b64_tr_b16 v[44:45], v13 offset:25600
v_mfma_f32_16x16x32_bf16 v[80:83], v[36:39], a[224:227], v[80:83]
ds_read_b64_tr_b16 v[46:47], v13 offset:26112
v_mfma_f32_16x16x32_bf16 v[80:83], v[40:43], a[240:243], v[80:83]
ds_read_b64_tr_b16 v[48:49], v13 offset:27648
v_mfma_f32_16x16x32_bf16 v[84:87], v[40:43], a[244:247], v[84:87]
ds_read_b64_tr_b16 v[50:51], v13 offset:28160
v_mfma_f32_16x16x32_bf16 v[84:87], v[36:39], a[228:231], v[84:87]
ds_read_b64_tr_b16 v[52:53], v13 offset:29696
v_mfma_f32_16x16x32_bf16 v[84:87], v[32:35], a[212:215], v[84:87]
ds_read_b64_tr_b16 v[54:55], v13 offset:30208
v_mfma_f32_16x16x32_bf16 v[88:91], v[32:35], a[216:219], v[88:91]
s_add_u32 s66, s64, 3244416
s_add_u32 m0, s65, 77824
v_mfma_f32_16x16x32_bf16 v[88:91], v[36:39], a[232:235], v[88:91]
v_mfma_f32_16x16x32_bf16 v[88:91], v[40:43], a[248:251], v[88:91]
v_mfma_f32_16x16x32_bf16 v[92:95], v[40:43], a[252:255], v[92:95]
v_mfma_f32_16x16x32_bf16 v[92:95], v[36:39], a[236:239], v[92:95]
v_mfma_f32_16x16x32_bf16 v[92:95], v[32:35], a[220:223], v[92:95]
buffer_load_dwordx4 v2, s[16:19], s66 offen offset:0 lds
s_waitcnt lgkmcnt(0)
v_mfma_f32_16x16x32_bf16 v[112:115], v[44:47], a[208:211], v[112:115]
s_waitcnt vmcnt(21)
s_barrier
v_mfma_f32_16x16x32_bf16 v[112:115], v[48:51], a[224:227], v[112:115]
ds_read_b64_tr_b16 v[32:33], v8 offset:0
v_mfma_f32_16x16x32_bf16 v[112:115], v[52:55], a[240:243], v[112:115]
ds_read_b64_tr_b16 v[34:35], v8 offset:512
v_mfma_f32_16x16x32_bf16 v[116:119], v[52:55], a[244:247], v[116:119]
ds_read_b64_tr_b16 v[36:37], v8 offset:2048
v_mfma_f32_16x16x32_bf16 v[116:119], v[48:51], a[228:231], v[116:119]
ds_read_b64_tr_b16 v[38:39], v8 offset:2560
v_mfma_f32_16x16x32_bf16 v[116:119], v[44:47], a[212:215], v[116:119]
ds_read_b64_tr_b16 v[40:41], v8 offset:4096
buffer_load_dwordx4 v2, s[20:23], s66 offen offset:1024 lds
v_mfma_f32_16x16x32_bf16 v[120:123], v[44:47], a[216:219], v[120:123]
ds_read_b64_tr_b16 v[42:43], v8 offset:4608
v_mfma_f32_16x16x32_bf16 v[120:123], v[48:51], a[232:235], v[120:123]
v_mfma_f32_16x16x32_bf16 v[120:123], v[52:55], a[248:251], v[120:123]
v_mfma_f32_16x16x32_bf16 v[124:127], v[52:55], a[252:255], v[124:127]
v_mfma_f32_16x16x32_bf16 v[124:127], v[48:51], a[236:239], v[124:127]
v_mfma_f32_16x16x32_bf16 v[124:127], v[44:47], a[220:223], v[124:127]
s_waitcnt lgkmcnt(0)
v_mfma_f32_16x16x32_bf16 v[128:131], v[32:35], v[224:227], 0
ds_read_b64_tr_b16 v[44:45], v8 offset:1024
v_mfma_f32_16x16x32_bf16 v[128:131], v[36:39], v[240:243], v[128:131]
ds_read_b64_tr_b16 v[46:47], v8 offset:1536
v_mfma_f32_16x16x32_bf16 v[128:131], v[40:43], a[0:3], v[128:131]
ds_read_b64_tr_b16 v[48:49], v8 offset:3072
v_mfma_f32_16x16x32_bf16 v[132:135], v[40:43], a[4:7], 0
ds_read_b64_tr_b16 v[50:51], v8 offset:3584
v_mfma_f32_16x16x32_bf16 v[132:135], v[36:39], v[244:247], v[132:135]
ds_read_b64_tr_b16 v[52:53], v8 offset:5120
v_mfma_f32_16x16x32_bf16 v[132:135], v[32:35], v[228:231], v[132:135]
ds_read_b64_tr_b16 v[54:55], v8 offset:5632
v_mfma_f32_16x16x32_bf16 v[136:139], v[32:35], v[232:235], 0
s_add_u32 s66, s64, 3539328
s_add_u32 m0, s65, 98304
v_mfma_f32_16x16x32_bf16 v[136:139], v[36:39], v[248:251], v[136:139]
buffer_load_dwordx4 v2, s[16:19], s66 offen offset:0 lds
v_mfma_f32_16x16x32_bf16 v[136:139], v[40:43], a[8:11], v[136:139]
v_mfma_f32_16x16x32_bf16 v[140:143], v[40:43], a[12:15], 0
v_mfma_f32_16x16x32_bf16 v[140:143], v[36:39], v[252:255], v[140:143]
v_mul_f32 v64, v64, v96
v_mfma_f32_16x16x32_bf16 v[140:143], v[32:35], v[236:239], v[140:143]
buffer_load_dwordx4 v2, s[20:23], s66 offen offset:1024 lds
v_mul_f32 v65, v65, v97
s_waitcnt lgkmcnt(0)
v_mfma_f32_16x16x32_bf16 v[160:163], v[44:47], v[224:227], 0
ds_read_b64_tr_b16 v[32:33], v9 offset:0
v_mfma_f32_16x16x32_bf16 v[160:163], v[48:51], v[240:243], v[160:163]
ds_read_b64_tr_b16 v[34:35], v9 offset:512
v_mul_f32 v66, v66, v98
v_mfma_f32_16x16x32_bf16 v[160:163], v[52:55], a[0:3], v[160:163]
ds_read_b64_tr_b16 v[36:37], v9 offset:2048
v_mul_f32 v67, v67, v99
v_mfma_f32_16x16x32_bf16 v[164:167], v[52:55], a[4:7], 0
ds_read_b64_tr_b16 v[38:39], v9 offset:2560
v_mfma_f32_16x16x32_bf16 v[164:167], v[48:51], v[244:247], v[164:167]
ds_read_b64_tr_b16 v[40:41], v9 offset:4096
v_cvt_pk_bf16_f32 v64, v64, v65
v_mfma_f32_16x16x32_bf16 v[164:167], v[44:47], v[228:231], v[164:167]
ds_read_b64_tr_b16 v[42:43], v9 offset:4608
buffer_load_dwordx4 v3, s[16:19], s66 offen offset:2048 lds
v_mfma_f32_16x16x32_bf16 v[168:171], v[44:47], v[232:235], 0
v_cvt_pk_bf16_f32 v65, v66, v67
v_mfma_f32_16x16x32_bf16 v[168:171], v[48:51], v[248:251], v[168:171]
v_mul_f32 v80, v80, v112
v_mfma_f32_16x16x32_bf16 v[168:171], v[52:55], a[8:11], v[168:171]
v_mfma_f32_16x16x32_bf16 v[172:175], v[52:55], a[12:15], 0
v_mul_f32 v81, v81, v113
v_mfma_f32_16x16x32_bf16 v[172:175], v[48:51], v[252:255], v[172:175]
v_mul_f32 v82, v82, v114
v_mfma_f32_16x16x32_bf16 v[172:175], v[44:47], v[236:239], v[172:175]
buffer_load_dwordx4 v3, s[20:23], s66 offen offset:3072 lds
s_waitcnt lgkmcnt(0)
v_mfma_f32_16x16x32_bf16 v[144:147], v[32:35], v[224:227], 0
ds_read_b64_tr_b16 v[44:45], v9 offset:1024
v_mul_f32 v83, v83, v115
v_mfma_f32_16x16x32_bf16 v[144:147], v[36:39], v[240:243], v[144:147]
ds_read_b64_tr_b16 v[46:47], v9 offset:1536
v_cvt_pk_bf16_f32 v66, v80, v81
v_mfma_f32_16x16x32_bf16 v[144:147], v[40:43], a[0:3], v[144:147]
ds_read_b64_tr_b16 v[48:49], v9 offset:3072
v_mfma_f32_16x16x32_bf16 v[148:151], v[40:43], a[4:7], 0
ds_read_b64_tr_b16 v[50:51], v9 offset:3584
v_cvt_pk_bf16_f32 v67, v82, v83
v_mfma_f32_16x16x32_bf16 v[148:151], v[36:39], v[244:247], v[148:151]
ds_read_b64_tr_b16 v[52:53], v9 offset:5120
v_mfma_f32_16x16x32_bf16 v[148:151], v[32:35], v[228:231], v[148:151]
ds_read_b64_tr_b16 v[54:55], v9 offset:5632
v_mul_f32 v68, v68, v100
v_mfma_f32_16x16x32_bf16 v[152:155], v[32:35], v[232:235], 0
s_add_u32 s66, s64, 4129152
s_add_u32 m0, s65, 102400
v_mfma_f32_16x16x32_bf16 v[152:155], v[36:39], v[248:251], v[152:155]
v_mul_f32 v69, v69, v101
v_mfma_f32_16x16x32_bf16 v[152:155], v[40:43], a[8:11], v[152:155]
v_mul_f32 v70, v70, v102
v_mfma_f32_16x16x32_bf16 v[156:159], v[40:43], a[12:15], 0
v_mul_f32 v71, v71, v103
v_mfma_f32_16x16x32_bf16 v[156:159], v[36:39], v[252:255], v[156:159]
v_mfma_f32_16x16x32_bf16 v[156:159], v[32:35], v[236:239], v[156:159]
buffer_load_dwordx4 v2, s[16:19], s66 offen offset:0 lds
v_cvt_pk_bf16_f32 v68, v68, v69
s_waitcnt lgkmcnt(0)
v_mfma_f32_16x16x32_bf16 v[176:179], v[44:47], v[224:227], 0
s_waitcnt vmcnt(21)
s_barrier
v_mfma_f32_16x16x32_bf16 v[176:179], v[48:51], v[240:243], v[176:179]
ds_read_b64_tr_b16 v[32:33], v8 offset:24576
v_cvt_pk_bf16_f32 v69, v70, v71
v_mfma_f32_16x16x32_bf16 v[176:179], v[52:55], a[0:3], v[176:179]
ds_read_b64_tr_b16 v[34:35], v8 offset:25088
v_mul_f32 v84, v84, v116
v_mfma_f32_16x16x32_bf16 v[180:183], v[52:55], a[4:7], 0
ds_read_b64_tr_b16 v[36:37], v8 offset:26624
v_mfma_f32_16x16x32_bf16 v[180:183], v[48:51], v[244:247], v[180:183]
ds_read_b64_tr_b16 v[38:39], v8 offset:27136
v_mul_f32 v85, v85, v117
v_mfma_f32_16x16x32_bf16 v[180:183], v[44:47], v[228:231], v[180:183]
ds_read_b64_tr_b16 v[40:41], v8 offset:28672
buffer_load_dwordx4 v2, s[20:23], s66 offen offset:1024 lds
v_mfma_f32_16x16x32_bf16 v[184:187], v[44:47], v[232:235], 0
ds_read_b64_tr_b16 v[42:43], v8 offset:29184
v_mul_f32 v86, v86, v118
v_mfma_f32_16x16x32_bf16 v[184:187], v[48:51], v[248:251], v[184:187]
v_mul_f32 v87, v87, v119
v_mfma_f32_16x16x32_bf16 v[184:187], v[52:55], a[8:11], v[184:187]
v_cvt_pk_bf16_f32 v70, v84, v85
v_mfma_f32_16x16x32_bf16 v[188:191], v[52:55], a[12:15], 0
v_mfma_f32_16x16x32_bf16 v[188:191], v[48:51], v[252:255], v[188:191]
v_cvt_pk_bf16_f32 v71, v86, v87
v_mfma_f32_16x16x32_bf16 v[188:191], v[44:47], v[236:239], v[188:191]
s_waitcnt lgkmcnt(0)
v_mfma_f32_16x16x32_bf16 v[128:131], v[32:35], a[16:19], v[128:131]
ds_read_b64_tr_b16 v[44:45], v8 offset:25600
v_mul_f32 v72, v72, v104
v_mfma_f32_16x16x32_bf16 v[128:131], v[36:39], a[32:35], v[128:131]
ds_read_b64_tr_b16 v[46:47], v8 offset:26112
v_mfma_f32_16x16x32_bf16 v[128:131], v[40:43], a[48:51], v[128:131]
ds_read_b64_tr_b16 v[48:49], v8 offset:27648
v_mul_f32 v73, v73, v105
v_mfma_f32_16x16x32_bf16 v[132:135], v[40:43], a[52:55], v[132:135]
ds_read_b64_tr_b16 v[50:51], v8 offset:28160
v_mfma_f32_16x16x32_bf16 v[132:135], v[36:39], a[36:39], v[132:135]
ds_read_b64_tr_b16 v[52:53], v8 offset:29696
v_mul_f32 v74, v74, v106
v_mfma_f32_16x16x32_bf16 v[132:135], v[32:35], a[20:23], v[132:135]
ds_read_b64_tr_b16 v[54:55], v8 offset:30208
v_mfma_f32_16x16x32_bf16 v[136:139], v[32:35], a[24:27], v[136:139]
s_add_u32 s66, s64, 4424064
s_add_u32 m0, s65, 122880
v_mfma_f32_16x16x32_bf16 v[136:139], v[36:39], a[40:43], v[136:139]
buffer_load_dwordx4 v2, s[16:19], s66 offen offset:0 lds
v_mul_f32 v75, v75, v107
v_mfma_f32_16x16x32_bf16 v[136:139], v[40:43], a[56:59], v[136:139]
v_cvt_pk_bf16_f32 v72, v72, v73
v_mfma_f32_16x16x32_bf16 v[140:143], v[40:43], a[60:63], v[140:143]
buffer_load_dwordx4 v2, s[20:23], s66 offen offset:1024 lds
v_mfma_f32_16x16x32_bf16 v[140:143], v[36:39], a[44:47], v[140:143]
v_cvt_pk_bf16_f32 v73, v74, v75
v_mfma_f32_16x16x32_bf16 v[140:143], v[32:35], a[28:31], v[140:143]
s_waitcnt lgkmcnt(0)
v_mfma_f32_16x16x32_bf16 v[160:163], v[44:47], a[16:19], v[160:163]
ds_read_b64_tr_b16 v[32:33], v9 offset:24576
v_mul_f32 v88, v88, v120
v_mfma_f32_16x16x32_bf16 v[160:163], v[48:51], a[32:35], v[160:163]
ds_read_b64_tr_b16 v[34:35], v9 offset:25088
v_mfma_f32_16x16x32_bf16 v[160:163], v[52:55], a[48:51], v[160:163]
ds_read_b64_tr_b16 v[36:37], v9 offset:26624
buffer_load_dwordx4 v3, s[16:19], s66 offen offset:2048 lds
v_mfma_f32_16x16x32_bf16 v[164:167], v[52:55], a[52:55], v[164:167]
ds_read_b64_tr_b16 v[38:39], v9 offset:27136
v_mul_f32 v89, v89, v121
v_mfma_f32_16x16x32_bf16 v[164:167], v[48:51], a[36:39], v[164:167]
ds_read_b64_tr_b16 v[40:41], v9 offset:28672
v_mul_f32 v90, v90, v122
v_mfma_f32_16x16x32_bf16 v[164:167], v[44:47], a[20:23], v[164:167]
ds_read_b64_tr_b16 v[42:43], v9 offset:29184
v_mfma_f32_16x16x32_bf16 v[168:171], v[44:47], a[24:27], v[168:171]
buffer_load_dwordx4 v3, s[20:23], s66 offen offset:3072 lds
v_mul_f32 v91, v91, v123
v_mfma_f32_16x16x32_bf16 v[168:171], v[48:51], a[40:43], v[168:171]
v_mfma_f32_16x16x32_bf16 v[168:171], v[52:55], a[56:59], v[168:171]
v_cvt_pk_bf16_f32 v74, v88, v89
v_mfma_f32_16x16x32_bf16 v[172:175], v[52:55], a[60:63], v[172:175]
v_mfma_f32_16x16x32_bf16 v[172:175], v[48:51], a[44:47], v[172:175]
v_cvt_pk_bf16_f32 v75, v90, v91
v_mfma_f32_16x16x32_bf16 v[172:175], v[44:47], a[28:31], v[172:175]
s_add_u32 s66, s64, 5013888
s_add_u32 m0, s65, 126976
s_waitcnt lgkmcnt(0)
v_mfma_f32_16x16x32_bf16 v[144:147], v[32:35], a[16:19], v[144:147]
ds_read_b64_tr_b16 v[44:45], v9 offset:25600
v_mul_f32 v76, v76, v108
v_mfma_f32_16x16x32_bf16 v[144:147], v[36:39], a[32:35], v[144:147]
ds_read_b64_tr_b16 v[46:47], v9 offset:26112
v_mfma_f32_16x16x32_bf16 v[144:147], v[40:43], a[48:51], v[144:147]
ds_read_b64_tr_b16 v[48:49], v9 offset:27648
v_mul_f32 v77, v77, v109
v_mfma_f32_16x16x32_bf16 v[148:151], v[40:43], a[52:55], v[148:151]
ds_read_b64_tr_b16 v[50:51], v9 offset:28160
v_mfma_f32_16x16x32_bf16 v[148:151], v[36:39], a[36:39], v[148:151]
ds_read_b64_tr_b16 v[52:53], v9 offset:29696
buffer_load_dwordx4 v2, s[16:19], s66 offen offset:0 lds
v_mfma_f32_16x16x32_bf16 v[148:151], v[32:35], a[20:23], v[148:151]
ds_read_b64_tr_b16 v[54:55], v9 offset:30208
v_mul_f32 v78, v78, v110
v_mfma_f32_16x16x32_bf16 v[152:155], v[32:35], a[24:27], v[152:155]
v_mul_f32 v79, v79, v111
v_mfma_f32_16x16x32_bf16 v[152:155], v[36:39], a[40:43], v[152:155]
v_mfma_f32_16x16x32_bf16 v[152:155], v[40:43], a[56:59], v[152:155]
buffer_load_dwordx4 v2, s[20:23], s66 offen offset:1024 lds
v_cvt_pk_bf16_f32 v76, v76, v77
v_mfma_f32_16x16x32_bf16 v[156:159], v[40:43], a[60:63], v[156:159]
STUB_g3:
s_cbranch_execz NEXT_g3
v_mfma_f32_16x16x32_bf16 v[156:159], v[36:39], a[44:47], v[156:159]
v_cvt_pk_bf16_f32 v77, v78, v79
v_mfma_f32_16x16x32_bf16 v[156:159], v[32:35], a[28:31], v[156:159]
s_waitcnt lgkmcnt(0)
v_mfma_f32_16x16x32_bf16 v[176:179], v[44:47], a[16:19], v[176:179]
s_waitcnt vmcnt(17)
s_barrier
v_mfma_f32_16x16x32_bf16 v[176:179], v[48:51], a[32:35], v[176:179]
ds_read_b64_tr_b16 v[32:33], v10 offset:0
buffer_store_dwordx2 v[216:217], v218, s[32:35], s57 offen sc1
v_mfma_f32_16x16x32_bf16 v[176:179], v[52:55], a[48:51], v[176:179]
ds_read_b64_tr_b16 v[34:35], v10 offset:512
v_mov_b32 v26, v216
v_mfma_f32_16x16x32_bf16 v[180:183], v[52:55], a[52:55], v[180:183]
ds_read_b64_tr_b16 v[36:37], v10 offset:2048
v_mul_f32 v92, v92, v124
v_mfma_f32_16x16x32_bf16 v[180:183], v[48:51], a[36:39], v[180:183]
ds_read_b64_tr_b16 v[38:39], v10 offset:2560
v_mul_f32 v93, v93, v125
v_mfma_f32_16x16x32_bf16 v[180:183], v[44:47], a[20:23], v[180:183]
ds_read_b64_tr_b16 v[40:41], v10 offset:4096
v_mul_f32 v94, v94, v126
v_mfma_f32_16x16x32_bf16 v[184:187], v[44:47], a[24:27], v[184:187]
ds_read_b64_tr_b16 v[42:43], v10 offset:4608
v_mov_b32 v27, v217
v_mfma_f32_16x16x32_bf16 v[184:187], v[48:51], a[40:43], v[184:187]
v_mul_f32 v95, v95, v127
v_mfma_f32_16x16x32_bf16 v[184:187], v[52:55], a[56:59], v[184:187]
v_cvt_pk_bf16_f32 v78, v92, v93
v_mfma_f32_16x16x32_bf16 v[188:191], v[52:55], a[60:63], v[188:191]
v_mfma_f32_16x16x32_bf16 v[188:191], v[48:51], a[44:47], v[188:191]
v_cvt_pk_bf16_f32 v79, v94, v95
v_mfma_f32_16x16x32_bf16 v[188:191], v[44:47], a[28:31], v[188:191]
s_waitcnt lgkmcnt(0)
v_mfma_f32_16x16x32_bf16 v[128:131], v[32:35], a[64:67], v[128:131]
ds_read_b64_tr_b16 v[44:45], v10 offset:1024
buffer_store_dwordx4 v[64:67], v7, s[32:35], s100 offen offset:0 sc1
v_mfma_f32_16x16x32_bf16 v[128:131], v[36:39], a[80:83], v[128:131]
ds_read_b64_tr_b16 v[46:47], v10 offset:1536
v_mfma_f32_16x16x32_bf16 v[128:131], v[40:43], a[96:99], v[128:131]
ds_read_b64_tr_b16 v[48:49], v10 offset:3072
v_mfma_f32_16x16x32_bf16 v[132:135], v[40:43], a[100:103], v[132:135]
ds_read_b64_tr_b16 v[50:51], v10 offset:3584
buffer_store_dwordx4 v[68:71], v7, s[32:35], s101 offen offset:0 sc1
v_mfma_f32_16x16x32_bf16 v[132:135], v[36:39], a[84:87], v[132:135]
ds_read_b64_tr_b16 v[52:53], v10 offset:5120
v_mfma_f32_16x16x32_bf16 v[132:135], v[32:35], a[68:71], v[132:135]
ds_read_b64_tr_b16 v[54:55], v10 offset:5632
v_mfma_f32_16x16x32_bf16 v[136:139], v[32:35], a[72:75], v[136:139]
s_add_u32 s66, s63, 0
s_add_u32 m0, s65, 0
v_mfma_f32_16x16x32_bf16 v[136:139], v[36:39], a[88:91], v[136:139]
buffer_store_dwordx4 v[72:75], v7, s[32:35], s3 offen offset:0 sc1
buffer_load_dwordx4 v4, s[16:19], s66 offen offset:0 lds
v_mfma_f32_16x16x32_bf16 v[136:139], v[40:43], a[104:107], v[136:139]
v_mfma_f32_16x16x32_bf16 v[140:143], v[40:43], a[108:111], v[140:143]
v_mfma_f32_16x16x32_bf16 v[140:143], v[36:39], a[92:95], v[140:143]
v_mfma_f32_16x16x32_bf16 v[140:143], v[32:35], a[76:79], v[140:143]
buffer_store_dwordx4 v[76:79], v7, s[32:35], s15 offen offset:0 sc1
buffer_load_dwordx4 v4, s[20:23], s66 offen offset:1024 lds
s_waitcnt lgkmcnt(0)
v_mfma_f32_16x16x32_bf16 v[160:163], v[44:47], a[64:67], v[160:163]
ds_read_b64_tr_b16 v[32:33], v11 offset:0
v_mfma_f32_16x16x32_bf16 v[160:163], v[48:51], a[80:83], v[160:163]
ds_read_b64_tr_b16 v[34:35], v11 offset:512
v_mfma_f32_16x16x32_bf16 v[160:163], v[52:55], a[96:99], v[160:163]
ds_read_b64_tr_b16 v[36:37], v11 offset:2048
v_mfma_f32_16x16x32_bf16 v[164:167], v[52:55], a[100:103], v[164:167]
ds_read_b64_tr_b16 v[38:39], v11 offset:2560
v_mfma_f32_16x16x32_bf16 v[164:167], v[48:51], a[84:87], v[164:167]
ds_read_b64_tr_b16 v[40:41], v11 offset:4096
v_mfma_f32_16x16x32_bf16 v[164:167], v[44:47], a[68:71], v[164:167]
ds_read_b64_tr_b16 v[42:43], v11 offset:4608
buffer_load_dwordx4 v5, s[16:19], s66 offen offset:2048 lds
v_mfma_f32_16x16x32_bf16 v[168:171], v[44:47], a[72:75], v[168:171]
v_mfma_f32_16x16x32_bf16 v[168:171], v[48:51], a[88:91], v[168:171]
v_mfma_f32_16x16x32_bf16 v[168:171], v[52:55], a[104:107], v[168:171]
v_mfma_f32_16x16x32_bf16 v[172:175], v[52:55], a[108:111], v[172:175]
v_mfma_f32_16x16x32_bf16 v[172:175], v[48:51], a[92:95], v[172:175]
v_mfma_f32_16x16x32_bf16 v[172:175], v[44:47], a[76:79], v[172:175]
buffer_load_dwordx4 v5, s[20:23], s66 offen offset:3072 lds
s_waitcnt lgkmcnt(0)
v_mfma_f32_16x16x32_bf16 v[144:147], v[32:35], a[64:67], v[144:147]
ds_read_b64_tr_b16 v[44:45], v11 offset:1024
v_mfma_f32_16x16x32_bf16 v[144:147], v[36:39], a[80:83], v[144:147]
ds_read_b64_tr_b16 v[46:47], v11 offset:1536
v_mfma_f32_16x16x32_bf16 v[144:147], v[40:43], a[96:99], v[144:147]
ds_read_b64_tr_b16 v[48:49], v11 offset:3072
v_mfma_f32_16x16x32_bf16 v[148:151], v[40:43], a[100:103], v[148:151]
ds_read_b64_tr_b16 v[50:51], v11 offset:3584
v_mfma_f32_16x16x32_bf16 v[148:151], v[36:39], a[84:87], v[148:151]
ds_read_b64_tr_b16 v[52:53], v11 offset:5120
v_mfma_f32_16x16x32_bf16 v[148:151], v[32:35], a[68:71], v[148:151]
ds_read_b64_tr_b16 v[54:55], v11 offset:5632
v_mfma_f32_16x16x32_bf16 v[152:155], v[32:35], a[72:75], v[152:155]
s_add_u32 s66, s63, 589824
s_add_u32 m0, s65, 4096
v_mfma_f32_16x16x32_bf16 v[152:155], v[36:39], a[88:91], v[152:155]
v_mfma_f32_16x16x32_bf16 v[152:155], v[40:43], a[104:107], v[152:155]
v_mfma_f32_16x16x32_bf16 v[156:159], v[40:43], a[108:111], v[156:159]
v_mfma_f32_16x16x32_bf16 v[156:159], v[36:39], a[92:95], v[156:159]
v_mfma_f32_16x16x32_bf16 v[156:159], v[32:35], a[76:79], v[156:159]
buffer_load_dwordx4 v4, s[16:19], s66 offen offset:0 lds
s_waitcnt lgkmcnt(0)
v_mfma_f32_16x16x32_bf16 v[176:179], v[44:47], a[64:67], v[176:179]
s_waitcnt vmcnt(22)
s_barrier
v_mfma_f32_16x16x32_bf16 v[176:179], v[48:51], a[80:83], v[176:179]
ds_read_b64_tr_b16 v[32:33], v10 offset:24576
v_mfma_f32_16x16x32_bf16 v[176:179], v[52:55], a[96:99], v[176:179]
ds_read_b64_tr_b16 v[34:35], v10 offset:25088
v_mfma_f32_16x16x32_bf16 v[180:183], v[52:55], a[100:103], v[180:183]
ds_read_b64_tr_b16 v[36:37], v10 offset:26624
v_mfma_f32_16x16x32_bf16 v[180:183], v[48:51], a[84:87], v[180:183]
ds_read_b64_tr_b16 v[38:39], v10 offset:27136
v_mfma_f32_16x16x32_bf16 v[180:183], v[44:47], a[68:71], v[180:183]
ds_read_b64_tr_b16 v[40:41], v10 offset:28672
buffer_load_dwordx4 v4, s[20:23], s66 offen offset:1024 lds
v_mfma_f32_16x16x32_bf16 v[184:187], v[44:47], a[72:75], v[184:187]
ds_read_b64_tr_b16 v[42:43], v10 offset:29184
v_mfma_f32_16x16x32_bf16 v[184:187], v[48:51], a[88:91], v[184:187]
v_mfma_f32_16x16x32_bf16 v[184:187], v[52:55], a[104:107], v[184:187]
v_mfma_f32_16x16x32_bf16 v[188:191], v[52:55], a[108:111], v[188:191]
v_mfma_f32_16x16x32_bf16 v[188:191], v[48:51], a[92:95], v[188:191]
v_mfma_f32_16x16x32_bf16 v[188:191], v[44:47], a[76:79], v[188:191]
s_waitcnt lgkmcnt(0)
v_mfma_f32_16x16x32_bf16 v[128:131], v[32:35], a[112:115], v[128:131]
ds_read_b64_tr_b16 v[44:45], v10 offset:25600
s_max_u32 s58, s2, 112
v_mfma_f32_16x16x32_bf16 v[128:131], v[36:39], a[128:131], v[128:131]
ds_read_b64_tr_b16 v[46:47], v10 offset:26112
v_mfma_f32_16x16x32_bf16 v[128:131], v[40:43], a[144:147], v[128:131]
ds_read_b64_tr_b16 v[48:49], v10 offset:27648
v_mfma_f32_16x16x32_bf16 v[132:135], v[40:43], a[148:151], v[132:135]
ds_read_b64_tr_b16 v[50:51], v10 offset:28160
v_mfma_f32_16x16x32_bf16 v[132:135], v[36:39], a[132:135], v[132:135]
ds_read_b64_tr_b16 v[52:53], v10 offset:29696
v_mfma_f32_16x16x32_bf16 v[132:135], v[32:35], a[116:119], v[132:135]
ds_read_b64_tr_b16 v[54:55], v10 offset:30208
v_mfma_f32_16x16x32_bf16 v[136:139], v[32:35], a[120:123], v[136:139]
s_add_u32 s66, s63, 884736
s_add_u32 m0, s65, 24576
v_mfma_f32_16x16x32_bf16 v[136:139], v[36:39], a[136:139], v[136:139]
s_sub_u32 s58, s58, 112
buffer_load_dwordx4 v4, s[16:19], s66 offen offset:0 lds
v_mfma_f32_16x16x32_bf16 v[136:139], v[40:43], a[152:155], v[136:139]
v_mfma_f32_16x16x32_bf16 v[140:143], v[40:43], a[156:159], v[140:143]
v_mfma_f32_16x16x32_bf16 v[140:143], v[36:39], a[140:143], v[140:143]
v_mfma_f32_16x16x32_bf16 v[140:143], v[32:35], a[124:127], v[140:143]
buffer_load_dwordx4 v4, s[20:23], s66 offen offset:1024 lds
s_waitcnt lgkmcnt(0)
v_mfma_f32_16x16x32_bf16 v[160:163], v[44:47], a[112:115], v[160:163]
ds_read_b64_tr_b16 v[32:33], v11 offset:24576
v_mfma_f32_16x16x32_bf16 v[160:163], v[48:51], a[128:131], v[160:163]
ds_read_b64_tr_b16 v[34:35], v11 offset:25088
v_mfma_f32_16x16x32_bf16 v[160:163], v[52:55], a[144:147], v[160:163]
ds_read_b64_tr_b16 v[36:37], v11 offset:26624
v_mfma_f32_16x16x32_bf16 v[164:167], v[52:55], a[148:151], v[164:167]
ds_read_b64_tr_b16 v[38:39], v11 offset:27136
s_lshr_b32 s58, s58, 4
v_mfma_f32_16x16x32_bf16 v[164:167], v[48:51], a[132:135], v[164:167]
ds_read_b64_tr_b16 v[40:41], v11 offset:28672
v_mfma_f32_16x16x32_bf16 v[164:167], v[44:47], a[116:119], v[164:167]
ds_read_b64_tr_b16 v[42:43], v11 offset:29184
buffer_load_dwordx4 v5, s[16:19], s66 offen offset:2048 lds
v_mfma_f32_16x16x32_bf16 v[168:171], v[44:47], a[120:123], v[168:171]
v_mfma_f32_16x16x32_bf16 v[168:171], v[48:51], a[136:139], v[168:171]
v_mfma_f32_16x16x32_bf16 v[168:171], v[52:55], a[152:155], v[168:171]
v_mfma_f32_16x16x32_bf16 v[172:175], v[52:55], a[156:159], v[172:175]
v_mfma_f32_16x16x32_bf16 v[172:175], v[48:51], a[140:143], v[172:175]
v_mfma_f32_16x16x32_bf16 v[172:175], v[44:47], a[124:127], v[172:175]
s_lshl_b32 s58, s58, 7
buffer_load_dwordx4 v5, s[20:23], s66 offen offset:3072 lds
s_waitcnt lgkmcnt(0)
v_mfma_f32_16x16x32_bf16 v[144:147], v[32:35], a[112:115], v[144:147]
ds_read_b64_tr_b16 v[44:45], v11 offset:25600
v_mfma_f32_16x16x32_bf16 v[144:147], v[36:39], a[128:131], v[144:147]
ds_read_b64_tr_b16 v[46:47], v11 offset:26112
v_mfma_f32_16x16x32_bf16 v[144:147], v[40:43], a[144:147], v[144:147]
ds_read_b64_tr_b16 v[48:49], v11 offset:27648
v_mfma_f32_16x16x32_bf16 v[148:151], v[40:43], a[148:151], v[148:151]
ds_read_b64_tr_b16 v[50:51], v11 offset:28160
v_mfma_f32_16x16x32_bf16 v[148:151], v[36:39], a[132:135], v[148:151]
ds_read_b64_tr_b16 v[52:53], v11 offset:29696
v_mfma_f32_16x16x32_bf16 v[148:151], v[32:35], a[116:119], v[148:151]
ds_read_b64_tr_b16 v[54:55], v11 offset:30208
v_mfma_f32_16x16x32_bf16 v[152:155], v[32:35], a[120:123], v[152:155]
s_add_u32 s44, s58, 62914560
v_mfma_f32_16x16x32_bf16 v[152:155], v[36:39], a[136:139], v[152:155]
s_add_u32 s66, s63, 1474560
s_add_u32 m0, s65, 28672
v_mfma_f32_16x16x32_bf16 v[152:155], v[40:43], a[152:155], v[152:155]
v_mfma_f32_16x16x32_bf16 v[156:159], v[40:43], a[156:159], v[156:159]
v_mfma_f32_16x16x32_bf16 v[156:159], v[36:39], a[140:143], v[156:159]
v_mfma_f32_16x16x32_bf16 v[156:159], v[32:35], a[124:127], v[156:159]
buffer_load_dwordx4 v4, s[16:19], s66 offen offset:0 lds
s_waitcnt lgkmcnt(0)
v_mfma_f32_16x16x32_bf16 v[176:179], v[44:47], a[112:115], v[176:179]
s_waitcnt vmcnt(22)
s_barrier
v_mfma_f32_16x16x32_bf16 v[176:179], v[48:51], a[128:131], v[176:179]
ds_read_b64_tr_b16 v[32:33], v12 offset:0
v_mfma_f32_16x16x32_bf16 v[176:179], v[52:55], a[144:147], v[176:179]
ds_read_b64_tr_b16 v[34:35], v12 offset:512
buffer_load_dwordx2 v[210:211], v18, s[32:35], s44 offen sc1
v_mfma_f32_16x16x32_bf16 v[180:183], v[52:55], a[148:151], v[180:183]
ds_read_b64_tr_b16 v[36:37], v12 offset:2048
v_mfma_f32_16x16x32_bf16 v[180:183], v[48:51], a[132:135], v[180:183]
ds_read_b64_tr_b16 v[38:39], v12 offset:2560
v_mfma_f32_16x16x32_bf16 v[180:183], v[44:47], a[116:119], v[180:183]
ds_read_b64_tr_b16 v[40:41], v12 offset:4096
buffer_load_dwordx4 v4, s[20:23], s66 offen offset:1024 lds
v_mfma_f32_16x16x32_bf16 v[184:187], v[44:47], a[120:123], v[184:187]
ds_read_b64_tr_b16 v[42:43], v12 offset:4608
v_mfma_f32_16x16x32_bf16 v[184:187], v[48:51], a[136:139], v[184:187]
v_mfma_f32_16x16x32_bf16 v[184:187], v[52:55], a[152:155], v[184:187]
v_mfma_f32_16x16x32_bf16 v[188:191], v[52:55], a[156:159], v[188:191]
v_mfma_f32_16x16x32_bf16 v[188:191], v[48:51], a[140:143], v[188:191]
v_mfma_f32_16x16x32_bf16 v[188:191], v[44:47], a[124:127], v[188:191]
s_waitcnt lgkmcnt(0)
v_mfma_f32_16x16x32_bf16 v[128:131], v[32:35], a[160:163], v[128:131]
ds_read_b64_tr_b16 v[44:45], v12 offset:1024
buffer_load_dwordx2 v[2:3], v19, s[32:35], s56 offen sc1
v_mfma_f32_16x16x32_bf16 v[128:131], v[36:39], a[176:179], v[128:131]
ds_read_b64_tr_b16 v[46:47], v12 offset:1536
v_mfma_f32_16x16x32_bf16 v[128:131], v[40:43], a[192:195], v[128:131]
ds_read_b64_tr_b16 v[48:49], v12 offset:3072
v_mfma_f32_16x16x32_bf16 v[132:135], v[40:43], a[196:199], v[132:135]
ds_read_b64_tr_b16 v[50:51], v12 offset:3584
v_mfma_f32_16x16x32_bf16 v[132:135], v[36:39], a[180:183], v[132:135]
ds_read_b64_tr_b16 v[52:53], v12 offset:5120
v_mfma_f32_16x16x32_bf16 v[132:135], v[32:35], a[164:167], v[132:135]
ds_read_b64_tr_b16 v[54:55], v12 offset:5632
v_mfma_f32_16x16x32_bf16 v[136:139], v[32:35], a[168:171], v[136:139]
s_add_u32 s66, s63, 1769472
s_add_u32 m0, s65, 49152
v_mfma_f32_16x16x32_bf16 v[136:139], v[36:39], a[184:187], v[136:139]
buffer_load_dwordx4 v4, s[16:19], s66 offen offset:0 lds
v_mfma_f32_16x16x32_bf16 v[136:139], v[40:43], a[200:203], v[136:139]
v_mfma_f32_16x16x32_bf16 v[140:143], v[40:43], a[204:207], v[140:143]
v_mfma_f32_16x16x32_bf16 v[140:143], v[36:39], a[188:191], v[140:143]
v_mfma_f32_16x16x32_bf16 v[140:143], v[32:35], a[172:175], v[140:143]
buffer_load_dwordx4 v4, s[20:23], s66 offen offset:1024 lds
s_waitcnt lgkmcnt(0)
v_mfma_f32_16x16x32_bf16 v[160:163], v[44:47], a[160:163], v[160:163]
ds_read_b64_tr_b16 v[32:33], v13 offset:0
v_mfma_f32_16x16x32_bf16 v[160:163], v[48:51], a[176:179], v[160:163]
ds_read_b64_tr_b16 v[34:35], v13 offset:512
v_mfma_f32_16x16x32_bf16 v[160:163], v[52:55], a[192:195], v[160:163]
ds_read_b64_tr_b16 v[36:37], v13 offset:2048
v_mfma_f32_16x16x32_bf16 v[164:167], v[52:55], a[196:199], v[164:167]
ds_read_b64_tr_b16 v[38:39], v13 offset:2560
v_mfma_f32_16x16x32_bf16 v[164:167], v[48:51], a[180:183], v[164:167]
ds_read_b64_tr_b16 v[40:41], v13 offset:4096
v_mfma_f32_16x16x32_bf16 v[164:167], v[44:47], a[164:167], v[164:167]
ds_read_b64_tr_b16 v[42:43], v13 offset:4608
buffer_load_dwordx4 v5, s[16:19], s66 offen offset:2048 lds
v_mfma_f32_16x16x32_bf16 v[168:171], v[44:47], a[168:171], v[168:171]
v_mfma_f32_16x16x32_bf16 v[168:171], v[48:51], a[184:187], v[168:171]
v_mfma_f32_16x16x32_bf16 v[168:171], v[52:55], a[200:203], v[168:171]
v_mfma_f32_16x16x32_bf16 v[172:175], v[52:55], a[204:207], v[172:175]
v_mfma_f32_16x16x32_bf16 v[172:175], v[48:51], a[188:191], v[172:175]
v_mfma_f32_16x16x32_bf16 v[172:175], v[44:47], a[172:175], v[172:175]
buffer_load_dwordx4 v5, s[20:23], s66 offen offset:3072 lds
s_waitcnt lgkmcnt(0)
v_mfma_f32_16x16x32_bf16 v[144:147], v[32:35], a[160:163], v[144:147]
ds_read_b64_tr_b16 v[44:45], v13 offset:1024
v_mfma_f32_16x16x32_bf16 v[144:147], v[36:39], a[176:179], v[144:147]
ds_read_b64_tr_b16 v[46:47], v13 offset:1536
v_mfma_f32_16x16x32_bf16 v[144:147], v[40:43], a[192:195], v[144:147]
ds_read_b64_tr_b16 v[48:49], v13 offset:3072
v_mfma_f32_16x16x32_bf16 v[148:151], v[40:43], a[196:199], v[148:151]
ds_read_b64_tr_b16 v[50:51], v13 offset:3584
v_mfma_f32_16x16x32_bf16 v[148:151], v[36:39], a[180:183], v[148:151]
ds_read_b64_tr_b16 v[52:53], v13 offset:5120
v_mfma_f32_16x16x32_bf16 v[148:151], v[32:35], a[164:167], v[148:151]
ds_read_b64_tr_b16 v[54:55], v13 offset:5632
v_mfma_f32_16x16x32_bf16 v[152:155], v[32:35], a[168:171], v[152:155]
s_add_u32 s66, s63, 2359296
s_add_u32 m0, s65, 53248
v_mfma_f32_16x16x32_bf16 v[152:155], v[36:39], a[184:187], v[152:155]
v_mfma_f32_16x16x32_bf16 v[152:155], v[40:43], a[200:203], v[152:155]
v_mfma_f32_16x16x32_bf16 v[156:159], v[40:43], a[204:207], v[156:159]
v_mfma_f32_16x16x32_bf16 v[156:159], v[36:39], a[188:191], v[156:159]
v_mfma_f32_16x16x32_bf16 v[156:159], v[32:35], a[172:175], v[156:159]
buffer_load_dwordx4 v4, s[16:19], s66 offen offset:0 lds
s_waitcnt lgkmcnt(0)
v_mfma_f32_16x16x32_bf16 v[176:179], v[44:47], a[160:163], v[176:179]
s_waitcnt vmcnt(18)
s_barrier
v_mfma_f32_16x16x32_bf16 v[176:179], v[48:51], a[176:179], v[176:179]
ds_read_b64_tr_b16 v[32:33], v12 offset:24576
v_mfma_f32_16x16x32_bf16 v[176:179], v[52:55], a[192:195], v[176:179]
ds_read_b64_tr_b16 v[34:35], v12 offset:25088
v_mfma_f32_16x16x32_bf16 v[180:183], v[52:55], a[196:199], v[180:183]
ds_read_b64_tr_b16 v[36:37], v12 offset:26624
v_mfma_f32_16x16x32_bf16 v[180:183], v[48:51], a[180:183], v[180:183]
ds_read_b64_tr_b16 v[38:39], v12 offset:27136
v_mfma_f32_16x16x32_bf16 v[180:183], v[44:47], a[164:167], v[180:183]
ds_read_b64_tr_b16 v[40:41], v12 offset:28672
buffer_load_dwordx4 v4, s[20:23], s66 offen offset:1024 lds
v_mfma_f32_16x16x32_bf16 v[184:187], v[44:47], a[168:171], v[184:187]
ds_read_b64_tr_b16 v[42:43], v12 offset:29184
v_mfma_f32_16x16x32_bf16 v[184:187], v[48:51], a[184:187], v[184:187]
s_add_u32 s98, s57, 0x4000
buffer_store_dwordx2 v[216:217], v218, s[32:35], s98 offen sc1
v_mfma_f32_16x16x32_bf16 v[184:187], v[52:55], a[200:203], v[184:187]
v_mfma_f32_16x16x32_bf16 v[188:191], v[52:55], a[204:207], v[188:191]
v_mfma_f32_16x16x32_bf16 v[188:191], v[48:51], a[188:191], v[188:191]
v_mfma_f32_16x16x32_bf16 v[188:191], v[44:47], a[172:175], v[188:191]
s_waitcnt lgkmcnt(0)
v_mfma_f32_16x16x32_bf16 v[128:131], v[32:35], a[208:211], v[128:131]
ds_read_b64_tr_b16 v[44:45], v12 offset:25600
s_max_u32 s58, s2, 112
v_mfma_f32_16x16x32_bf16 v[128:131], v[36:39], a[224:227], v[128:131]
ds_read_b64_tr_b16 v[46:47], v12 offset:26112
s_mov_b32 s16, s86
v_mfma_f32_16x16x32_bf16 v[128:131], v[40:43], a[240:243], v[128:131]
ds_read_b64_tr_b16 v[48:49], v12 offset:27648
v_mfma_f32_16x16x32_bf16 v[132:135], v[40:43], a[244:247], v[132:135]
ds_read_b64_tr_b16 v[50:51], v12 offset:28160
s_sub_u32 s58, s58, 112
v_mfma_f32_16x16x32_bf16 v[132:135], v[36:39], a[228:231], v[132:135]
ds_read_b64_tr_b16 v[52:53], v12 offset:29696
s_mov_b32 s17, s87
v_mfma_f32_16x16x32_bf16 v[132:135], v[32:35], a[212:215], v[132:135]
ds_read_b64_tr_b16 v[54:55], v12 offset:30208
v_mfma_f32_16x16x32_bf16 v[136:139], v[32:35], a[216:219], v[136:139]
s_lshl_b32 s58, s58, 2
v_mfma_f32_16x16x32_bf16 v[136:139], v[36:39], a[232:235], v[136:139]
v_mfma_f32_16x16x32_bf16 v[136:139], v[40:43], a[248:251], v[136:139]
v_mfma_f32_16x16x32_bf16 v[140:143], v[40:43], a[252:255], v[140:143]
s_add_u32 s58, s58, s14
s_mul_i32 s64, s41, 1152
v_mfma_f32_16x16x32_bf16 v[140:143], v[36:39], a[236:239], v[140:143]
v_mfma_f32_16x16x32_bf16 v[140:143], v[32:35], a[220:223], v[140:143]
s_waitcnt lgkmcnt(0)
v_mfma_f32_16x16x32_bf16 v[160:163], v[44:47], a[208:211], v[160:163]
ds_read_b64_tr_b16 v[32:33], v13 offset:24576
s_lshl_b32 s49, s58, 12
v_mfma_f32_16x16x32_bf16 v[160:163], v[48:51], a[224:227], v[160:163]
ds_read_b64_tr_b16 v[34:35], v13 offset:25088
v_mfma_f32_16x16x32_bf16 v[160:163], v[52:55], a[240:243], v[160:163]
ds_read_b64_tr_b16 v[36:37], v13 offset:26624
s_mul_i32 s63, s47, 576
v_mfma_f32_16x16x32_bf16 v[164:167], v[52:55], a[244:247], v[164:167]
ds_read_b64_tr_b16 v[38:39], v13 offset:27136
s_lshl_b32 s60, s58, 1
v_mfma_f32_16x16x32_bf16 v[164:167], v[48:51], a[228:231], v[164:167]
ds_read_b64_tr_b16 v[40:41], v13 offset:28672
v_mfma_f32_16x16x32_bf16 v[164:167], v[44:47], a[212:215], v[164:167]
ds_read_b64_tr_b16 v[42:43], v13 offset:29184
v_mfma_f32_16x16x32_bf16 v[168:171], v[44:47], a[216:219], v[168:171]
s_add_u32 s28, s76, s49
s_addc_u32 s29, s77, 0
v_mfma_f32_16x16x32_bf16 v[168:171], v[48:51], a[232:235], v[168:171]
s_add_u32 s64, s64, s63
v_mfma_f32_16x16x32_bf16 v[168:171], v[52:55], a[248:251], v[168:171]
v_mfma_f32_16x16x32_bf16 v[172:175], v[52:55], a[252:255], v[172:175]
s_mov_b32 s30, 4096
v_mfma_f32_16x16x32_bf16 v[172:175], v[48:51], a[236:239], v[172:175]
v_mfma_f32_16x16x32_bf16 v[172:175], v[44:47], a[220:223], v[172:175]
s_mul_i32 s64, s64, 1152
s_waitcnt lgkmcnt(0)
v_mfma_f32_16x16x32_bf16 v[144:147], v[32:35], a[208:211], v[144:147]
ds_read_b64_tr_b16 v[44:45], v13 offset:25600
s_mov_b32 s31, 0x20000
v_mfma_f32_16x16x32_bf16 v[144:147], v[36:39], a[224:227], v[144:147]
ds_read_b64_tr_b16 v[46:47], v13 offset:26112
v_mfma_f32_16x16x32_bf16 v[144:147], v[40:43], a[240:243], v[144:147]
ds_read_b64_tr_b16 v[48:49], v13 offset:27648
v_mfma_f32_16x16x32_bf16 v[148:151], v[40:43], a[244:247], v[148:151]
ds_read_b64_tr_b16 v[50:51], v13 offset:28160
s_mul_i32 s45, s14, 4160
v_mfma_f32_16x16x32_bf16 v[148:151], v[36:39], a[228:231], v[148:151]
ds_read_b64_tr_b16 v[52:53], v13 offset:29696
s_mul_i32 s63, s42, 288
v_mfma_f32_16x16x32_bf16 v[148:151], v[32:35], a[212:215], v[148:151]
ds_read_b64_tr_b16 v[54:55], v13 offset:30208
v_mfma_f32_16x16x32_bf16 v[152:155], v[32:35], a[216:219], v[152:155]
s_add_u32 s67, s62, 0
s_add_u32 m0, s45, 73792
v_mfma_f32_16x16x32_bf16 v[152:155], v[36:39], a[232:235], v[152:155]
v_mfma_f32_16x16x32_bf16 v[152:155], v[40:43], a[248:251], v[152:155]
s_add_u32 s64, s64, s63
v_mfma_f32_16x16x32_bf16 v[156:159], v[40:43], a[252:255], v[156:159]
buffer_load_dwordx4 v7, s[28:31], s67 offen offset:0  lds
v_mfma_f32_16x16x32_bf16 v[156:159], v[36:39], a[236:239], v[156:159]
v_mfma_f32_16x16x32_bf16 v[156:159], v[32:35], a[220:223], v[156:159]
s_waitcnt lgkmcnt(0)
v_mfma_f32_16x16x32_bf16 v[176:179], v[44:47], a[208:211], v[176:179]
s_waitcnt vmcnt(8)
s_barrier
v_mfma_f32_16x16x32_bf16 v[176:179], v[48:51], a[224:227], v[176:179]
ds_read_b64_tr_b16 v[32:33], v220 offset:0
buffer_load_dwordx4 v7, s[28:31], s67 offen offset:1024  lds
v_mfma_f32_16x16x32_bf16 v[176:179], v[52:55], a[240:243], v[176:179]
ds_read_b64_tr_b16 v[34:35], v220 offset:512
s_mul_i32 s65, s14, 9216
v_mfma_f32_16x16x32_bf16 v[180:183], v[52:55], a[244:247], v[180:183]
ds_read_b64_tr_b16 v[36:37], v220 offset:2048
buffer_load_dwordx4 v7, s[28:31], s67 offen offset:2048  lds
v_mfma_f32_16x16x32_bf16 v[180:183], v[48:51], a[228:231], v[180:183]
ds_read_b64_tr_b16 v[38:39], v220 offset:2560
v_mfma_f32_16x16x32_bf16 v[180:183], v[44:47], a[212:215], v[180:183]
ds_read_b64_tr_b16 v[40:41], v220 offset:4096
v_mfma_f32_16x16x32_bf16 v[184:187], v[44:47], a[216:219], v[184:187]
ds_read_b64_tr_b16 v[42:43], v220 offset:4608
buffer_load_dwordx4 v7, s[28:31], s67 offen offset:3072  lds
v_mfma_f32_16x16x32_bf16 v[184:187], v[48:51], a[232:235], v[184:187]
v_cmp_ne_u64 vcc, s[94:95], v[2:3]
s_nop 1
s_cmp_lg_u64 vcc, 0
s_cbranch_scc1 SLOW_F3A
BACK_F3A:
v_mfma_f32_16x16x32_bf16 v[184:187], v[52:55], a[248:251], v[184:187]
buffer_load_dword v213, v16, s[32:35], s48 offen sc1
s_mul_i32 s63, s46, 36864
v_mfma_f32_16x16x32_bf16 v[188:191], v[52:55], a[252:255], v[188:191]
v_mfma_f32_16x16x32_bf16 v[188:191], v[48:51], a[236:239], v[188:191]
v_mfma_f32_16x16x32_bf16 v[188:191], v[44:47], a[220:223], v[188:191]
s_waitcnt lgkmcnt(0)
v_mfma_f32_16x16x32_bf16 v[64:67], v[32:35], v[224:227], 0
ds_read_b64_tr_b16 v[44:45], v220 offset:1024
v_mfma_f32_16x16x32_bf16 v[64:67], v[36:39], v[240:243], v[64:67]
ds_read_b64_tr_b16 v[46:47], v220 offset:1536
v_mfma_f32_16x16x32_bf16 v[64:67], v[40:43], a[0:3], v[64:67]
ds_read_b64_tr_b16 v[48:49], v220 offset:3072
v_mfma_f32_16x16x32_bf16 v[68:71], v[40:43], a[4:7], 0
ds_read_b64_tr_b16 v[50:51], v220 offset:3584
v_mfma_f32_16x16x32_bf16 v[68:71], v[36:39], v[244:247], v[68:71]
ds_read_b64_tr_b16 v[52:53], v220 offset:5120
v_mfma_f32_16x16x32_bf16 v[68:71], v[32:35], v[228:231], v[68:71]
ds_read_b64_tr_b16 v[54:55], v220 offset:5632
v_mfma_f32_16x16x32_bf16 v[72:75], v[32:35], v[232:235], 0
s_add_u32 s67, s62, 4
s_add_u32 m0, s45, 90560
v_mfma_f32_16x16x32_bf16 v[72:75], v[36:39], v[248:251], v[72:75]
buffer_load_dwordx4 v7, s[28:31], s67 offen offset:0  lds
buffer_load_dwordx4 v7, s[28:31], s67 offen offset:1024  lds
v_mfma_f32_16x16x32_bf16 v[72:75], v[40:43], a[8:11], v[72:75]
v_mfma_f32_16x16x32_bf16 v[76:79], v[40:43], a[12:15], 0
buffer_load_dwordx4 v7, s[28:31], s67 offen offset:2048  lds
v_mfma_f32_16x16x32_bf16 v[76:79], v[36:39], v[252:255], v[76:79]
v_mul_f32 v128, v128, v160
v_mfma_f32_16x16x32_bf16 v[76:79], v[32:35], v[236:239], v[76:79]
v_mul_f32 v129, v129, v161
s_waitcnt lgkmcnt(0)
v_mfma_f32_16x16x32_bf16 v[80:83], v[44:47], v[224:227], 0
ds_read_b64_tr_b16 v[32:33], v221 offset:0
buffer_load_dwordx4 v7, s[28:31], s67 offen offset:3072  lds
v_mfma_f32_16x16x32_bf16 v[80:83], v[48:51], v[240:243], v[80:83]
ds_read_b64_tr_b16 v[34:35], v221 offset:512
v_mul_f32 v130, v130, v162
v_mfma_f32_16x16x32_bf16 v[80:83], v[52:55], a[0:3], v[80:83]
ds_read_b64_tr_b16 v[36:37], v221 offset:2048
v_mul_f32 v131, v131, v163
v_mfma_f32_16x16x32_bf16 v[84:87], v[52:55], a[4:7], 0
ds_read_b64_tr_b16 v[38:39], v221 offset:2560
v_and_b32 v56, 31, v1
v_mfma_f32_16x16x32_bf16 v[84:87], v[48:51], v[244:247], v[84:87]
ds_read_b64_tr_b16 v[40:41], v221 offset:4096
v_cvt_pk_bf16_f32 v128, v128, v129
v_mfma_f32_16x16x32_bf16 v[84:87], v[44:47], v[228:231], v[84:87]
ds_read_b64_tr_b16 v[42:43], v221 offset:4608
v_cvt_pk_bf16_f32 v129, v130, v131
v_mfma_f32_16x16x32_bf16 v[88:91], v[44:47], v[232:235], 0
v_lshrrev_b32 v57, 5, v1
v_mfma_f32_16x16x32_bf16 v[88:91], v[48:51], v[248:251], v[88:91]
v_mul_f32 v144, v144, v176
v_mfma_f32_16x16x32_bf16 v[88:91], v[52:55], a[8:11], v[88:91]
v_mfma_f32_16x16x32_bf16 v[92:95], v[52:55], a[12:15], 0
v_lshl_add_u32 v56, v57, 1, v56
v_mul_f32 v145, v145, v177
v_mfma_f32_16x16x32_bf16 v[92:95], v[48:51], v[252:255], v[92:95]
v_mul_f32 v146, v146, v178
v_mfma_f32_16x16x32_bf16 v[92:95], v[44:47], v[236:239], v[92:95]
s_waitcnt lgkmcnt(0)
v_mfma_f32_16x16x32_bf16 v[64:67], v[32:35], a[112:115], v[64:67]
ds_read_b64_tr_b16 v[44:45], v221 offset:1024
v_subrev_u32 v56, 32, v56
v_mfma_f32_16x16x32_bf16 v[64:67], v[36:39], a[128:131], v[64:67]
ds_read_b64_tr_b16 v[46:47], v221 offset:1536
v_mul_f32 v147, v147, v179
v_mfma_f32_16x16x32_bf16 v[64:67], v[40:43], a[144:147], v[64:67]
ds_read_b64_tr_b16 v[48:49], v221 offset:3072
v_cvt_pk_bf16_f32 v130, v144, v145
v_mfma_f32_16x16x32_bf16 v[68:71], v[40:43], a[148:151], v[68:71]
ds_read_b64_tr_b16 v[50:51], v221 offset:3584
v_lshlrev_b32 v56, 1, v56
v_mfma_f32_16x16x32_bf16 v[68:71], v[36:39], a[132:135], v[68:71]
ds_read_b64_tr_b16 v[52:53], v221 offset:5120
v_cvt_pk_bf16_f32 v131, v146, v147
v_mfma_f32_16x16x32_bf16 v[68:71], v[32:35], a[116:119], v[68:71]
ds_read_b64_tr_b16 v[54:55], v221 offset:5632
v_mul_f32 v132, v132, v164
v_mfma_f32_16x16x32_bf16 v[72:75], v[32:35], a[120:123], v[72:75]
buffer_load_ushort v4, v56, s[28:31], 0 offen
v_mul_f32 v133, v133, v165
v_mfma_f32_16x16x32_bf16 v[72:75], v[36:39], a[136:139], v[72:75]
v_mfma_f32_16x16x32_bf16 v[72:75], v[40:43], a[152:155], v[72:75]
v_mul_f32 v134, v134, v166
v_mfma_f32_16x16x32_bf16 v[76:79], v[40:43], a[156:159], v[76:79]
v_mul_f32 v135, v135, v167
v_mfma_f32_16x16x32_bf16 v[76:79], v[36:39], a[140:143], v[76:79]
v_mfma_f32_16x16x32_bf16 v[76:79], v[32:35], a[124:127], v[76:79]
v_cvt_pk_bf16_f32 v132, v132, v133
s_waitcnt lgkmcnt(0)
v_mfma_f32_16x16x32_bf16 v[80:83], v[44:47], a[112:115], v[80:83]
s_waitcnt vmcnt(18)
s_barrier
v_mfma_f32_16x16x32_bf16 v[80:83], v[48:51], a[128:131], v[80:83]
ds_read_b64_tr_b16 v[32:33], v220 offset:24576
v_cvt_pk_bf16_f32 v133, v134, v135
v_mfma_f32_16x16x32_bf16 v[80:83], v[52:55], a[144:147], v[80:83]
ds_read_b64_tr_b16 v[34:35], v220 offset:25088
v_mul_f32 v148, v148, v180
v_mfma_f32_16x16x32_bf16 v[84:87], v[52:55], a[148:151], v[84:87]
ds_read_b64_tr_b16 v[36:37], v220 offset:26624
v_mfma_f32_16x16x32_bf16 v[84:87], v[48:51], a[132:135], v[84:87]
ds_read_b64_tr_b16 v[38:39], v220 offset:27136
v_mul_f32 v149, v149, v181
v_mfma_f32_16x16x32_bf16 v[84:87], v[44:47], a[116:119], v[84:87]
ds_read_b64_tr_b16 v[40:41], v220 offset:28672
v_mul_f32 v150, v150, v182
v_mfma_f32_16x16x32_bf16 v[88:91], v[44:47], a[120:123], v[88:91]
ds_read_b64_tr_b16 v[42:43], v220 offset:29184
v_mfma_f32_16x16x32_bf16 v[88:91], v[48:51], a[136:139], v[88:91]
s_cmp_lt_u32 s2, 112
s_cbranch_scc1 BACK_F2
v_cmp_ne_u64 vcc, s[94:95], v[210:211]
s_nop 1
s_cmp_lg_u64 vcc, 0
s_cbranch_scc1 SLOW_F2
BACK_F2:
v_mfma_f32_16x16x32_bf16 v[88:91], v[52:55], a[152:155], v[88:91]
v_mul_f32 v151, v151, v183
v_cvt_pk_bf16_f32 v134, v148, v149
v_mfma_f32_16x16x32_bf16 v[92:95], v[52:55], a[156:159], v[92:95]
v_mfma_f32_16x16x32_bf16 v[92:95], v[48:51], a[140:143], v[92:95]
v_cvt_pk_bf16_f32 v135, v150, v151
v_mfma_f32_16x16x32_bf16 v[92:95], v[44:47], a[124:127], v[92:95]
s_waitcnt lgkmcnt(0)
v_mfma_f32_16x16x32_bf16 v[64:67], v[32:35], a[16:19], v[64:67]
ds_read_b64_tr_b16 v[44:45], v220 offset:25600
buffer_load_dwordx4 v[224:227], v7, s[32:35], s52 offen offset:0 sc1
v_mfma_f32_16x16x32_bf16 v[64:67], v[36:39], a[32:35], v[64:67]
ds_read_b64_tr_b16 v[46:47], v220 offset:26112
v_mul_f32 v136, v136, v168
v_mfma_f32_16x16x32_bf16 v[64:67], v[40:43], a[48:51], v[64:67]
ds_read_b64_tr_b16 v[48:49], v220 offset:27648
v_mul_f32 v137, v137, v169
v_mfma_f32_16x16x32_bf16 v[68:71], v[40:43], a[52:55], v[68:71]
ds_read_b64_tr_b16 v[50:51], v220 offset:28160
v_mfma_f32_16x16x32_bf16 v[68:71], v[36:39], a[36:39], v[68:71]
ds_read_b64_tr_b16 v[52:53], v220 offset:29696
v_mul_f32 v138, v138, v170
v_mfma_f32_16x16x32_bf16 v[68:71], v[32:35], a[20:23], v[68:71]
STUB_g4:
s_cbranch_execz NEXT_g4
ds_read_b64_tr_b16 v[54:55], v220 offset:30208
v_mfma_f32_16x16x32_bf16 v[72:75], v[32:35], a[24:27], v[72:75]
s_add_u32 s67, s49, 4194304
s_add_u32 s67, s67, s62
s_mul_i32 s58, s14, 9280
s_add_u32 m0, s58, 107264
v_mfma_f32_16x16x32_bf16 v[72:75], v[36:39], a[40:43], v[72:75]
buffer_load_dwordx4 v7, s[32:35], s67 offen offset:0 sc1 lds
buffer_load_dwordx4 v[228:231], v7, s[32:35], s53 offen offset:0 sc1
v_mfma_f32_16x16x32_bf16 v[72:75], v[40:43], a[56:59], v[72:75]
buffer_load_dwordx4 v7, s[32:35], s67 offen offset:1024 sc1 lds
v_mul_f32 v139, v139, v171
v_mfma_f32_16x16x32_bf16 v[76:79], v[40:43], a[60:63], v[76:79]
v_cvt_pk_bf16_f32 v136, v136, v137
v_mfma_f32_16x16x32_bf16 v[76:79], v[36:39], a[44:47], v[76:79]
v_cvt_pk_bf16_f32 v137, v138, v139
v_mfma_f32_16x16x32_bf16 v[76:79], v[32:35], a[28:31], v[76:79]
s_waitcnt lgkmcnt(0)
v_mfma_f32_16x16x32_bf16 v[80:83], v[44:47], a[16:19], v[80:83]
ds_read_b64_tr_b16 v[32:33], v221 offset:24576
buffer_load_dwordx4 v7, s[32:35], s67 offen offset:2048 sc1 lds
v_mfma_f32_16x16x32_bf16 v[80:83], v[48:51], a[32:35], v[80:83]
ds_read_b64_tr_b16 v[34:35], v221 offset:25088
v_mul_f32 v152, v152, v184
v_mfma_f32_16x16x32_bf16 v[80:83], v[52:55], a[48:51], v[80:83]
ds_read_b64_tr_b16 v[36:37], v221 offset:26624
v_mul_f32 v153, v153, v185
v_mfma_f32_16x16x32_bf16 v[84:87], v[52:55], a[52:55], v[84:87]
ds_read_b64_tr_b16 v[38:39], v221 offset:27136
buffer_load_dwordx4 v[232:235], v7, s[32:35], s54 offen offset:0 sc1
v_mfma_f32_16x16x32_bf16 v[84:87], v[48:51], a[36:39], v[84:87]
ds_read_b64_tr_b16 v[40:41], v221 offset:28672
v_mul_f32 v154, v154, v186
v_mfma_f32_16x16x32_bf16 v[84:87], v[44:47], a[20:23], v[84:87]
ds_read_b64_tr_b16 v[42:43], v221 offset:29184
buffer_load_dwordx4 v7, s[32:35], s67 offen offset:3072 sc1 lds
v_mfma_f32_16x16x32_bf16 v[88:91], v[44:47], a[24:27], v[88:91]
v_mul_f32 v155, v155, v187
v_mfma_f32_16x16x32_bf16 v[88:91], v[48:51], a[40:43], v[88:91]
v_mfma_f32_16x16x32_bf16 v[88:91], v[52:55], a[56:59], v[88:91]
v_cvt_pk_bf16_f32 v138, v152, v153
v_mfma_f32_16x16x32_bf16 v[92:95], v[52:55], a[60:63], v[92:95]
s_add_u32 s67, s49, 11534336
s_add_u32 s67, s67, s62
s_mul_i32 s58, s14, 9280
s_add_u32 m0, s58, 111904
v_mfma_f32_16x16x32_bf16 v[92:95], v[48:51], a[44:47], v[92:95]
v_cvt_pk_bf16_f32 v139, v154, v155
v_mfma_f32_16x16x32_bf16 v[92:95], v[44:47], a[28:31], v[92:95]
buffer_load_dwordx4 v[236:239], v7, s[32:35], s55 offen offset:0 sc1
s_waitcnt lgkmcnt(0)
v_mfma_f32_16x16x32_bf16 v[64:67], v[32:35], a[160:163], v[64:67]
ds_read_b64_tr_b16 v[44:45], v221 offset:25600
v_mul_f32 v140, v140, v172
v_mfma_f32_16x16x32_bf16 v[64:67], v[36:39], a[176:179], v[64:67]
ds_read_b64_tr_b16 v[46:47], v221 offset:26112
buffer_load_dwordx4 v7, s[32:35], s67 offen offset:0 sc1 lds
v_mfma_f32_16x16x32_bf16 v[64:67], v[40:43], a[192:195], v[64:67]
ds_read_b64_tr_b16 v[48:49], v221 offset:27648
v_mul_f32 v141, v141, v173
v_mfma_f32_16x16x32_bf16 v[68:71], v[40:43], a[196:199], v[68:71]
ds_read_b64_tr_b16 v[50:51], v221 offset:28160
v_mfma_f32_16x16x32_bf16 v[68:71], v[36:39], a[180:183], v[68:71]
ds_read_b64_tr_b16 v[52:53], v221 offset:29696
v_mul_f32 v142, v142, v174
v_mfma_f32_16x16x32_bf16 v[68:71], v[32:35], a[164:167], v[68:71]
ds_read_b64_tr_b16 v[54:55], v221 offset:30208
buffer_load_dwordx4 v7, s[32:35], s67 offen offset:1024 sc1 lds
v_mfma_f32_16x16x32_bf16 v[72:75], v[32:35], a[168:171], v[72:75]
v_mul_f32 v143, v143, v175
v_mfma_f32_16x16x32_bf16 v[72:75], v[36:39], a[184:187], v[72:75]
buffer_load_dwordx4 v[240:243], v7, s[32:35], s52 offen offset:1024 sc1
v_mfma_f32_16x16x32_bf16 v[72:75], v[40:43], a[200:203], v[72:75]
v_cvt_pk_bf16_f32 v140, v140, v141
v_mfma_f32_16x16x32_bf16 v[76:79], v[40:43], a[204:207], v[76:79]
v_mfma_f32_16x16x32_bf16 v[76:79], v[36:39], a[188:191], v[76:79]
v_cvt_pk_bf16_f32 v141, v142, v143
v_mfma_f32_16x16x32_bf16 v[76:79], v[32:35], a[172:175], v[76:79]
s_waitcnt lgkmcnt(0)
v_mfma_f32_16x16x32_bf16 v[80:83], v[44:47], a[160:163], v[80:83]
s_waitcnt vmcnt(11)
s_barrier
v_mfma_f32_16x16x32_bf16 v[80:83], v[48:51], a[176:179], v[80:83]
ds_read_b64_tr_b16 v[32:33], v222 offset:0
v_mul_f32 v156, v156, v188
v_mfma_f32_16x16x32_bf16 v[80:83], v[52:55], a[192:195], v[80:83]
ds_read_b64_tr_b16 v[34:35], v222 offset:512
v_mul_f32 v157, v157, v189
v_mfma_f32_16x16x32_bf16 v[84:87], v[52:55], a[196:199], v[84:87]
ds_read_b64_tr_b16 v[36:37], v222 offset:2048
buffer_load_dwordx4 v[244:247], v7, s[32:35], s53 offen offset:1024 sc1
v_mfma_f32_16x16x32_bf16 v[84:87], v[48:51], a[180:183], v[84:87]
ds_read_b64_tr_b16 v[38:39], v222 offset:2560
v_mul_f32 v158, v158, v190
v_mfma_f32_16x16x32_bf16 v[84:87], v[44:47], a[164:167], v[84:87]
ds_read_b64_tr_b16 v[40:41], v222 offset:4096
v_mfma_f32_16x16x32_bf16 v[88:91], v[44:47], a[168:171], v[88:91]
ds_read_b64_tr_b16 v[42:43], v222 offset:4608
v_mul_f32 v159, v159, v191
v_mfma_f32_16x16x32_bf16 v[88:91], v[48:51], a[184:187], v[88:91]
v_mfma_f32_16x16x32_bf16 v[88:91], v[52:55], a[200:203], v[88:91]
v_cvt_pk_bf16_f32 v142, v156, v157
v_mfma_f32_16x16x32_bf16 v[92:95], v[52:55], a[204:207], v[92:95]
v_mfma_f32_16x16x32_bf16 v[92:95], v[48:51], a[188:191], v[92:95]
v_cvt_pk_bf16_f32 v143, v158, v159
v_mfma_f32_16x16x32_bf16 v[92:95], v[44:47], a[172:175], v[92:95]
s_waitcnt lgkmcnt(0)
v_mfma_f32_16x16x32_bf16 v[64:67], v[32:35], a[64:67], v[64:67]
ds_read_b64_tr_b16 v[44:45], v222 offset:1024
v_mov_b32 v60, 0
v_mfma_f32_16x16x32_bf16 v[64:67], v[36:39], a[80:83], v[64:67]
ds_read_b64_tr_b16 v[46:47], v222 offset:1536
buffer_store_dwordx4 v[128:131], v7, s[32:35], s100 offen offset:2048 sc1
v_mfma_f32_16x16x32_bf16 v[64:67], v[40:43], a[96:99], v[64:67]
ds_read_b64_tr_b16 v[48:49], v222 offset:3072
v_mov_b32 v61, 0
v_mfma_f32_16x16x32_bf16 v[68:71], v[40:43], a[100:103], v[68:71]
ds_read_b64_tr_b16 v[50:51], v222 offset:3584
v_mfma_f32_16x16x32_bf16 v[68:71], v[36:39], a[84:87], v[68:71]
ds_read_b64_tr_b16 v[52:53], v222 offset:5120
v_mov_b32 v62, 0
v_mfma_f32_16x16x32_bf16 v[68:71], v[32:35], a[68:71], v[68:71]
ds_read_b64_tr_b16 v[54:55], v222 offset:5632
v_mfma_f32_16x16x32_bf16 v[72:75], v[32:35], a[72:75], v[72:75]
s_add_u32 s67, s49, 11534336
s_add_u32 s67, s67, s62
s_mul_i32 s58, s14, 9280
s_add_u32 m0, s58, 111904
v_mfma_f32_16x16x32_bf16 v[72:75], v[36:39], a[88:91], v[72:75]
buffer_load_dwordx4 v7, s[32:35], s67 offen offset:2048 sc1 lds
v_mov_b32 v63, 0
v_mfma_f32_16x16x32_bf16 v[72:75], v[40:43], a[104:107], v[72:75]
ds_write_b128 v202, v[60:63] offset:4096
s_add_u32 s100, s100, 4096
v_mfma_f32_16x16x32_bf16 v[76:79], v[40:43], a[108:111], v[76:79]
v_mfma_f32_16x16x32_bf16 v[76:79], v[36:39], a[92:95], v[76:79]
ds_write_b16 v201, v4
v_mfma_f32_16x16x32_bf16 v[76:79], v[32:35], a[76:79], v[76:79]
s_waitcnt lgkmcnt(2)
v_mfma_f32_16x16x32_bf16 v[80:83], v[44:47], a[64:67], v[80:83]
ds_read_b64_tr_b16 v[32:33], v223 offset:0
v_lshlrev_b32 v21, 16, v21
v_mfma_f32_16x16x32_bf16 v[80:83], v[48:51], a[80:83], v[80:83]
ds_read_b64_tr_b16 v[34:35], v223 offset:512
buffer_load_dwordx4 v7, s[32:35], s67 offen offset:3072 sc1 lds
v_mfma_f32_16x16x32_bf16 v[80:83], v[52:55], a[96:99], v[80:83]
ds_read_b64_tr_b16 v[36:37], v223 offset:2048
v_lshrrev_b32 v2, 2, v1
v_mfma_f32_16x16x32_bf16 v[84:87], v[52:55], a[100:103], v[84:87]
ds_read_b64_tr_b16 v[38:39], v223 offset:2560
buffer_store_dwordx4 v[132:135], v7, s[32:35], s101 offen offset:2048 sc1
v_mfma_f32_16x16x32_bf16 v[84:87], v[48:51], a[84:87], v[84:87]
ds_read_b64_tr_b16 v[40:41], v223 offset:4096
v_mfma_f32_16x16x32_bf16 v[84:87], v[44:47], a[68:71], v[84:87]
ds_read_b64_tr_b16 v[42:43], v223 offset:4608
v_mul_u32_u24 v2, 288, v2
v_mfma_f32_16x16x32_bf16 v[88:91], v[44:47], a[72:75], v[88:91]
s_add_u32 s101, s101, 4096
v_mfma_f32_16x16x32_bf16 v[88:91], v[48:51], a[88:91], v[88:91]
v_and_b32 v3, 3, v1
v_mfma_f32_16x16x32_bf16 v[88:91], v[52:55], a[104:107], v[88:91]
v_mfma_f32_16x16x32_bf16 v[92:95], v[52:55], a[108:111], v[92:95]
v_lshl_add_u32 v2, v3, 3, v2
v_mfma_f32_16x16x32_bf16 v[92:95], v[48:51], a[92:95], v[92:95]
v_mfma_f32_16x16x32_bf16 v[92:95], v[44:47], a[76:79], v[92:95]
s_mul_i32 s59, s47, 9216
s_waitcnt lgkmcnt(0)
v_mfma_f32_16x16x32_bf16 v[64:67], v[32:35], a[208:211], v[64:67]
ds_read_b64_tr_b16 v[44:45], v223 offset:1024
buffer_store_dwordx4 v[136:139], v7, s[32:35], s3 offen offset:2048 sc1
v_mfma_f32_16x16x32_bf16 v[64:67], v[36:39], a[224:227], v[64:67]
ds_read_b64_tr_b16 v[46:47], v223 offset:1536
v_add_u32 v2, s59, v2
v_mfma_f32_16x16x32_bf16 v[64:67], v[40:43], a[240:243], v[64:67]
ds_read_b64_tr_b16 v[48:49], v223 offset:3072
v_mfma_f32_16x16x32_bf16 v[68:71], v[40:43], a[244:247], v[68:71]
ds_read_b64_tr_b16 v[50:51], v223 offset:3584
v_add_u32 v3, 36864, v2
v_mfma_f32_16x16x32_bf16 v[68:71], v[36:39], a[228:231], v[68:71]
ds_read_b64_tr_b16 v[52:53], v223 offset:5120
v_mfma_f32_16x16x32_bf16 v[68:71], v[32:35], a[212:215], v[68:71]
ds_read_b64_tr_b16 v[54:55], v223 offset:5632
v_add_u32 v4, 73728, v2
v_mfma_f32_16x16x32_bf16 v[72:75], v[32:35], a[216:219], v[72:75]
s_add_u32 s3, s3, 4096
v_mfma_f32_16x16x32_bf16 v[72:75], v[36:39], a[232:235], v[72:75]
v_mfma_f32_16x16x32_bf16 v[72:75], v[40:43], a[248:251], v[72:75]
v_add_u32 v5, 110592, v2
v_mfma_f32_16x16x32_bf16 v[76:79], v[40:43], a[252:255], v[76:79]
v_mfma_f32_16x16x32_bf16 v[76:79], v[36:39], a[236:239], v[76:79]
buffer_load_dwordx4 v[248:251], v7, s[32:35], s54 offen offset:1024 sc1
v_mfma_f32_16x16x32_bf16 v[76:79], v[32:35], a[220:223], v[76:79]
s_waitcnt lgkmcnt(0)
v_mfma_f32_16x16x32_bf16 v[80:83], v[44:47], a[208:211], v[80:83]
buffer_load_dwordx4 v[252:255], v7, s[32:35], s55 offen offset:1024 sc1
buffer_store_dwordx4 v[140:143], v7, s[32:35], s15 offen offset:2048 sc1
v_mfma_f32_16x16x32_bf16 v[80:83], v[48:51], a[224:227], v[80:83]
v_mfma_f32_16x16x32_bf16 v[80:83], v[52:55], a[240:243], v[80:83]
buffer_load_dwordx4 a[0:3], v7, s[32:35], s52 offen offset:2048 sc1
v_mfma_f32_16x16x32_bf16 v[84:87], v[52:55], a[244:247], v[84:87]
v_mfma_f32_16x16x32_bf16 v[84:87], v[48:51], a[228:231], v[84:87]
buffer_load_dwordx4 a[4:7], v7, s[32:35], s53 offen offset:2048 sc1
v_mfma_f32_16x16x32_bf16 v[84:87], v[44:47], a[212:215], v[84:87]
v_mfma_f32_16x16x32_bf16 v[88:91], v[44:47], a[216:219], v[88:91]
buffer_load_dwordx4 a[8:11], v7, s[32:35], s54 offen offset:2048 sc1
s_add_u32 s15, s15, 4096
v_mfma_f32_16x16x32_bf16 v[88:91], v[48:51], a[232:235], v[88:91]
v_mfma_f32_16x16x32_bf16 v[88:91], v[52:55], a[248:251], v[88:91]
buffer_load_dwordx4 a[12:15], v7, s[32:35], s55 offen offset:2048 sc1
v_mfma_f32_16x16x32_bf16 v[92:95], v[52:55], a[252:255], v[92:95]
v_mfma_f32_16x16x32_bf16 v[92:95], v[48:51], a[236:239], v[92:95]
v_mfma_f32_16x16x32_bf16 v[92:95], v[44:47], a[220:223], v[92:95]
P1_END:
s_barrier
v_mov_b32 v8, v192
v_mov_b32 v9, v193
v_mov_b32 v10, v194
v_mov_b32 v11, v195
v_mov_b32 v12, v196
v_mov_b32 v13, v197
v_mov_b32 v14, v198
v_mov_b32 v15, v199
v_mov_b32 v16, v200
v_mov_b32 v222, v207
v_mov_b32 v223, v208
s_cmp_lt_u32 s2, 112
s_cbranch_scc1 NOCV0
s_waitcnt vmcnt(9)
ds_read_b64 v[128:129], v203 offset:0
ds_read_b64 v[130:131], v203 offset:8
ds_read_b128 v[160:163], v204 offset:3584
ds_read_b64 v[132:133], v203 offset:512
ds_read_b64 v[134:135], v203 offset:520
ds_read_b128 v[164:167], v204 offset:3072
ds_read_b64 v[136:137], v203 offset:1024
ds_read_b64 v[138:139], v203 offset:1032
ds_read_b128 v[168:171], v204 offset:2560
ds_read_b64 v[140:141], v203 offset:1536
ds_read_b64 v[142:143], v203 offset:1544
ds_read_b128 v[172:175], v204 offset:2048
ds_read_b64 v[144:145], v203 offset:2048
ds_read_b64 v[146:147], v203 offset:2056
ds_read_b128 v[176:179], v204 offset:1536
ds_read_b64 v[148:149], v203 offset:2560
ds_read_b64 v[150:151], v203 offset:2568
ds_read_b128 v[180:183], v204 offset:1024
ds_read_b64 v[152:153], v203 offset:3072
ds_read_b64 v[154:155], v203 offset:3080
ds_read_b128 v[184:187], v204 offset:512
ds_read_b64 v[156:157], v203 offset:3584
ds_read_b64 v[158:159], v203 offset:3592
ds_read_b128 v[188:191], v204 offset:0
NOCV0:
v_mul_f32 v64, v64, v80
v_mul_f32 v65, v65, v81
v_mul_f32 v66, v66, v82
v_mul_f32 v67, v67, v83
v_cvt_pk_bf16_f32 v64, v64, v65
v_cvt_pk_bf16_f32 v65, v66, v67
s_sub_u32 s67, s100, s99
buffer_store_dwordx2 v[64:65], v17, s[32:35], s67 offen sc1
v_mul_f32 v68, v68, v84
v_mul_f32 v69, v69, v85
v_mul_f32 v70, v70, v86
v_mul_f32 v71, v71, v87
v_cvt_pk_bf16_f32 v68, v68, v69
v_cvt_pk_bf16_f32 v69, v70, v71
s_sub_u32 s67, s101, s99
buffer_store_dwordx2 v[68:69], v17, s[32:35], s67 offen sc1
v_mul_f32 v72, v72, v88
v_mul_f32 v73, v73, v89
v_mul_f32 v74, v74, v90
v_mul_f32 v75, v75, v91
v_cvt_pk_bf16_f32 v72, v72, v73
v_cvt_pk_bf16_f32 v73, v74, v75
s_sub_u32 s67, s3, s99
buffer_store_dwordx2 v[72:73], v17, s[32:35], s67 offen sc1
v_mul_f32 v76, v76, v92
v_mul_f32 v77, v77, v93
v_mul_f32 v78, v78, v94
v_mul_f32 v79, v79, v95
v_cvt_pk_bf16_f32 v76, v76, v77
v_cvt_pk_bf16_f32 v77, v78, v79
s_sub_u32 s67, s15, s99
buffer_store_dwordx2 v[76:77], v17, s[32:35], s67 offen sc1
s_cmp_lt_u32 s2, 112
s_cbranch_scc1 NOCONV
s_add_u32 s49, s49, 8388608
s_add_u32 s44, s56, 0x4000
s_add_u32 s51, s56, 0x8000
s_waitcnt lgkmcnt(0)
v_mfma_f32_16x16x32_bf16 v[60:63], v[128:131], v[188:191], 0
ds_read_b64 v[64:65], v203 offset:64
buffer_load_dwordx4 a[16:19], v7, s[32:35], s52 offen offset:3072 sc1
v_mfma_f32_16x16x32_bf16 v[60:63], v[132:135], v[184:187], v[60:63]
ds_read_b64 v[66:67], v203 offset:72
v_mfma_f32_16x16x32_bf16 v[60:63], v[136:139], v[180:183], v[60:63]
ds_read_b128 v[96:99], v204 offset:3648
v_mfma_f32_16x16x32_bf16 v[60:63], v[140:143], v[176:179], v[60:63]
ds_read_b64 v[68:69], v203 offset:576
v_mfma_f32_16x16x32_bf16 v[60:63], v[144:147], v[172:175], v[60:63]
ds_read_b64 v[70:71], v203 offset:584
v_mfma_f32_16x16x32_bf16 v[60:63], v[148:151], v[168:171], v[60:63]
v_mfma_f32_16x16x32_bf16 v[60:63], v[152:155], v[164:167], v[60:63]
ds_read_b128 v[100:103], v204 offset:3136
v_mfma_f32_16x16x32_bf16 v[60:63], v[156:159], v[160:163], v[60:63]
ds_read_b64 v[72:73], v203 offset:1088
v_mfma_f32_16x16x32_bf16 v[56:59], v[128:131], v[184:187], 0
ds_read_b64 v[74:75], v203 offset:1096
buffer_load_dwordx4 a[20:23], v7, s[32:35], s53 offen offset:3072 sc1
v_mfma_f32_16x16x32_bf16 v[56:59], v[132:135], v[180:183], v[56:59]
ds_read_b128 v[104:107], v204 offset:2624
v_mfma_f32_16x16x32_bf16 v[56:59], v[136:139], v[176:179], v[56:59]
ds_read_b64 v[76:77], v203 offset:1600
v_mfma_f32_16x16x32_bf16 v[56:59], v[140:143], v[172:175], v[56:59]
v_mfma_f32_16x16x32_bf16 v[56:59], v[144:147], v[168:171], v[56:59]
ds_read_b64 v[78:79], v203 offset:1608
v_mfma_f32_16x16x32_bf16 v[56:59], v[148:151], v[164:167], v[56:59]
ds_read_b128 v[108:111], v204 offset:2112
v_mfma_f32_16x16x32_bf16 v[56:59], v[152:155], v[160:163], v[56:59]
ds_read_b64 v[80:81], v203 offset:2112
v_mfma_f32_16x16x32_bf16 v[52:55], v[128:131], v[180:183], 0
ds_read_b64 v[82:83], v203 offset:2120
v_mfma_f32_16x16x32_bf16 v[52:55], v[132:135], v[176:179], v[52:55]
ds_read_b128 v[112:115], v204 offset:1600
v_mfma_f32_16x16x32_bf16 v[52:55], v[136:139], v[172:175], v[52:55]
buffer_load_dwordx4 a[24:27], v7, s[32:35], s54 offen offset:3072 sc1
v_mfma_f32_16x16x32_bf16 v[52:55], v[140:143], v[168:171], v[52:55]
ds_read_b64 v[84:85], v203 offset:2624
v_mfma_f32_16x16x32_bf16 v[52:55], v[144:147], v[164:167], v[52:55]
ds_read_b64 v[86:87], v203 offset:2632
v_mfma_f32_16x16x32_bf16 v[52:55], v[148:151], v[160:163], v[52:55]
ds_read_b128 v[116:119], v204 offset:1088
v_mfma_f32_16x16x32_bf16 v[48:51], v[128:131], v[176:179], 0
ds_read_b64 v[88:89], v203 offset:3136
v_mfma_f32_16x16x32_bf16 v[48:51], v[132:135], v[172:175], v[48:51]
ds_read_b64 v[90:91], v203 offset:3144
v_mfma_f32_16x16x32_bf16 v[48:51], v[136:139], v[168:171], v[48:51]
v_mfma_f32_16x16x32_bf16 v[48:51], v[140:143], v[164:167], v[48:51]
ds_read_b128 v[120:123], v204 offset:576
v_mfma_f32_16x16x32_bf16 v[48:51], v[144:147], v[160:163], v[48:51]
ds_read_b64 v[92:93], v203 offset:3648
v_mfma_f32_16x16x32_bf16 v[44:47], v[128:131], v[172:175], 0
ds_read_b64 v[94:95], v203 offset:3656
buffer_load_dwordx4 a[28:31], v7, s[32:35], s55 offen offset:3072 sc1
v_mfma_f32_16x16x32_bf16 v[44:47], v[132:135], v[168:171], v[44:47]
ds_read_b128 v[124:127], v204 offset:64
v_mfma_f32_16x16x32_bf16 v[44:47], v[136:139], v[164:167], v[44:47]
v_mfma_f32_16x16x32_bf16 v[44:47], v[140:143], v[160:163], v[44:47]
v_mfma_f32_16x16x32_bf16 v[40:43], v[128:131], v[168:171], 0
v_mfma_f32_16x16x32_bf16 v[40:43], v[132:135], v[164:167], v[40:43]
v_mfma_f32_16x16x32_bf16 v[40:43], v[136:139], v[160:163], v[40:43]
v_mfma_f32_16x16x32_bf16 v[36:39], v[128:131], v[164:167], 0
v_mfma_f32_16x16x32_bf16 v[36:39], v[132:135], v[160:163], v[36:39]
v_mfma_f32_16x16x32_bf16 v[32:35], v[128:131], v[160:163], 0
s_waitcnt lgkmcnt(0)
v_mfma_f32_16x16x32_bf16 v[60:63], v[64:67], v[124:127], v[60:63]
ds_read_b64 v[128:129], v203 offset:128
v_mfma_f32_16x16x32_bf16 v[60:63], v[68:71], v[120:123], v[60:63]
ds_read_b64 v[130:131], v203 offset:136
v_mfma_f32_16x16x32_bf16 v[60:63], v[72:75], v[116:119], v[60:63]
ds_read_b128 v[160:163], v204 offset:3712
v_mfma_f32_16x16x32_bf16 v[60:63], v[76:79], v[112:115], v[60:63]
ds_read_b64 v[132:133], v203 offset:640
v_mfma_f32_16x16x32_bf16 v[60:63], v[80:83], v[108:111], v[60:63]
ds_read_b64 v[134:135], v203 offset:648
v_mfma_f32_16x16x32_bf16 v[60:63], v[84:87], v[104:107], v[60:63]
s_add_u32 s66, s64, 0
s_add_u32 s66, s66, s63
s_add_u32 m0, s65, 0
v_mfma_f32_16x16x32_bf16 v[60:63], v[88:91], v[100:103], v[60:63]
ds_read_b128 v[164:167], v204 offset:3200
buffer_load_dwordx4 v8, s[16:19], s66 offen offset:0 lds
v_mfma_f32_16x16x32_bf16 v[60:63], v[92:95], v[96:99], v[60:63]
ds_read_b64 v[136:137], v203 offset:1152
buffer_load_dwordx4 v9, s[16:19], s66 offen offset:1024 lds
v_mfma_f32_16x16x32_bf16 v[56:59], v[64:67], v[120:123], v[56:59]
ds_read_b64 v[138:139], v203 offset:1160
v_mfma_f32_16x16x32_bf16 v[56:59], v[68:71], v[116:119], v[56:59]
ds_read_b128 v[168:171], v204 offset:2688
v_mfma_f32_16x16x32_bf16 v[56:59], v[72:75], v[112:115], v[56:59]
ds_read_b64 v[140:141], v203 offset:1664
v_mfma_f32_16x16x32_bf16 v[56:59], v[76:79], v[108:111], v[56:59]
buffer_load_dwordx4 v10, s[16:19], s66 offen offset:2048 lds
v_mfma_f32_16x16x32_bf16 v[56:59], v[80:83], v[104:107], v[56:59]
ds_read_b64 v[142:143], v203 offset:1672
v_mfma_f32_16x16x32_bf16 v[56:59], v[84:87], v[100:103], v[56:59]
ds_read_b128 v[172:175], v204 offset:2176
v_mfma_f32_16x16x32_bf16 v[56:59], v[88:91], v[96:99], v[56:59]
ds_read_b64 v[144:145], v203 offset:2176
v_mfma_f32_16x16x32_bf16 v[52:55], v[64:67], v[116:119], v[52:55]
ds_read_b64 v[146:147], v203 offset:2184
buffer_load_dwordx4 v11, s[16:19], s66 offen offset:3072 lds
v_mfma_f32_16x16x32_bf16 v[52:55], v[68:71], v[112:115], v[52:55]
ds_read_b128 v[176:179], v204 offset:1664
v_mfma_f32_16x16x32_bf16 v[52:55], v[72:75], v[108:111], v[52:55]
v_mfma_f32_16x16x32_bf16 v[52:55], v[76:79], v[104:107], v[52:55]
ds_read_b64 v[148:149], v203 offset:2688
v_mfma_f32_16x16x32_bf16 v[52:55], v[80:83], v[100:103], v[52:55]
ds_read_b64 v[150:151], v203 offset:2696
s_add_u32 m0, s65, 4096
v_mfma_f32_16x16x32_bf16 v[52:55], v[84:87], v[96:99], v[52:55]
ds_read_b128 v[180:183], v204 offset:1152
v_mfma_f32_16x16x32_bf16 v[48:51], v[64:67], v[112:115], v[48:51]
ds_read_b64 v[152:153], v203 offset:3200
v_mfma_f32_16x16x32_bf16 v[48:51], v[68:71], v[108:111], v[48:51]
ds_read_b64 v[154:155], v203 offset:3208
v_mfma_f32_16x16x32_bf16 v[48:51], v[72:75], v[104:107], v[48:51]
buffer_load_dwordx4 v12, s[16:19], s66 offen offset:0 lds
v_mfma_f32_16x16x32_bf16 v[48:51], v[76:79], v[100:103], v[48:51]
ds_read_b128 v[184:187], v204 offset:640
v_mfma_f32_16x16x32_bf16 v[48:51], v[80:83], v[96:99], v[48:51]
ds_read_b64 v[156:157], v203 offset:3712
v_mfma_f32_16x16x32_bf16 v[44:47], v[64:67], v[108:111], v[44:47]
ds_read_b64 v[158:159], v203 offset:3720
v_mfma_f32_16x16x32_bf16 v[44:47], v[68:71], v[104:107], v[44:47]
ds_read_b128 v[188:191], v204 offset:128
buffer_load_dwordx4 v13, s[16:19], s66 offen offset:1024 lds
v_mfma_f32_16x16x32_bf16 v[44:47], v[72:75], v[100:103], v[44:47]
v_mfma_f32_16x16x32_bf16 v[44:47], v[76:79], v[96:99], v[44:47]
v_mfma_f32_16x16x32_bf16 v[40:43], v[64:67], v[104:107], v[40:43]
v_mfma_f32_16x16x32_bf16 v[40:43], v[68:71], v[100:103], v[40:43]
buffer_load_dwordx4 v14, s[16:19], s66 offen offset:2048 lds
v_mfma_f32_16x16x32_bf16 v[40:43], v[72:75], v[96:99], v[40:43]
v_mfma_f32_16x16x32_bf16 v[36:39], v[64:67], v[100:103], v[36:39]
v_mfma_f32_16x16x32_bf16 v[36:39], v[68:71], v[96:99], v[36:39]
v_mfma_f32_16x16x32_bf16 v[32:35], v[64:67], v[96:99], v[32:35]
s_waitcnt lgkmcnt(0)
v_mfma_f32_16x16x32_bf16 v[60:63], v[128:131], v[188:191], v[60:63]
ds_read_b64 v[64:65], v203 offset:192
v_mfma_f32_16x16x32_bf16 v[60:63], v[132:135], v[184:187], v[60:63]
ds_read_b64 v[66:67], v203 offset:200
v_mfma_f32_16x16x32_bf16 v[60:63], v[136:139], v[180:183], v[60:63]
ds_read_b128 v[96:99], v204 offset:3776
v_mfma_f32_16x16x32_bf16 v[60:63], v[140:143], v[176:179], v[60:63]
ds_read_b64 v[68:69], v203 offset:704
v_mfma_f32_16x16x32_bf16 v[60:63], v[144:147], v[172:175], v[60:63]
ds_read_b64 v[70:71], v203 offset:712
v_mfma_f32_16x16x32_bf16 v[60:63], v[148:151], v[168:171], v[60:63]
s_waitcnt vmcnt(11)
s_add_u32 s67, s57, 0x8000
buffer_store_dwordx2 v[26:27], v25, s[32:35], s67 offen sc1
v_mfma_f32_16x16x32_bf16 v[60:63], v[152:155], v[164:167], v[60:63]
ds_read_b128 v[100:103], v204 offset:3264
buffer_load_dwordx4 v15, s[16:19], s66 offen offset:3072 lds
v_mfma_f32_16x16x32_bf16 v[60:63], v[156:159], v[160:163], v[60:63]
ds_read_b64 v[72:73], v203 offset:1216
s_add_u32 m0, s65, 8192
v_mfma_f32_16x16x32_bf16 v[56:59], v[128:131], v[184:187], v[56:59]
ds_read_b64 v[74:75], v203 offset:1224
v_mfma_f32_16x16x32_bf16 v[56:59], v[132:135], v[180:183], v[56:59]
ds_read_b128 v[104:107], v204 offset:2752
v_mfma_f32_16x16x32_bf16 v[56:59], v[136:139], v[176:179], v[56:59]
ds_read_b64 v[76:77], v203 offset:1728
v_mfma_f32_16x16x32_bf16 v[56:59], v[140:143], v[172:175], v[56:59]
buffer_load_dwordx4 v16, s[16:19], s66 offen offset:0 lds
v_mfma_f32_16x16x32_bf16 v[56:59], v[144:147], v[168:171], v[56:59]
ds_read_b64 v[78:79], v203 offset:1736
v_mfma_f32_16x16x32_bf16 v[56:59], v[148:151], v[164:167], v[56:59]
ds_read_b128 v[108:111], v204 offset:2240
v_mfma_f32_16x16x32_bf16 v[56:59], v[152:155], v[160:163], v[56:59]
ds_read_b64 v[80:81], v203 offset:2240
v_mfma_f32_16x16x32_bf16 v[52:55], v[128:131], v[180:183], v[52:55]
ds_read_b64 v[82:83], v203 offset:2248
buffer_load_dwordx4 a[32:35], v29, s[32:35], s52 offen offset:2048 sc1
v_mfma_f32_16x16x32_bf16 v[52:55], v[132:135], v[176:179], v[52:55]
ds_read_b128 v[112:115], v204 offset:1728
v_mfma_f32_16x16x32_bf16 v[52:55], v[136:139], v[172:175], v[52:55]
v_mfma_f32_16x16x32_bf16 v[52:55], v[140:143], v[168:171], v[52:55]
ds_read_b64 v[84:85], v203 offset:2752
v_mfma_f32_16x16x32_bf16 v[52:55], v[144:147], v[164:167], v[52:55]
ds_read_b64 v[86:87], v203 offset:2760
buffer_load_dwordx4 a[36:39], v29, s[32:35], s53 offen offset:2048 sc1
v_mfma_f32_16x16x32_bf16 v[52:55], v[148:151], v[160:163], v[52:55]
ds_read_b128 v[116:119], v204 offset:1216
v_mfma_f32_16x16x32_bf16 v[48:51], v[128:131], v[176:179], v[48:51]
ds_read_b64 v[88:89], v203 offset:3264
v_mfma_f32_16x16x32_bf16 v[48:51], v[132:135], v[172:175], v[48:51]
ds_read_b64 v[90:91], v203 offset:3272
v_mfma_f32_16x16x32_bf16 v[48:51], v[136:139], v[168:171], v[48:51]
buffer_load_dwordx4 a[40:43], v29, s[32:35], s54 offen offset:2048 sc1
v_mfma_f32_16x16x32_bf16 v[48:51], v[140:143], v[164:167], v[48:51]
ds_read_b128 v[120:123], v204 offset:704
v_mfma_f32_16x16x32_bf16 v[48:51], v[144:147], v[160:163], v[48:51]
ds_read_b64 v[92:93], v203 offset:3776
v_mfma_f32_16x16x32_bf16 v[44:47], v[128:131], v[172:175], v[44:47]
ds_read_b64 v[94:95], v203 offset:3784
v_mfma_f32_16x16x32_bf16 v[44:47], v[132:135], v[168:171], v[44:47]
ds_read_b128 v[124:127], v204 offset:192
buffer_load_dwordx4 a[44:47], v29, s[32:35], s55 offen offset:2048 sc1
v_mfma_f32_16x16x32_bf16 v[44:47], v[136:139], v[164:167], v[44:47]
v_mfma_f32_16x16x32_bf16 v[44:47], v[140:143], v[160:163], v[44:47]
v_mfma_f32_16x16x32_bf16 v[40:43], v[128:131], v[168:171], v[40:43]
v_mfma_f32_16x16x32_bf16 v[40:43], v[132:135], v[164:167], v[40:43]
buffer_load_dwordx2 v[22:23], v19, s[32:35], s44 offen sc1
v_mfma_f32_16x16x32_bf16 v[40:43], v[136:139], v[160:163], v[40:43]
v_mfma_f32_16x16x32_bf16 v[36:39], v[128:131], v[164:167], v[36:39]
v_mfma_f32_16x16x32_bf16 v[36:39], v[132:135], v[160:163], v[36:39]
v_mfma_f32_16x16x32_bf16 v[32:35], v[128:131], v[160:163], v[32:35]
s_waitcnt lgkmcnt(0)
v_mfma_f32_16x16x32_bf16 v[60:63], v[64:67], v[124:127], v[60:63]
ds_read_b64 v[128:129], v203 offset:256
v_mfma_f32_16x16x32_bf16 v[60:63], v[68:71], v[120:123], v[60:63]
ds_read_b64 v[130:131], v203 offset:264
v_mfma_f32_16x16x32_bf16 v[60:63], v[72:75], v[116:119], v[60:63]
ds_read_b128 v[160:163], v204 offset:3840
v_mfma_f32_16x16x32_bf16 v[60:63], v[76:79], v[112:115], v[60:63]
ds_read_b64 v[132:133], v203 offset:768
v_mfma_f32_16x16x32_bf16 v[60:63], v[80:83], v[108:111], v[60:63]
ds_read_b64 v[134:135], v203 offset:776
v_mfma_f32_16x16x32_bf16 v[60:63], v[84:87], v[104:107], v[60:63]
s_add_u32 s66, s64, 73728
s_add_u32 s66, s66, s63
s_add_u32 m0, s65, 36864
v_mfma_f32_16x16x32_bf16 v[60:63], v[88:91], v[100:103], v[60:63]
ds_read_b128 v[164:167], v204 offset:3328
buffer_load_dwordx4 v8, s[16:19], s66 offen offset:0 lds
v_mfma_f32_16x16x32_bf16 v[60:63], v[92:95], v[96:99], v[60:63]
ds_read_b64 v[136:137], v203 offset:1280
buffer_load_dwordx4 v9, s[16:19], s66 offen offset:1024 lds
v_mfma_f32_16x16x32_bf16 v[56:59], v[64:67], v[120:123], v[56:59]
ds_read_b64 v[138:139], v203 offset:1288
v_mfma_f32_16x16x32_bf16 v[56:59], v[68:71], v[116:119], v[56:59]
ds_read_b128 v[168:171], v204 offset:2816
v_mfma_f32_16x16x32_bf16 v[56:59], v[72:75], v[112:115], v[56:59]
ds_read_b64 v[140:141], v203 offset:1792
v_mfma_f32_16x16x32_bf16 v[56:59], v[76:79], v[108:111], v[56:59]
buffer_load_dwordx4 v10, s[16:19], s66 offen offset:2048 lds
v_mfma_f32_16x16x32_bf16 v[56:59], v[80:83], v[104:107], v[56:59]
ds_read_b64 v[142:143], v203 offset:1800
v_mfma_f32_16x16x32_bf16 v[56:59], v[84:87], v[100:103], v[56:59]
ds_read_b128 v[172:175], v204 offset:2304
v_mfma_f32_16x16x32_bf16 v[56:59], v[88:91], v[96:99], v[56:59]
ds_read_b64 v[144:145], v203 offset:2304
v_mfma_f32_16x16x32_bf16 v[52:55], v[64:67], v[116:119], v[52:55]
ds_read_b64 v[146:147], v203 offset:2312
buffer_load_dwordx4 v11, s[16:19], s66 offen offset:3072 lds
v_mfma_f32_16x16x32_bf16 v[52:55], v[68:71], v[112:115], v[52:55]
ds_read_b128 v[176:179], v204 offset:1792
v_mfma_f32_16x16x32_bf16 v[52:55], v[72:75], v[108:111], v[52:55]
v_mfma_f32_16x16x32_bf16 v[52:55], v[76:79], v[104:107], v[52:55]
ds_read_b64 v[148:149], v203 offset:2816
v_mfma_f32_16x16x32_bf16 v[52:55], v[80:83], v[100:103], v[52:55]
ds_read_b64 v[150:151], v203 offset:2824
s_add_u32 m0, s65, 40960
v_mfma_f32_16x16x32_bf16 v[52:55], v[84:87], v[96:99], v[52:55]
ds_read_b128 v[180:183], v204 offset:1280
v_mfma_f32_16x16x32_bf16 v[48:51], v[64:67], v[112:115], v[48:51]
ds_read_b64 v[152:153], v203 offset:3328
v_mfma_f32_16x16x32_bf16 v[48:51], v[68:71], v[108:111], v[48:51]
ds_read_b64 v[154:155], v203 offset:3336
v_mfma_f32_16x16x32_bf16 v[48:51], v[72:75], v[104:107], v[48:51]
STUB_g5:
s_cbranch_execz NEXT_g5
buffer_load_dwordx4 v12, s[16:19], s66 offen offset:0 lds
v_mfma_f32_16x16x32_bf16 v[48:51], v[76:79], v[100:103], v[48:51]
ds_read_b128 v[184:187], v204 offset:768
v_mfma_f32_16x16x32_bf16 v[48:51], v[80:83], v[96:99], v[48:51]
ds_read_b64 v[156:157], v203 offset:3840
v_mfma_f32_16x16x32_bf16 v[44:47], v[64:67], v[108:111], v[44:47]
ds_read_b64 v[158:159], v203 offset:3848
v_mfma_f32_16x16x32_bf16 v[44:47], v[68:71], v[104:107], v[44:47]
ds_read_b128 v[188:191], v204 offset:256
buffer_load_dwordx4 v13, s[16:19], s66 offen offset:1024 lds
v_mfma_f32_16x16x32_bf16 v[44:47], v[72:75], v[100:103], v[44:47]
v_mfma_f32_16x16x32_bf16 v[44:47], v[76:79], v[96:99], v[44:47]
v_mfma_f32_16x16x32_bf16 v[40:43], v[64:67], v[104:107], v[40:43]
v_mfma_f32_16x16x32_bf16 v[40:43], v[68:71], v[100:103], v[40:43]
buffer_load_dwordx4 v14, s[16:19], s66 offen offset:2048 lds
v_mfma_f32_16x16x32_bf16 v[40:43], v[72:75], v[96:99], v[40:43]
v_mfma_f32_16x16x32_bf16 v[36:39], v[64:67], v[100:103], v[36:39]
v_mfma_f32_16x16x32_bf16 v[36:39], v[68:71], v[96:99], v[36:39]
v_mfma_f32_16x16x32_bf16 v[32:35], v[64:67], v[96:99], v[32:35]
s_waitcnt lgkmcnt(0)
v_mfma_f32_16x16x32_bf16 v[60:63], v[128:131], v[188:191], v[60:63]
ds_read_b64 v[64:65], v203 offset:320
v_mfma_f32_16x16x32_bf16 v[60:63], v[132:135], v[184:187], v[60:63]
ds_read_b64 v[66:67], v203 offset:328
v_mfma_f32_16x16x32_bf16 v[60:63], v[136:139], v[180:183], v[60:63]
ds_read_b128 v[96:99], v204 offset:3904
v_mfma_f32_16x16x32_bf16 v[60:63], v[140:143], v[176:179], v[60:63]
ds_read_b64 v[68:69], v203 offset:832
v_mfma_f32_16x16x32_bf16 v[60:63], v[144:147], v[172:175], v[60:63]
ds_read_b64 v[70:71], v203 offset:840
v_mfma_f32_16x16x32_bf16 v[60:63], v[148:151], v[168:171], v[60:63]
s_waitcnt vmcnt(7)
v_cmp_ne_u64 vcc, s[94:95], v[22:23]
s_nop 1
s_cmp_lg_u64 vcc, 0
s_cbranch_scc1 SLOW_F3B1
BACK_F3B1:
v_mfma_f32_16x16x32_bf16 v[60:63], v[152:155], v[164:167], v[60:63]
ds_read_b128 v[100:103], v204 offset:3392
buffer_load_dwordx4 v15, s[16:19], s66 offen offset:3072 lds
v_mfma_f32_16x16x32_bf16 v[60:63], v[156:159], v[160:163], v[60:63]
ds_read_b64 v[72:73], v203 offset:1344
v_mfma_f32_16x16x32_bf16 v[56:59], v[128:131], v[184:187], v[56:59]
ds_read_b64 v[74:75], v203 offset:1352
s_add_u32 m0, s65, 45056
v_mfma_f32_16x16x32_bf16 v[56:59], v[132:135], v[180:183], v[56:59]
ds_read_b128 v[104:107], v204 offset:2880
v_mfma_f32_16x16x32_bf16 v[56:59], v[136:139], v[176:179], v[56:59]
ds_read_b64 v[76:77], v203 offset:1856
v_mfma_f32_16x16x32_bf16 v[56:59], v[140:143], v[172:175], v[56:59]
v_mfma_f32_16x16x32_bf16 v[56:59], v[144:147], v[168:171], v[56:59]
ds_read_b64 v[78:79], v203 offset:1864
v_mfma_f32_16x16x32_bf16 v[56:59], v[148:151], v[164:167], v[56:59]
ds_read_b128 v[108:111], v204 offset:2368
buffer_load_dwordx4 v16, s[16:19], s66 offen offset:0 lds
v_mfma_f32_16x16x32_bf16 v[56:59], v[152:155], v[160:163], v[56:59]
ds_read_b64 v[80:81], v203 offset:2368
v_mfma_f32_16x16x32_bf16 v[52:55], v[128:131], v[180:183], v[52:55]
ds_read_b64 v[82:83], v203 offset:2376
v_mfma_f32_16x16x32_bf16 v[52:55], v[132:135], v[176:179], v[52:55]
ds_read_b128 v[112:115], v204 offset:1856
v_mfma_f32_16x16x32_bf16 v[52:55], v[136:139], v[172:175], v[52:55]
buffer_load_dwordx4 a[48:51], v29, s[32:35], s52 offen offset:3072 sc1
v_mfma_f32_16x16x32_bf16 v[52:55], v[140:143], v[168:171], v[52:55]
ds_read_b64 v[84:85], v203 offset:2880
v_mfma_f32_16x16x32_bf16 v[52:55], v[144:147], v[164:167], v[52:55]
ds_read_b64 v[86:87], v203 offset:2888
v_mfma_f32_16x16x32_bf16 v[52:55], v[148:151], v[160:163], v[52:55]
ds_read_b128 v[116:119], v204 offset:1344
v_mfma_f32_16x16x32_bf16 v[48:51], v[128:131], v[176:179], v[48:51]
ds_read_b64 v[88:89], v203 offset:3392
buffer_load_dwordx4 a[52:55], v29, s[32:35], s53 offen offset:3072 sc1
v_mfma_f32_16x16x32_bf16 v[48:51], v[132:135], v[172:175], v[48:51]
ds_read_b64 v[90:91], v203 offset:3400
v_mfma_f32_16x16x32_bf16 v[48:51], v[136:139], v[168:171], v[48:51]
v_mfma_f32_16x16x32_bf16 v[48:51], v[140:143], v[164:167], v[48:51]
ds_read_b128 v[120:123], v204 offset:832
v_mfma_f32_16x16x32_bf16 v[48:51], v[144:147], v[160:163], v[48:51]
ds_read_b64 v[92:93], v203 offset:3904
v_mfma_f32_16x16x32_bf16 v[44:47], v[128:131], v[172:175], v[44:47]
ds_read_b64 v[94:95], v203 offset:3912
buffer_load_dwordx4 a[56:59], v29, s[32:35], s54 offen offset:3072 sc1
v_mfma_f32_16x16x32_bf16 v[44:47], v[132:135], v[168:171], v[44:47]
ds_read_b128 v[124:127], v204 offset:320
v_mfma_f32_16x16x32_bf16 v[44:47], v[136:139], v[164:167], v[44:47]
v_mfma_f32_16x16x32_bf16 v[44:47], v[140:143], v[160:163], v[44:47]
v_mfma_f32_16x16x32_bf16 v[40:43], v[128:131], v[168:171], v[40:43]
buffer_load_dwordx4 a[60:63], v29, s[32:35], s55 offen offset:3072 sc1
v_mfma_f32_16x16x32_bf16 v[40:43], v[132:135], v[164:167], v[40:43]
v_mfma_f32_16x16x32_bf16 v[40:43], v[136:139], v[160:163], v[40:43]
v_mfma_f32_16x16x32_bf16 v[36:39], v[128:131], v[164:167], v[36:39]
v_mfma_f32_16x16x32_bf16 v[36:39], v[132:135], v[160:163], v[36:39]
v_mfma_f32_16x16x32_bf16 v[32:35], v[128:131], v[160:163], v[32:35]
s_waitcnt lgkmcnt(0)
v_mfma_f32_16x16x32_bf16 v[60:63], v[64:67], v[124:127], v[60:63]
ds_read_b64 v[128:129], v203 offset:384
buffer_load_dwordx4 a[64:67], v30, s[32:35], s52 offen offset:0 sc1
v_mfma_f32_16x16x32_bf16 v[60:63], v[68:71], v[120:123], v[60:63]
ds_read_b64 v[130:131], v203 offset:392
v_mfma_f32_16x16x32_bf16 v[60:63], v[72:75], v[116:119], v[60:63]
ds_read_b128 v[160:163], v204 offset:3968
v_mfma_f32_16x16x32_bf16 v[60:63], v[76:79], v[112:115], v[60:63]
ds_read_b64 v[132:133], v203 offset:896
v_mfma_f32_16x16x32_bf16 v[60:63], v[80:83], v[108:111], v[60:63]
ds_read_b64 v[134:135], v203 offset:904
buffer_load_dwordx4 a[68:71], v30, s[32:35], s53 offen offset:0 sc1
v_mfma_f32_16x16x32_bf16 v[60:63], v[84:87], v[104:107], v[60:63]
v_mfma_f32_16x16x32_bf16 v[60:63], v[88:91], v[100:103], v[60:63]
ds_read_b128 v[164:167], v204 offset:3456
v_mfma_f32_16x16x32_bf16 v[60:63], v[92:95], v[96:99], v[60:63]
ds_read_b64 v[136:137], v203 offset:1408
v_mfma_f32_16x16x32_bf16 v[56:59], v[64:67], v[120:123], v[56:59]
ds_read_b64 v[138:139], v203 offset:1416
buffer_load_dwordx4 a[72:75], v30, s[32:35], s54 offen offset:0 sc1
v_mfma_f32_16x16x32_bf16 v[56:59], v[68:71], v[116:119], v[56:59]
ds_read_b128 v[168:171], v204 offset:2944
v_mfma_f32_16x16x32_bf16 v[56:59], v[72:75], v[112:115], v[56:59]
ds_read_b64 v[140:141], v203 offset:1920
v_mfma_f32_16x16x32_bf16 v[56:59], v[76:79], v[108:111], v[56:59]
v_mfma_f32_16x16x32_bf16 v[56:59], v[80:83], v[104:107], v[56:59]
ds_read_b64 v[142:143], v203 offset:1928
v_mfma_f32_16x16x32_bf16 v[56:59], v[84:87], v[100:103], v[56:59]
ds_read_b128 v[172:175], v204 offset:2432
buffer_load_dwordx4 a[76:79], v30, s[32:35], s55 offen offset:0 sc1
v_mfma_f32_16x16x32_bf16 v[56:59], v[88:91], v[96:99], v[56:59]
ds_read_b64 v[144:145], v203 offset:2432
v_mfma_f32_16x16x32_bf16 v[52:55], v[64:67], v[116:119], v[52:55]
ds_read_b64 v[146:147], v203 offset:2440
v_mfma_f32_16x16x32_bf16 v[52:55], v[68:71], v[112:115], v[52:55]
ds_read_b128 v[176:179], v204 offset:1920
v_mfma_f32_16x16x32_bf16 v[52:55], v[72:75], v[108:111], v[52:55]
buffer_load_dwordx4 a[80:83], v30, s[32:35], s52 offen offset:1024 sc1
v_mfma_f32_16x16x32_bf16 v[52:55], v[76:79], v[104:107], v[52:55]
ds_read_b64 v[148:149], v203 offset:2944
v_mfma_f32_16x16x32_bf16 v[52:55], v[80:83], v[100:103], v[52:55]
ds_read_b64 v[150:151], v203 offset:2952
v_mfma_f32_16x16x32_bf16 v[52:55], v[84:87], v[96:99], v[52:55]
ds_read_b128 v[180:183], v204 offset:1408
v_mfma_f32_16x16x32_bf16 v[48:51], v[64:67], v[112:115], v[48:51]
ds_read_b64 v[152:153], v203 offset:3456
buffer_load_dwordx4 a[84:87], v30, s[32:35], s53 offen offset:1024 sc1
v_mfma_f32_16x16x32_bf16 v[48:51], v[68:71], v[108:111], v[48:51]
ds_read_b64 v[154:155], v203 offset:3464
v_mfma_f32_16x16x32_bf16 v[48:51], v[72:75], v[104:107], v[48:51]
v_mfma_f32_16x16x32_bf16 v[48:51], v[76:79], v[100:103], v[48:51]
ds_read_b128 v[184:187], v204 offset:896
v_mfma_f32_16x16x32_bf16 v[48:51], v[80:83], v[96:99], v[48:51]
ds_read_b64 v[156:157], v203 offset:3968
v_mfma_f32_16x16x32_bf16 v[44:47], v[64:67], v[108:111], v[44:47]
ds_read_b64 v[158:159], v203 offset:3976
buffer_load_dwordx4 a[88:91], v30, s[32:35], s54 offen offset:1024 sc1
v_mfma_f32_16x16x32_bf16 v[44:47], v[68:71], v[104:107], v[44:47]
ds_read_b128 v[188:191], v204 offset:384
v_mfma_f32_16x16x32_bf16 v[44:47], v[72:75], v[100:103], v[44:47]
v_mfma_f32_16x16x32_bf16 v[44:47], v[76:79], v[96:99], v[44:47]
v_mfma_f32_16x16x32_bf16 v[40:43], v[64:67], v[104:107], v[40:43]
buffer_load_dwordx4 a[92:95], v30, s[32:35], s55 offen offset:1024 sc1
v_mfma_f32_16x16x32_bf16 v[40:43], v[68:71], v[100:103], v[40:43]
v_mfma_f32_16x16x32_bf16 v[40:43], v[72:75], v[96:99], v[40:43]
v_mfma_f32_16x16x32_bf16 v[36:39], v[64:67], v[100:103], v[36:39]
v_mfma_f32_16x16x32_bf16 v[36:39], v[68:71], v[96:99], v[36:39]
v_mfma_f32_16x16x32_bf16 v[32:35], v[64:67], v[96:99], v[32:35]
s_waitcnt lgkmcnt(0)
v_mfma_f32_16x16x32_bf16 v[60:63], v[128:131], v[188:191], v[60:63]
ds_read_b64 v[64:65], v203 offset:448
buffer_load_dwordx4 a[96:99], v28, s[32:35], s52 offen offset:0 sc1
v_mfma_f32_16x16x32_bf16 v[60:63], v[132:135], v[184:187], v[60:63]
ds_read_b64 v[66:67], v203 offset:456
v_mfma_f32_16x16x32_bf16 v[60:63], v[136:139], v[180:183], v[60:63]
ds_read_b128 v[96:99], v204 offset:4032
buffer_load_dwordx4 a[100:103], v28, s[32:35], s53 offen offset:0 sc1
v_mfma_f32_16x16x32_bf16 v[60:63], v[140:143], v[176:179], v[60:63]
ds_read_b64 v[68:69], v203 offset:960
v_mfma_f32_16x16x32_bf16 v[60:63], v[144:147], v[172:175], v[60:63]
ds_read_b64 v[70:71], v203 offset:968
v_mfma_f32_16x16x32_bf16 v[60:63], v[148:151], v[168:171], v[60:63]
buffer_load_dwordx4 a[104:107], v28, s[32:35], s54 offen offset:0 sc1
v_mfma_f32_16x16x32_bf16 v[60:63], v[152:155], v[164:167], v[60:63]
ds_read_b128 v[100:103], v204 offset:3520
v_mfma_f32_16x16x32_bf16 v[60:63], v[156:159], v[160:163], v[60:63]
ds_read_b64 v[72:73], v203 offset:1472
v_mfma_f32_16x16x32_bf16 v[56:59], v[128:131], v[184:187], v[56:59]
ds_read_b64 v[74:75], v203 offset:1480
buffer_load_dwordx4 a[108:111], v28, s[32:35], s55 offen offset:0 sc1
v_mfma_f32_16x16x32_bf16 v[56:59], v[132:135], v[180:183], v[56:59]
ds_read_b128 v[104:107], v204 offset:3008
v_mfma_f32_16x16x32_bf16 v[56:59], v[136:139], v[176:179], v[56:59]
ds_read_b64 v[76:77], v203 offset:1984
v_mfma_f32_16x16x32_bf16 v[56:59], v[140:143], v[172:175], v[56:59]
buffer_load_dwordx4 a[112:115], v28, s[32:35], s52 offen offset:1024 sc1
v_mfma_f32_16x16x32_bf16 v[56:59], v[144:147], v[168:171], v[56:59]
ds_read_b64 v[78:79], v203 offset:1992
v_mfma_f32_16x16x32_bf16 v[56:59], v[148:151], v[164:167], v[56:59]
ds_read_b128 v[108:111], v204 offset:2496
v_mfma_f32_16x16x32_bf16 v[56:59], v[152:155], v[160:163], v[56:59]
ds_read_b64 v[80:81], v203 offset:2496
buffer_load_dwordx4 a[116:119], v28, s[32:35], s53 offen offset:1024 sc1
v_mfma_f32_16x16x32_bf16 v[52:55], v[128:131], v[180:183], v[52:55]
ds_read_b64 v[82:83], v203 offset:2504
v_mfma_f32_16x16x32_bf16 v[52:55], v[132:135], v[176:179], v[52:55]
ds_read_b128 v[112:115], v204 offset:1984
v_mfma_f32_16x16x32_bf16 v[52:55], v[136:139], v[172:175], v[52:55]
buffer_load_dwordx4 a[120:123], v28, s[32:35], s54 offen offset:1024 sc1
v_mfma_f32_16x16x32_bf16 v[52:55], v[140:143], v[168:171], v[52:55]
ds_read_b64 v[84:85], v203 offset:3008
v_mfma_f32_16x16x32_bf16 v[52:55], v[144:147], v[164:167], v[52:55]
ds_read_b64 v[86:87], v203 offset:3016
v_mfma_f32_16x16x32_bf16 v[52:55], v[148:151], v[160:163], v[52:55]
ds_read_b128 v[116:119], v204 offset:1472
buffer_load_dwordx4 a[124:127], v28, s[32:35], s55 offen offset:1024 sc1
v_mfma_f32_16x16x32_bf16 v[48:51], v[128:131], v[176:179], v[48:51]
ds_read_b64 v[88:89], v203 offset:3520
v_mfma_f32_16x16x32_bf16 v[48:51], v[132:135], v[172:175], v[48:51]
ds_read_b64 v[90:91], v203 offset:3528
v_mfma_f32_16x16x32_bf16 v[48:51], v[136:139], v[168:171], v[48:51]
buffer_load_dwordx4 a[128:131], v30, s[32:35], s52 offen offset:2048 sc1
v_mfma_f32_16x16x32_bf16 v[48:51], v[140:143], v[164:167], v[48:51]
ds_read_b128 v[120:123], v204 offset:960
v_mfma_f32_16x16x32_bf16 v[48:51], v[144:147], v[160:163], v[48:51]
ds_read_b64 v[92:93], v203 offset:4032
v_mfma_f32_16x16x32_bf16 v[44:47], v[128:131], v[172:175], v[44:47]
ds_read_b64 v[94:95], v203 offset:4040
buffer_load_dwordx4 a[132:135], v30, s[32:35], s53 offen offset:2048 sc1
v_mfma_f32_16x16x32_bf16 v[44:47], v[132:135], v[168:171], v[44:47]
ds_read_b128 v[124:127], v204 offset:448
v_mfma_f32_16x16x32_bf16 v[44:47], v[136:139], v[164:167], v[44:47]
v_mfma_f32_16x16x32_bf16 v[44:47], v[140:143], v[160:163], v[44:47]
buffer_load_dwordx4 a[136:139], v30, s[32:35], s54 offen offset:2048 sc1
v_mfma_f32_16x16x32_bf16 v[40:43], v[128:131], v[168:171], v[40:43]
v_mfma_f32_16x16x32_bf16 v[40:43], v[132:135], v[164:167], v[40:43]
v_mfma_f32_16x16x32_bf16 v[40:43], v[136:139], v[160:163], v[40:43]
buffer_load_dwordx4 a[140:143], v30, s[32:35], s55 offen offset:2048 sc1
v_mfma_f32_16x16x32_bf16 v[36:39], v[128:131], v[164:167], v[36:39]
v_mfma_f32_16x16x32_bf16 v[36:39], v[132:135], v[160:163], v[36:39]
v_mfma_f32_16x16x32_bf16 v[32:35], v[128:131], v[160:163], v[32:35]
s_waitcnt lgkmcnt(0)
v_mfma_f32_16x16x32_bf16 v[60:63], v[64:67], v[124:127], v[60:63]
ds_read_b128 v[156:159], v206 offset:0
buffer_load_dwordx4 a[144:147], v30, s[32:35], s52 offen offset:3072 sc1
s_mov_b32 s58, 0x55555555
s_mov_b32 s59, 0x55555555
v_mfma_f32_16x16x32_bf16 v[60:63], v[68:71], v[120:123], v[60:63]
ds_read_b128 v[152:155], v206 offset:512
v_mfma_f32_16x16x32_bf16 v[60:63], v[72:75], v[116:119], v[60:63]
ds_read_b128 v[148:151], v206 offset:1024
v_mfma_f32_16x16x32_bf16 v[60:63], v[76:79], v[112:115], v[60:63]
ds_read_b128 v[144:147], v206 offset:1536
v_mfma_f32_16x16x32_bf16 v[60:63], v[80:83], v[108:111], v[60:63]
ds_read_b128 v[140:143], v206 offset:2048
v_mfma_f32_16x16x32_bf16 v[60:63], v[84:87], v[104:107], v[60:63]
ds_read_b128 v[136:139], v206 offset:2560
v_mfma_f32_16x16x32_bf16 v[60:63], v[88:91], v[100:103], v[60:63]
ds_read_b128 v[132:135], v206 offset:3072
v_mfma_f32_16x16x32_bf16 v[60:63], v[92:95], v[96:99], v[60:63]
ds_read_b128 v[128:131], v206 offset:3584
v_mfma_f32_16x16x32_bf16 v[56:59], v[64:67], v[120:123], v[56:59]
buffer_load_dwordx4 a[148:151], v30, s[32:35], s53 offen offset:3072 sc1
v_mfma_f32_16x16x32_bf16 v[56:59], v[68:71], v[116:119], v[56:59]
v_mfma_f32_16x16x32_bf16 v[56:59], v[72:75], v[112:115], v[56:59]
v_mfma_f32_16x16x32_bf16 v[56:59], v[76:79], v[108:111], v[56:59]
v_mfma_f32_16x16x32_bf16 v[56:59], v[80:83], v[104:107], v[56:59]
v_mfma_f32_16x16x32_bf16 v[56:59], v[84:87], v[100:103], v[56:59]
s_waitcnt lgkmcnt(0)
v_mfma_f32_16x16x32_bf16 v[56:59], v[88:91], v[96:99], v[56:59]
v_lshlrev_b32 v156, 16, v156
v_lshlrev_b32 v157, 16, v157
v_mfma_f32_16x16x32_bf16 v[52:55], v[64:67], v[116:119], v[52:55]
v_lshlrev_b32 v158, 16, v158
v_lshlrev_b32 v159, 16, v159
v_mfma_f32_16x16x32_bf16 v[52:55], v[68:71], v[112:115], v[52:55]
v_fmac_f32 v60, v159, v21
v_fmac_f32 v61, v158, v21
v_mfma_f32_16x16x32_bf16 v[52:55], v[72:75], v[108:111], v[52:55]
buffer_load_dwordx4 a[152:155], v30, s[32:35], s54 offen offset:3072 sc1
v_fmac_f32 v62, v157, v21
v_mfma_f32_16x16x32_bf16 v[52:55], v[76:79], v[104:107], v[52:55]
v_fmac_f32 v63, v156, v21
s_mov_b64 vcc, s[58:59]
v_mfma_f32_16x16x32_bf16 v[52:55], v[80:83], v[100:103], v[52:55]
s_nop 0
v_cndmask_b32_dpp v188, v62, v60, vcc quad_perm:[1,0,3,2] row_mask:0xf bank_mask:0xf
v_mfma_f32_16x16x32_bf16 v[52:55], v[84:87], v[96:99], v[52:55]
v_cndmask_b32_dpp v190, v63, v61, vcc quad_perm:[1,0,3,2] row_mask:0xf bank_mask:0xf
s_not_b64 vcc, vcc
v_mfma_f32_16x16x32_bf16 v[48:51], v[64:67], v[112:115], v[48:51]
v_cndmask_b32_dpp v189, v60, v62, vcc quad_perm:[1,0,3,2] row_mask:0xf bank_mask:0xf
v_cndmask_b32_dpp v191, v61, v63, vcc quad_perm:[1,0,3,2] row_mask:0xf bank_mask:0xf
v_mfma_f32_16x16x32_bf16 v[48:51], v[68:71], v[108:111], v[48:51]
v_cvt_pk_bf16_f32 v188, v188, v189
v_cvt_pk_bf16_f32 v189, v190, v191
buffer_store_dwordx2 v[188:189], v205, s[32:35], s49 offen offset:3584 sc1
v_mfma_f32_16x16x32_bf16 v[48:51], v[72:75], v[104:107], v[48:51]
v_lshlrev_b32 v152, 16, v152
v_lshlrev_b32 v153, 16, v153
v_mfma_f32_16x16x32_bf16 v[48:51], v[76:79], v[100:103], v[48:51]
v_lshlrev_b32 v154, 16, v154
v_mfma_f32_16x16x32_bf16 v[48:51], v[80:83], v[96:99], v[48:51]
v_lshlrev_b32 v155, 16, v155
v_fmac_f32 v56, v155, v21
v_mfma_f32_16x16x32_bf16 v[44:47], v[64:67], v[108:111], v[44:47]
buffer_load_dwordx4 a[156:159], v30, s[32:35], s55 offen offset:3072 sc1
v_fmac_f32 v57, v154, v21
v_mfma_f32_16x16x32_bf16 v[44:47], v[68:71], v[104:107], v[44:47]
v_fmac_f32 v58, v153, v21
v_mfma_f32_16x16x32_bf16 v[44:47], v[72:75], v[100:103], v[44:47]
v_fmac_f32 v59, v152, v21
s_mov_b64 vcc, s[58:59]
v_mfma_f32_16x16x32_bf16 v[44:47], v[76:79], v[96:99], v[44:47]
s_nop 0
v_mfma_f32_16x16x32_bf16 v[40:43], v[64:67], v[104:107], v[40:43]
v_cndmask_b32_dpp v184, v58, v56, vcc quad_perm:[1,0,3,2] row_mask:0xf bank_mask:0xf
v_cndmask_b32_dpp v186, v59, v57, vcc quad_perm:[1,0,3,2] row_mask:0xf bank_mask:0xf
v_mfma_f32_16x16x32_bf16 v[40:43], v[68:71], v[100:103], v[40:43]
s_not_b64 vcc, vcc
v_mfma_f32_16x16x32_bf16 v[40:43], v[72:75], v[96:99], v[40:43]
v_cndmask_b32_dpp v185, v56, v58, vcc quad_perm:[1,0,3,2] row_mask:0xf bank_mask:0xf
v_mfma_f32_16x16x32_bf16 v[36:39], v[64:67], v[100:103], v[36:39]
v_cndmask_b32_dpp v187, v57, v59, vcc quad_perm:[1,0,3,2] row_mask:0xf bank_mask:0xf
v_cvt_pk_bf16_f32 v184, v184, v185
v_mfma_f32_16x16x32_bf16 v[36:39], v[68:71], v[96:99], v[36:39]
v_cvt_pk_bf16_f32 v185, v186, v187
v_mfma_f32_16x16x32_bf16 v[32:35], v[64:67], v[96:99], v[32:35]
buffer_store_dwordx2 v[184:185], v205, s[32:35], s49 offen offset:3072 sc1
v_lshlrev_b32 v148, 16, v148
v_lshlrev_b32 v149, 16, v149
v_lshlrev_b32 v150, 16, v150
v_lshlrev_b32 v151, 16, v151
v_fmac_f32 v52, v151, v21
v_fmac_f32 v53, v150, v21
v_fmac_f32 v54, v149, v21
v_fmac_f32 v55, v148, v21
s_mov_b64 vcc, s[58:59]
s_nop 0
v_cndmask_b32_dpp v180, v54, v52, vcc quad_perm:[1,0,3,2] row_mask:0xf bank_mask:0xf
v_cndmask_b32_dpp v182, v55, v53, vcc quad_perm:[1,0,3,2] row_mask:0xf bank_mask:0xf
s_not_b64 vcc, vcc
v_cndmask_b32_dpp v181, v52, v54, vcc quad_perm:[1,0,3,2] row_mask:0xf bank_mask:0xf
v_cndmask_b32_dpp v183, v53, v55, vcc quad_perm:[1,0,3,2] row_mask:0xf bank_mask:0xf
v_cvt_pk_bf16_f32 v180, v180, v181
v_cvt_pk_bf16_f32 v181, v182, v183
buffer_store_dwordx2 v[180:181], v205, s[32:35], s49 offen offset:2560 sc1
v_lshlrev_b32 v144, 16, v144
v_lshlrev_b32 v145, 16, v145
v_lshlrev_b32 v146, 16, v146
v_lshlrev_b32 v147, 16, v147
v_fmac_f32 v48, v147, v21
v_fmac_f32 v49, v146, v21
v_fmac_f32 v50, v145, v21
v_fmac_f32 v51, v144, v21
s_mov_b64 vcc, s[58:59]
s_nop 0
v_cndmask_b32_dpp v176, v50, v48, vcc quad_perm:[1,0,3,2] row_mask:0xf bank_mask:0xf
v_cndmask_b32_dpp v178, v51, v49, vcc quad_perm:[1,0,3,2] row_mask:0xf bank_mask:0xf
s_not_b64 vcc, vcc
v_cndmask_b32_dpp v177, v48, v50, vcc quad_perm:[1,0,3,2] row_mask:0xf bank_mask:0xf
v_cndmask_b32_dpp v179, v49, v51, vcc quad_perm:[1,0,3,2] row_mask:0xf bank_mask:0xf
v_cvt_pk_bf16_f32 v176, v176, v177
v_cvt_pk_bf16_f32 v177, v178, v179
buffer_store_dwordx2 v[176:177], v205, s[32:35], s49 offen offset:2048 sc1
v_lshlrev_b32 v140, 16, v140
v_lshlrev_b32 v141, 16, v141
v_lshlrev_b32 v142, 16, v142
v_lshlrev_b32 v143, 16, v143
v_fmac_f32 v44, v143, v21
v_fmac_f32 v45, v142, v21
v_fmac_f32 v46, v141, v21
v_fmac_f32 v47, v140, v21
s_mov_b64 vcc, s[58:59]
s_nop 0
v_cndmask_b32_dpp v172, v46, v44, vcc quad_perm:[1,0,3,2] row_mask:0xf bank_mask:0xf
v_cndmask_b32_dpp v174, v47, v45, vcc quad_perm:[1,0,3,2] row_mask:0xf bank_mask:0xf
s_not_b64 vcc, vcc
v_cndmask_b32_dpp v173, v44, v46, vcc quad_perm:[1,0,3,2] row_mask:0xf bank_mask:0xf
v_cndmask_b32_dpp v175, v45, v47, vcc quad_perm:[1,0,3,2] row_mask:0xf bank_mask:0xf
v_cvt_pk_bf16_f32 v172, v172, v173
v_cvt_pk_bf16_f32 v173, v174, v175
buffer_store_dwordx2 v[172:173], v205, s[32:35], s49 offen offset:1536 sc1
v_lshlrev_b32 v136, 16, v136
v_lshlrev_b32 v137, 16, v137
v_lshlrev_b32 v138, 16, v138
v_lshlrev_b32 v139, 16, v139
v_fmac_f32 v40, v139, v21
v_fmac_f32 v41, v138, v21
v_fmac_f32 v42, v137, v21
v_fmac_f32 v43, v136, v21
s_mov_b64 vcc, s[58:59]
s_nop 0
v_cndmask_b32_dpp v168, v42, v40, vcc quad_perm:[1,0,3,2] row_mask:0xf bank_mask:0xf
v_cndmask_b32_dpp v170, v43, v41, vcc quad_perm:[1,0,3,2] row_mask:0xf bank_mask:0xf
s_not_b64 vcc, vcc
v_cndmask_b32_dpp v169, v40, v42, vcc quad_perm:[1,0,3,2] row_mask:0xf bank_mask:0xf
v_cndmask_b32_dpp v171, v41, v43, vcc quad_perm:[1,0,3,2] row_mask:0xf bank_mask:0xf
v_cvt_pk_bf16_f32 v168, v168, v169
v_cvt_pk_bf16_f32 v169, v170, v171
buffer_store_dwordx2 v[168:169], v205, s[32:35], s49 offen offset:1024 sc1
v_lshlrev_b32 v132, 16, v132
v_lshlrev_b32 v133, 16, v133
v_lshlrev_b32 v134, 16, v134
v_lshlrev_b32 v135, 16, v135
v_fmac_f32 v36, v135, v21
v_fmac_f32 v37, v134, v21
v_fmac_f32 v38, v133, v21
v_fmac_f32 v39, v132, v21
s_mov_b64 vcc, s[58:59]
s_nop 0
v_cndmask_b32_dpp v164, v38, v36, vcc quad_perm:[1,0,3,2] row_mask:0xf bank_mask:0xf
v_cndmask_b32_dpp v166, v39, v37, vcc quad_perm:[1,0,3,2] row_mask:0xf bank_mask:0xf
s_not_b64 vcc, vcc
v_cndmask_b32_dpp v165, v36, v38, vcc quad_perm:[1,0,3,2] row_mask:0xf bank_mask:0xf
v_cndmask_b32_dpp v167, v37, v39, vcc quad_perm:[1,0,3,2] row_mask:0xf bank_mask:0xf
v_cvt_pk_bf16_f32 v164, v164, v165
v_cvt_pk_bf16_f32 v165, v166, v167
buffer_store_dwordx2 v[164:165], v205, s[32:35], s49 offen offset:512 sc1
v_lshlrev_b32 v128, 16, v128
v_lshlrev_b32 v129, 16, v129
v_lshlrev_b32 v130, 16, v130
v_lshlrev_b32 v131, 16, v131
v_fmac_f32 v32, v131, v21
v_fmac_f32 v33, v130, v21
v_fmac_f32 v34, v129, v21
v_fmac_f32 v35, v128, v21
s_mov_b64 vcc, s[58:59]
s_nop 0
v_cndmask_b32_dpp v160, v34, v32, vcc quad_perm:[1,0,3,2] row_mask:0xf bank_mask:0xf
v_cndmask_b32_dpp v162, v35, v33, vcc quad_perm:[1,0,3,2] row_mask:0xf bank_mask:0xf
s_not_b64 vcc, vcc
v_cndmask_b32_dpp v161, v32, v34, vcc quad_perm:[1,0,3,2] row_mask:0xf bank_mask:0xf
v_cndmask_b32_dpp v163, v33, v35, vcc quad_perm:[1,0,3,2] row_mask:0xf bank_mask:0xf
v_cvt_pk_bf16_f32 v160, v160, v161
v_cvt_pk_bf16_f32 v161, v162, v163
buffer_store_dwordx2 v[160:161], v205, s[32:35], s49 offen offset:0 sc1
s_waitcnt vmcnt(42)
s_barrier
ds_read_b64_tr_b16 v[32:33], v2 offset:0
ds_read_b64_tr_b16 v[34:35], v2 offset:4608
ds_read_b64_tr_b16 v[36:37], v2 offset:18432
ds_read_b64_tr_b16 v[38:39], v2 offset:23040
ds_read_b64_tr_b16 v[40:41], v2 offset:32
ds_read_b64_tr_b16 v[42:43], v2 offset:4640
ds_read_b64_tr_b16 v[44:45], v2 offset:18464
ds_read_b64_tr_b16 v[46:47], v2 offset:23072
s_waitcnt vmcnt(63)
s_waitcnt lgkmcnt(4)
v_mfma_f32_16x16x32_bf16 v[64:67], v[32:35], v[224:227], 0
ds_read_b64_tr_b16 v[48:49], v2 offset:64
s_lshl_b32 s43, s40, 2
v_mfma_f32_16x16x32_bf16 v[64:67], v[36:39], v[240:243], v[64:67]
ds_read_b64_tr_b16 v[50:51], v2 offset:4672
v_mfma_f32_16x16x32_bf16 v[100:103], v[36:39], v[244:247], 0
ds_read_b64_tr_b16 v[52:53], v2 offset:18496
s_add_u32 s43, s43, s41
v_mfma_f32_16x16x32_bf16 v[100:103], v[32:35], v[228:231], v[100:103]
ds_read_b64_tr_b16 v[54:55], v2 offset:23104
v_mfma_f32_16x16x32_bf16 v[136:139], v[32:35], v[232:235], 0
s_add_u32 s66, s64, 368640
s_add_u32 s66, s66, s63
s_add_u32 m0, s65, 73728
v_mfma_f32_16x16x32_bf16 v[136:139], v[36:39], v[248:251], v[136:139]
s_mul_i32 s45, s42, 144
buffer_load_dwordx4 v8, s[16:19], s66 offen offset:0 lds
v_mfma_f32_16x16x32_bf16 v[172:175], v[36:39], v[252:255], 0
v_mfma_f32_16x16x32_bf16 v[172:175], v[32:35], v[236:239], v[172:175]
s_waitcnt lgkmcnt(4)
v_mfma_f32_16x16x32_bf16 v[68:71], v[40:43], v[224:227], 0
ds_read_b64_tr_b16 v[32:33], v2 offset:96
v_mfma_f32_16x16x32_bf16 v[68:71], v[44:47], v[240:243], v[68:71]
ds_read_b64_tr_b16 v[34:35], v2 offset:4704
v_mfma_f32_16x16x32_bf16 v[104:107], v[44:47], v[244:247], 0
ds_read_b64_tr_b16 v[36:37], v2 offset:18528
buffer_load_dwordx4 v9, s[16:19], s66 offen offset:1024 lds
v_mfma_f32_16x16x32_bf16 v[104:107], v[40:43], v[228:231], v[104:107]
ds_read_b64_tr_b16 v[38:39], v2 offset:23136
v_mfma_f32_16x16x32_bf16 v[140:143], v[40:43], v[232:235], 0
s_cmp_lt_u32 s14, 3
s_cselect_b32 s61, 0, 2146435072
v_mfma_f32_16x16x32_bf16 v[140:143], v[44:47], v[248:251], v[140:143]
s_mul_i32 s50, s14, 3072
s_mul_i32 s100, s42, 288
v_mfma_f32_16x16x32_bf16 v[176:179], v[44:47], v[252:255], 0
v_mfma_f32_16x16x32_bf16 v[176:179], v[40:43], v[236:239], v[176:179]
buffer_load_dwordx4 v10, s[16:19], s66 offen offset:2048 lds
s_waitcnt lgkmcnt(4)
v_mfma_f32_16x16x32_bf16 v[72:75], v[48:51], v[224:227], 0
ds_read_b64_tr_b16 v[40:41], v2 offset:128
s_add_u32 s100, s100, 63045632
v_mfma_f32_16x16x32_bf16 v[72:75], v[52:55], v[240:243], v[72:75]
ds_read_b64_tr_b16 v[42:43], v2 offset:4736
v_mfma_f32_16x16x32_bf16 v[108:111], v[52:55], v[244:247], 0
ds_read_b64_tr_b16 v[44:45], v2 offset:18560
v_mfma_f32_16x16x32_bf16 v[108:111], v[48:51], v[228:231], v[108:111]
ds_read_b64_tr_b16 v[46:47], v2 offset:23168
s_lshl_b32 s58, s2, 3
v_mfma_f32_16x16x32_bf16 v[144:147], v[48:51], v[232:235], 0
v_mfma_f32_16x16x32_bf16 v[144:147], v[52:55], v[248:251], v[144:147]
buffer_load_dwordx4 v11, s[16:19], s66 offen offset:3072 lds
v_mfma_f32_16x16x32_bf16 v[180:183], v[52:55], v[252:255], 0
s_add_u32 s58, s58, 63044736
v_mfma_f32_16x16x32_bf16 v[180:183], v[48:51], v[236:239], v[180:183]
s_waitcnt lgkmcnt(4)
v_mfma_f32_16x16x32_bf16 v[76:79], v[32:35], v[224:227], 0
ds_read_b64_tr_b16 v[48:49], v2 offset:160
v_mfma_f32_16x16x32_bf16 v[76:79], v[36:39], v[240:243], v[76:79]
ds_read_b64_tr_b16 v[50:51], v2 offset:4768
v_mfma_f32_16x16x32_bf16 v[112:115], v[36:39], v[244:247], 0
ds_read_b64_tr_b16 v[52:53], v2 offset:18592
s_add_u32 m0, s65, 77824
v_mfma_f32_16x16x32_bf16 v[112:115], v[32:35], v[228:231], v[112:115]
ds_read_b64_tr_b16 v[54:55], v2 offset:23200
v_mfma_f32_16x16x32_bf16 v[148:151], v[32:35], v[232:235], 0
s_cmp_eq_u32 s14, 0
s_cselect_b32 s59, s62, 2146435072
v_mfma_f32_16x16x32_bf16 v[148:151], v[36:39], v[248:251], v[148:151]
s_add_u32 s101, s58, s59
v_mfma_f32_16x16x32_bf16 v[184:187], v[36:39], v[252:255], 0
s_mov_b32 s36, s68
v_mfma_f32_16x16x32_bf16 v[184:187], v[32:35], v[236:239], v[184:187]
buffer_load_dwordx4 v12, s[16:19], s66 offen offset:0 lds
s_waitcnt lgkmcnt(4)
v_mfma_f32_16x16x32_bf16 v[80:83], v[40:43], v[224:227], 0
ds_read_b64_tr_b16 v[32:33], v2 offset:192
v_mfma_f32_16x16x32_bf16 v[80:83], v[44:47], v[240:243], v[80:83]
ds_read_b64_tr_b16 v[34:35], v2 offset:4800
s_mov_b32 s37, s69
v_mfma_f32_16x16x32_bf16 v[116:119], v[44:47], v[244:247], 0
ds_read_b64_tr_b16 v[36:37], v2 offset:18624
v_mfma_f32_16x16x32_bf16 v[116:119], v[40:43], v[228:231], v[116:119]
ds_read_b64_tr_b16 v[38:39], v2 offset:23232
s_mov_b32 s38, 2359296
v_mfma_f32_16x16x32_bf16 v[152:155], v[40:43], v[232:235], 0
v_mfma_f32_16x16x32_bf16 v[152:155], v[44:47], v[248:251], v[152:155]
buffer_load_dwordx4 v13, s[16:19], s66 offen offset:1024 lds
v_mfma_f32_16x16x32_bf16 v[188:191], v[44:47], v[252:255], 0
s_mov_b32 s39, 0x20000
v_mfma_f32_16x16x32_bf16 v[188:191], v[40:43], v[236:239], v[188:191]
s_waitcnt lgkmcnt(4)
v_mfma_f32_16x16x32_bf16 v[84:87], v[48:51], v[224:227], 0
ds_read_b64_tr_b16 v[40:41], v2 offset:224
v_mfma_f32_16x16x32_bf16 v[84:87], v[52:55], v[240:243], v[84:87]
ds_read_b64_tr_b16 v[42:43], v2 offset:4832
s_mul_i32 s99, s43, 36864
v_mfma_f32_16x16x32_bf16 v[120:123], v[52:55], v[244:247], 0
ds_read_b64_tr_b16 v[44:45], v2 offset:18656
buffer_load_dwordx4 v14, s[16:19], s66 offen offset:2048 lds
v_mfma_f32_16x16x32_bf16 v[120:123], v[48:51], v[228:231], v[120:123]
ds_read_b64_tr_b16 v[46:47], v2 offset:23264
v_mfma_f32_16x16x32_bf16 v[156:159], v[48:51], v[232:235], 0
s_lshl_b32 s58, s45, 1
v_mfma_f32_16x16x32_bf16 v[156:159], v[52:55], v[248:251], v[156:159]
v_mfma_f32_16x16x32_bf16 v[192:195], v[52:55], v[252:255], 0
s_add_u32 s99, s99, s58
v_mfma_f32_16x16x32_bf16 v[192:195], v[48:51], v[236:239], v[192:195]
buffer_load_dwordx4 v15, s[16:19], s66 offen offset:3072 lds
s_waitcnt lgkmcnt(4)
v_mfma_f32_16x16x32_bf16 v[88:91], v[32:35], v[224:227], 0
ds_read_b64_tr_b16 v[48:49], v2 offset:256
v_mfma_f32_16x16x32_bf16 v[88:91], v[36:39], v[240:243], v[88:91]
ds_read_b64_tr_b16 v[50:51], v2 offset:4864
v_min_u32 v6, 35, v1
v_mfma_f32_16x16x32_bf16 v[124:127], v[36:39], v[244:247], 0
ds_read_b64_tr_b16 v[52:53], v2 offset:18688
v_mfma_f32_16x16x32_bf16 v[124:127], v[32:35], v[228:231], v[124:127]
ds_read_b64_tr_b16 v[54:55], v2 offset:23296
v_mfma_f32_16x16x32_bf16 v[160:163], v[32:35], v[232:235], 0
v_lshlrev_b32 v6, 3, v6
v_mfma_f32_16x16x32_bf16 v[160:163], v[36:39], v[248:251], v[160:163]
s_add_u32 m0, s65, 81920
v_mfma_f32_16x16x32_bf16 v[196:199], v[36:39], v[252:255], 0
v_mfma_f32_16x16x32_bf16 v[196:199], v[32:35], v[236:239], v[196:199]
s_waitcnt lgkmcnt(4)
v_mfma_f32_16x16x32_bf16 v[92:95], v[40:43], v[224:227], 0
s_waitcnt vmcnt(36)
s_barrier
v_mfma_f32_16x16x32_bf16 v[92:95], v[44:47], v[240:243], v[92:95]
ds_read_b64_tr_b16 v[32:33], v3 offset:0
STUB_g6:
s_cbranch_execz NEXT_g6
v_mfma_f32_16x16x32_bf16 v[128:131], v[44:47], v[244:247], 0
ds_read_b64_tr_b16 v[34:35], v3 offset:4608
buffer_load_dwordx4 v16, s[16:19], s66 offen offset:0 lds
v_mfma_f32_16x16x32_bf16 v[128:131], v[40:43], v[228:231], v[128:131]
ds_read_b64_tr_b16 v[36:37], v3 offset:18432
v_mfma_f32_16x16x32_bf16 v[164:167], v[40:43], v[232:235], 0
ds_read_b64_tr_b16 v[38:39], v3 offset:23040
v_mfma_f32_16x16x32_bf16 v[164:167], v[44:47], v[248:251], v[164:167]
v_mfma_f32_16x16x32_bf16 v[200:203], v[44:47], v[252:255], 0
v_mfma_f32_16x16x32_bf16 v[200:203], v[40:43], v[236:239], v[200:203]
buffer_load_dwordx2 v[22:23], v19, s[32:35], s51 offen sc1
s_waitcnt lgkmcnt(4)
v_mfma_f32_16x16x32_bf16 v[96:99], v[48:51], v[224:227], 0
ds_read_b64_tr_b16 v[40:41], v3 offset:32
v_mfma_f32_16x16x32_bf16 v[96:99], v[52:55], v[240:243], v[96:99]
ds_read_b64_tr_b16 v[42:43], v3 offset:4640
v_mfma_f32_16x16x32_bf16 v[132:135], v[52:55], v[244:247], 0
ds_read_b64_tr_b16 v[44:45], v3 offset:18464
v_mfma_f32_16x16x32_bf16 v[132:135], v[48:51], v[228:231], v[132:135]
ds_read_b64_tr_b16 v[46:47], v3 offset:23072
v_mfma_f32_16x16x32_bf16 v[168:171], v[48:51], v[232:235], 0
v_mfma_f32_16x16x32_bf16 v[168:171], v[52:55], v[248:251], v[168:171]
v_mfma_f32_16x16x32_bf16 v[204:207], v[52:55], v[252:255], 0
v_mfma_f32_16x16x32_bf16 v[204:207], v[48:51], v[236:239], v[204:207]
s_waitcnt lgkmcnt(4)
s_waitcnt vmcnt(61)
v_mfma_f32_16x16x32_bf16 v[64:67], v[32:35], a[0:3], v[64:67]
ds_read_b64_tr_b16 v[48:49], v3 offset:64
v_mfma_f32_16x16x32_bf16 v[64:67], v[36:39], a[16:19], v[64:67]
ds_read_b64_tr_b16 v[50:51], v3 offset:4672
v_mfma_f32_16x16x32_bf16 v[100:103], v[36:39], a[20:23], v[100:103]
ds_read_b64_tr_b16 v[52:53], v3 offset:18496
v_mfma_f32_16x16x32_bf16 v[100:103], v[32:35], a[4:7], v[100:103]
ds_read_b64_tr_b16 v[54:55], v3 offset:23104
v_mfma_f32_16x16x32_bf16 v[136:139], v[32:35], a[8:11], v[136:139]
s_add_u32 s66, s64, 442368
s_add_u32 s66, s66, s63
s_add_u32 m0, s65, 110592
v_mfma_f32_16x16x32_bf16 v[136:139], v[36:39], a[24:27], v[136:139]
buffer_load_dwordx4 v8, s[16:19], s66 offen offset:0 lds
v_mfma_f32_16x16x32_bf16 v[172:175], v[36:39], a[28:31], v[172:175]
v_mfma_f32_16x16x32_bf16 v[172:175], v[32:35], a[12:15], v[172:175]
s_waitcnt lgkmcnt(4)
v_mfma_f32_16x16x32_bf16 v[68:71], v[40:43], a[0:3], v[68:71]
ds_read_b64_tr_b16 v[32:33], v3 offset:96
v_mfma_f32_16x16x32_bf16 v[68:71], v[44:47], a[16:19], v[68:71]
ds_read_b64_tr_b16 v[34:35], v3 offset:4704
v_mfma_f32_16x16x32_bf16 v[104:107], v[44:47], a[20:23], v[104:107]
ds_read_b64_tr_b16 v[36:37], v3 offset:18528
v_mfma_f32_16x16x32_bf16 v[104:107], v[40:43], a[4:7], v[104:107]
ds_read_b64_tr_b16 v[38:39], v3 offset:23136
buffer_load_dwordx4 v9, s[16:19], s66 offen offset:1024 lds
v_mfma_f32_16x16x32_bf16 v[140:143], v[40:43], a[8:11], v[140:143]
v_mfma_f32_16x16x32_bf16 v[140:143], v[44:47], a[24:27], v[140:143]
v_mfma_f32_16x16x32_bf16 v[176:179], v[44:47], a[28:31], v[176:179]
v_mfma_f32_16x16x32_bf16 v[176:179], v[40:43], a[12:15], v[176:179]
s_waitcnt lgkmcnt(4)
v_mfma_f32_16x16x32_bf16 v[72:75], v[48:51], a[0:3], v[72:75]
ds_read_b64_tr_b16 v[40:41], v3 offset:128
v_mfma_f32_16x16x32_bf16 v[72:75], v[52:55], a[16:19], v[72:75]
ds_read_b64_tr_b16 v[42:43], v3 offset:4736
buffer_load_dwordx4 v10, s[16:19], s66 offen offset:2048 lds
v_mfma_f32_16x16x32_bf16 v[108:111], v[52:55], a[20:23], v[108:111]
ds_read_b64_tr_b16 v[44:45], v3 offset:18560
v_mfma_f32_16x16x32_bf16 v[108:111], v[48:51], a[4:7], v[108:111]
ds_read_b64_tr_b16 v[46:47], v3 offset:23168
v_mfma_f32_16x16x32_bf16 v[144:147], v[48:51], a[8:11], v[144:147]
v_mfma_f32_16x16x32_bf16 v[144:147], v[52:55], a[24:27], v[144:147]
v_mfma_f32_16x16x32_bf16 v[180:183], v[52:55], a[28:31], v[180:183]
v_mfma_f32_16x16x32_bf16 v[180:183], v[48:51], a[12:15], v[180:183]
buffer_load_dwordx4 v11, s[16:19], s66 offen offset:3072 lds
s_waitcnt lgkmcnt(4)
v_mfma_f32_16x16x32_bf16 v[76:79], v[32:35], a[0:3], v[76:79]
ds_read_b64_tr_b16 v[48:49], v3 offset:160
v_mfma_f32_16x16x32_bf16 v[76:79], v[36:39], a[16:19], v[76:79]
ds_read_b64_tr_b16 v[50:51], v3 offset:4768
v_mfma_f32_16x16x32_bf16 v[112:115], v[36:39], a[20:23], v[112:115]
ds_read_b64_tr_b16 v[52:53], v3 offset:18592
v_mfma_f32_16x16x32_bf16 v[112:115], v[32:35], a[4:7], v[112:115]
ds_read_b64_tr_b16 v[54:55], v3 offset:23200
v_mfma_f32_16x16x32_bf16 v[148:151], v[32:35], a[8:11], v[148:151]
s_add_u32 m0, s65, 114688
v_mfma_f32_16x16x32_bf16 v[148:151], v[36:39], a[24:27], v[148:151]
v_mfma_f32_16x16x32_bf16 v[184:187], v[36:39], a[28:31], v[184:187]
v_mfma_f32_16x16x32_bf16 v[184:187], v[32:35], a[12:15], v[184:187]
s_waitcnt lgkmcnt(4)
v_mfma_f32_16x16x32_bf16 v[80:83], v[40:43], a[0:3], v[80:83]
ds_read_b64_tr_b16 v[32:33], v3 offset:192
v_mfma_f32_16x16x32_bf16 v[80:83], v[44:47], a[16:19], v[80:83]
ds_read_b64_tr_b16 v[34:35], v3 offset:4800
v_mfma_f32_16x16x32_bf16 v[116:119], v[44:47], a[20:23], v[116:119]
ds_read_b64_tr_b16 v[36:37], v3 offset:18624
buffer_load_dwordx4 v12, s[16:19], s66 offen offset:0 lds
v_mfma_f32_16x16x32_bf16 v[116:119], v[40:43], a[4:7], v[116:119]
ds_read_b64_tr_b16 v[38:39], v3 offset:23232
v_mfma_f32_16x16x32_bf16 v[152:155], v[40:43], a[8:11], v[152:155]
v_mfma_f32_16x16x32_bf16 v[152:155], v[44:47], a[24:27], v[152:155]
v_mfma_f32_16x16x32_bf16 v[188:191], v[44:47], a[28:31], v[188:191]
v_mfma_f32_16x16x32_bf16 v[188:191], v[40:43], a[12:15], v[188:191]
s_waitcnt lgkmcnt(4)
v_mfma_f32_16x16x32_bf16 v[84:87], v[48:51], a[0:3], v[84:87]
ds_read_b64_tr_b16 v[40:41], v3 offset:224
buffer_load_dwordx4 v13, s[16:19], s66 offen offset:1024 lds
v_mfma_f32_16x16x32_bf16 v[84:87], v[52:55], a[16:19], v[84:87]
ds_read_b64_tr_b16 v[42:43], v3 offset:4832
v_mfma_f32_16x16x32_bf16 v[120:123], v[52:55], a[20:23], v[120:123]
ds_read_b64_tr_b16 v[44:45], v3 offset:18656
v_mfma_f32_16x16x32_bf16 v[120:123], v[48:51], a[4:7], v[120:123]
ds_read_b64_tr_b16 v[46:47], v3 offset:23264
v_mfma_f32_16x16x32_bf16 v[156:159], v[48:51], a[8:11], v[156:159]
v_mfma_f32_16x16x32_bf16 v[156:159], v[52:55], a[24:27], v[156:159]
v_mfma_f32_16x16x32_bf16 v[192:195], v[52:55], a[28:31], v[192:195]
buffer_load_dwordx4 v14, s[16:19], s66 offen offset:2048 lds
v_mfma_f32_16x16x32_bf16 v[192:195], v[48:51], a[12:15], v[192:195]
s_waitcnt lgkmcnt(4)
v_mfma_f32_16x16x32_bf16 v[88:91], v[32:35], a[0:3], v[88:91]
ds_read_b64_tr_b16 v[48:49], v3 offset:256
v_mfma_f32_16x16x32_bf16 v[88:91], v[36:39], a[16:19], v[88:91]
ds_read_b64_tr_b16 v[50:51], v3 offset:4864
v_mfma_f32_16x16x32_bf16 v[124:127], v[36:39], a[20:23], v[124:127]
ds_read_b64_tr_b16 v[52:53], v3 offset:18688
v_mfma_f32_16x16x32_bf16 v[124:127], v[32:35], a[4:7], v[124:127]
ds_read_b64_tr_b16 v[54:55], v3 offset:23296
buffer_load_dwordx4 v15, s[16:19], s66 offen offset:3072 lds
v_mfma_f32_16x16x32_bf16 v[160:163], v[32:35], a[8:11], v[160:163]
v_mfma_f32_16x16x32_bf16 v[160:163], v[36:39], a[24:27], v[160:163]
v_mfma_f32_16x16x32_bf16 v[196:199], v[36:39], a[28:31], v[196:199]
v_mfma_f32_16x16x32_bf16 v[196:199], v[32:35], a[12:15], v[196:199]
s_waitcnt lgkmcnt(4)
v_mfma_f32_16x16x32_bf16 v[92:95], v[40:43], a[0:3], v[92:95]
s_waitcnt vmcnt(8)
s_barrier
v_mfma_f32_16x16x32_bf16 v[92:95], v[44:47], a[16:19], v[92:95]
ds_read_b64_tr_b16 v[32:33], v4 offset:0
s_add_u32 m0, s65, 118784
v_mfma_f32_16x16x32_bf16 v[128:131], v[44:47], a[20:23], v[128:131]
ds_read_b64_tr_b16 v[34:35], v4 offset:4608
v_mfma_f32_16x16x32_bf16 v[128:131], v[40:43], a[4:7], v[128:131]
ds_read_b64_tr_b16 v[36:37], v4 offset:18432
v_mfma_f32_16x16x32_bf16 v[164:167], v[40:43], a[8:11], v[164:167]
ds_read_b64_tr_b16 v[38:39], v4 offset:23040
v_mfma_f32_16x16x32_bf16 v[164:167], v[44:47], a[24:27], v[164:167]
s_cmp_ge_u32 s101, 2146435072
s_cbranch_scc1 F4_SKIPc
buffer_store_dwordx2 v[26:27], v25, s[32:35], s101 offen sc1
F4_SKIPc:
v_mfma_f32_16x16x32_bf16 v[200:203], v[44:47], a[28:31], v[200:203]
v_mfma_f32_16x16x32_bf16 v[200:203], v[40:43], a[12:15], v[200:203]
buffer_load_dwordx4 v16, s[16:19], s66 offen offset:0 lds
s_waitcnt lgkmcnt(4)
v_mfma_f32_16x16x32_bf16 v[96:99], v[48:51], a[0:3], v[96:99]
ds_read_b64_tr_b16 v[40:41], v4 offset:32
v_mfma_f32_16x16x32_bf16 v[96:99], v[52:55], a[16:19], v[96:99]
ds_read_b64_tr_b16 v[42:43], v4 offset:4640
v_mfma_f32_16x16x32_bf16 v[132:135], v[52:55], a[20:23], v[132:135]
ds_read_b64_tr_b16 v[44:45], v4 offset:18464
v_mfma_f32_16x16x32_bf16 v[132:135], v[48:51], a[4:7], v[132:135]
ds_read_b64_tr_b16 v[46:47], v4 offset:23072
v_mfma_f32_16x16x32_bf16 v[168:171], v[48:51], a[8:11], v[168:171]
v_cmp_ne_u64 vcc, s[94:95], v[22:23]
s_nop 1
s_cmp_lg_u64 vcc, 0
s_cbranch_scc1 SLOW_F3Cc
BACK_F3Cc:
v_mfma_f32_16x16x32_bf16 v[168:171], v[52:55], a[24:27], v[168:171]
v_mfma_f32_16x16x32_bf16 v[204:207], v[52:55], a[28:31], v[204:207]
v_mfma_f32_16x16x32_bf16 v[204:207], v[48:51], a[12:15], v[204:207]
s_waitcnt lgkmcnt(4)
s_waitcnt vmcnt(43)
v_mfma_f32_16x16x32_bf16 v[64:67], v[32:35], a[32:35], v[64:67]
ds_read_b64_tr_b16 v[48:49], v4 offset:64
buffer_load_dwordx4 a[160:163], v28, s[32:35], s52 offen offset:2048 sc1
v_mfma_f32_16x16x32_bf16 v[64:67], v[36:39], a[48:51], v[64:67]
ds_read_b64_tr_b16 v[50:51], v4 offset:4672
v_mfma_f32_16x16x32_bf16 v[100:103], v[36:39], a[52:55], v[100:103]
ds_read_b64_tr_b16 v[52:53], v4 offset:18496
v_mfma_f32_16x16x32_bf16 v[100:103], v[32:35], a[36:39], v[100:103]
ds_read_b64_tr_b16 v[54:55], v4 offset:23104
v_mfma_f32_16x16x32_bf16 v[136:139], v[32:35], a[40:43], v[136:139]
buffer_load_dwordx4 a[164:167], v28, s[32:35], s53 offen offset:2048 sc1
v_mfma_f32_16x16x32_bf16 v[136:139], v[36:39], a[56:59], v[136:139]
v_mfma_f32_16x16x32_bf16 v[172:175], v[36:39], a[60:63], v[172:175]
v_mfma_f32_16x16x32_bf16 v[172:175], v[32:35], a[44:47], v[172:175]
s_waitcnt lgkmcnt(4)
v_mfma_f32_16x16x32_bf16 v[68:71], v[40:43], a[32:35], v[68:71]
ds_read_b64_tr_b16 v[32:33], v4 offset:96
buffer_load_dwordx4 a[168:171], v28, s[32:35], s54 offen offset:2048 sc1
v_mfma_f32_16x16x32_bf16 v[68:71], v[44:47], a[48:51], v[68:71]
ds_read_b64_tr_b16 v[34:35], v4 offset:4704
v_mfma_f32_16x16x32_bf16 v[104:107], v[44:47], a[52:55], v[104:107]
ds_read_b64_tr_b16 v[36:37], v4 offset:18528
v_mfma_f32_16x16x32_bf16 v[104:107], v[40:43], a[36:39], v[104:107]
ds_read_b64_tr_b16 v[38:39], v4 offset:23136
v_mfma_f32_16x16x32_bf16 v[140:143], v[40:43], a[40:43], v[140:143]
buffer_load_dwordx4 a[172:175], v28, s[32:35], s55 offen offset:2048 sc1
v_mfma_f32_16x16x32_bf16 v[140:143], v[44:47], a[56:59], v[140:143]
v_mfma_f32_16x16x32_bf16 v[176:179], v[44:47], a[60:63], v[176:179]
v_mfma_f32_16x16x32_bf16 v[176:179], v[40:43], a[44:47], v[176:179]
s_waitcnt lgkmcnt(4)
v_mfma_f32_16x16x32_bf16 v[72:75], v[48:51], a[32:35], v[72:75]
ds_read_b64_tr_b16 v[40:41], v4 offset:128
v_mfma_f32_16x16x32_bf16 v[72:75], v[52:55], a[48:51], v[72:75]
ds_read_b64_tr_b16 v[42:43], v4 offset:4736
v_mfma_f32_16x16x32_bf16 v[108:111], v[52:55], a[52:55], v[108:111]
ds_read_b64_tr_b16 v[44:45], v4 offset:18560
v_mfma_f32_16x16x32_bf16 v[108:111], v[48:51], a[36:39], v[108:111]
ds_read_b64_tr_b16 v[46:47], v4 offset:23168
v_mfma_f32_16x16x32_bf16 v[144:147], v[48:51], a[40:43], v[144:147]
s_add_u32 s66, s64, 147456
s_add_u32 s66, s66, s63
s_add_u32 m0, s65, 0
v_mfma_f32_16x16x32_bf16 v[144:147], v[52:55], a[56:59], v[144:147]
buffer_load_dwordx4 v8, s[16:19], s66 offen offset:0 lds
v_mfma_f32_16x16x32_bf16 v[180:183], v[52:55], a[60:63], v[180:183]
v_mfma_f32_16x16x32_bf16 v[180:183], v[48:51], a[44:47], v[180:183]
s_waitcnt lgkmcnt(4)
v_mfma_f32_16x16x32_bf16 v[76:79], v[32:35], a[32:35], v[76:79]
ds_read_b64_tr_b16 v[48:49], v4 offset:160
v_mfma_f32_16x16x32_bf16 v[76:79], v[36:39], a[48:51], v[76:79]
ds_read_b64_tr_b16 v[50:51], v4 offset:4768
buffer_load_dwordx4 v9, s[16:19], s66 offen offset:1024 lds
v_mfma_f32_16x16x32_bf16 v[112:115], v[36:39], a[52:55], v[112:115]
ds_read_b64_tr_b16 v[52:53], v4 offset:18592
v_mfma_f32_16x16x32_bf16 v[112:115], v[32:35], a[36:39], v[112:115]
ds_read_b64_tr_b16 v[54:55], v4 offset:23200
v_mfma_f32_16x16x32_bf16 v[148:151], v[32:35], a[40:43], v[148:151]
v_mfma_f32_16x16x32_bf16 v[148:151], v[36:39], a[56:59], v[148:151]
v_mfma_f32_16x16x32_bf16 v[184:187], v[36:39], a[60:63], v[184:187]
buffer_load_dwordx4 v10, s[16:19], s66 offen offset:2048 lds
v_mfma_f32_16x16x32_bf16 v[184:187], v[32:35], a[44:47], v[184:187]
s_waitcnt lgkmcnt(4)
v_mfma_f32_16x16x32_bf16 v[80:83], v[40:43], a[32:35], v[80:83]
ds_read_b64_tr_b16 v[32:33], v4 offset:192
v_mfma_f32_16x16x32_bf16 v[80:83], v[44:47], a[48:51], v[80:83]
ds_read_b64_tr_b16 v[34:35], v4 offset:4800
v_mfma_f32_16x16x32_bf16 v[116:119], v[44:47], a[52:55], v[116:119]
ds_read_b64_tr_b16 v[36:37], v4 offset:18624
buffer_load_dwordx4 v11, s[16:19], s66 offen offset:3072 lds
v_mfma_f32_16x16x32_bf16 v[116:119], v[40:43], a[36:39], v[116:119]
ds_read_b64_tr_b16 v[38:39], v4 offset:23232
v_mfma_f32_16x16x32_bf16 v[152:155], v[40:43], a[40:43], v[152:155]
v_mfma_f32_16x16x32_bf16 v[152:155], v[44:47], a[56:59], v[152:155]
v_mfma_f32_16x16x32_bf16 v[188:191], v[44:47], a[60:63], v[188:191]
s_add_u32 m0, s65, 4096
v_mfma_f32_16x16x32_bf16 v[188:191], v[40:43], a[44:47], v[188:191]
s_waitcnt lgkmcnt(4)
v_mfma_f32_16x16x32_bf16 v[84:87], v[48:51], a[32:35], v[84:87]
ds_read_b64_tr_b16 v[40:41], v4 offset:224
v_mfma_f32_16x16x32_bf16 v[84:87], v[52:55], a[48:51], v[84:87]
ds_read_b64_tr_b16 v[42:43], v4 offset:4832
v_mfma_f32_16x16x32_bf16 v[120:123], v[52:55], a[52:55], v[120:123]
ds_read_b64_tr_b16 v[44:45], v4 offset:18656
v_mfma_f32_16x16x32_bf16 v[120:123], v[48:51], a[36:39], v[120:123]
ds_read_b64_tr_b16 v[46:47], v4 offset:23264
buffer_load_dwordx4 v12, s[16:19], s66 offen offset:0 lds
v_mfma_f32_16x16x32_bf16 v[156:159], v[48:51], a[40:43], v[156:159]
v_mfma_f32_16x16x32_bf16 v[156:159], v[52:55], a[56:59], v[156:159]
v_mfma_f32_16x16x32_bf16 v[192:195], v[52:55], a[60:63], v[192:195]
v_mfma_f32_16x16x32_bf16 v[192:195], v[48:51], a[44:47], v[192:195]
buffer_load_dwordx4 v13, s[16:19], s66 offen offset:1024 lds
s_waitcnt lgkmcnt(4)
v_mfma_f32_16x16x32_bf16 v[88:91], v[32:35], a[32:35], v[88:91]
ds_read_b64_tr_b16 v[48:49], v4 offset:256
v_mfma_f32_16x16x32_bf16 v[88:91], v[36:39], a[48:51], v[88:91]
ds_read_b64_tr_b16 v[50:51], v4 offset:4864
v_mfma_f32_16x16x32_bf16 v[124:127], v[36:39], a[52:55], v[124:127]
ds_read_b64_tr_b16 v[52:53], v4 offset:18688
v_mfma_f32_16x16x32_bf16 v[124:127], v[32:35], a[36:39], v[124:127]
ds_read_b64_tr_b16 v[54:55], v4 offset:23296
buffer_load_dwordx4 v14, s[16:19], s66 offen offset:2048 lds
v_mfma_f32_16x16x32_bf16 v[160:163], v[32:35], a[40:43], v[160:163]
v_mfma_f32_16x16x32_bf16 v[160:163], v[36:39], a[56:59], v[160:163]
v_mfma_f32_16x16x32_bf16 v[196:199], v[36:39], a[60:63], v[196:199]
v_mfma_f32_16x16x32_bf16 v[196:199], v[32:35], a[44:47], v[196:199]
s_waitcnt lgkmcnt(4)
v_mfma_f32_16x16x32_bf16 v[92:95], v[40:43], a[32:35], v[92:95]
s_waitcnt vmcnt(11)
s_barrier
v_mfma_f32_16x16x32_bf16 v[92:95], v[44:47], a[48:51], v[92:95]
ds_read_b64_tr_b16 v[32:33], v5 offset:0
buffer_load_dwordx4 v15, s[16:19], s66 offen offset:3072 lds
v_mfma_f32_16x16x32_bf16 v[128:131], v[44:47], a[52:55], v[128:131]
ds_read_b64_tr_b16 v[34:35], v5 offset:4608
v_mfma_f32_16x16x32_bf16 v[128:131], v[40:43], a[36:39], v[128:131]
ds_read_b64_tr_b16 v[36:37], v5 offset:18432
v_mfma_f32_16x16x32_bf16 v[164:167], v[40:43], a[40:43], v[164:167]
ds_read_b64_tr_b16 v[38:39], v5 offset:23040
s_add_u32 m0, s65, 8192
v_mfma_f32_16x16x32_bf16 v[164:167], v[44:47], a[56:59], v[164:167]
v_mfma_f32_16x16x32_bf16 v[200:203], v[44:47], a[60:63], v[200:203]
v_mfma_f32_16x16x32_bf16 v[200:203], v[40:43], a[44:47], v[200:203]
s_waitcnt lgkmcnt(4)
v_mfma_f32_16x16x32_bf16 v[96:99], v[48:51], a[32:35], v[96:99]
ds_read_b64_tr_b16 v[40:41], v5 offset:32
buffer_load_dwordx4 v16, s[16:19], s66 offen offset:0 lds
v_mfma_f32_16x16x32_bf16 v[96:99], v[52:55], a[48:51], v[96:99]
ds_read_b64_tr_b16 v[42:43], v5 offset:4640
v_mfma_f32_16x16x32_bf16 v[132:135], v[52:55], a[52:55], v[132:135]
ds_read_b64_tr_b16 v[44:45], v5 offset:18464
v_mfma_f32_16x16x32_bf16 v[132:135], v[48:51], a[36:39], v[132:135]
ds_read_b64_tr_b16 v[46:47], v5 offset:23072
v_mfma_f32_16x16x32_bf16 v[168:171], v[48:51], a[40:43], v[168:171]
v_mfma_f32_16x16x32_bf16 v[168:171], v[52:55], a[56:59], v[168:171]
v_mfma_f32_16x16x32_bf16 v[204:207], v[52:55], a[60:63], v[204:207]
v_mfma_f32_16x16x32_bf16 v[204:207], v[48:51], a[44:47], v[204:207]
s_waitcnt lgkmcnt(4)
s_waitcnt vmcnt(48)
v_mfma_f32_16x16x32_bf16 v[64:67], v[32:35], a[64:67], v[64:67]
ds_read_b64_tr_b16 v[48:49], v5 offset:64
s_mul_i32 s58, s14, 192
v_mfma_f32_16x16x32_bf16 v[64:67], v[36:39], a[80:83], v[64:67]
ds_read_b64_tr_b16 v[50:51], v5 offset:4672
buffer_load_dwordx4 a[176:179], v28, s[32:35], s52 offen offset:3072 sc1
v_mfma_f32_16x16x32_bf16 v[100:103], v[36:39], a[84:87], v[100:103]
ds_read_b64_tr_b16 v[52:53], v5 offset:18496
v_mfma_f32_16x16x32_bf16 v[100:103], v[32:35], a[68:71], v[100:103]
ds_read_b64_tr_b16 v[54:55], v5 offset:23104
v_add_u32 v252, s58, v1
v_mfma_f32_16x16x32_bf16 v[136:139], v[32:35], a[72:75], v[136:139]
buffer_load_dwordx4 a[180:183], v28, s[32:35], s53 offen offset:3072 sc1
v_mfma_f32_16x16x32_bf16 v[136:139], v[36:39], a[88:91], v[136:139]
v_mfma_f32_16x16x32_bf16 v[172:175], v[36:39], a[92:95], v[172:175]
v_mul_u32_u24 v253, 3641, v252
v_mfma_f32_16x16x32_bf16 v[172:175], v[32:35], a[76:79], v[172:175]
s_waitcnt lgkmcnt(4)
v_mfma_f32_16x16x32_bf16 v[68:71], v[40:43], a[64:67], v[68:71]
ds_read_b64_tr_b16 v[32:33], v5 offset:96
buffer_load_dwordx4 a[184:187], v28, s[32:35], s54 offen offset:3072 sc1
v_mfma_f32_16x16x32_bf16 v[68:71], v[44:47], a[80:83], v[68:71]
ds_read_b64_tr_b16 v[34:35], v5 offset:4704
v_mfma_f32_16x16x32_bf16 v[104:107], v[44:47], a[84:87], v[104:107]
ds_read_b64_tr_b16 v[36:37], v5 offset:18528
v_lshrrev_b32 v253, 16, v253
v_mfma_f32_16x16x32_bf16 v[104:107], v[40:43], a[68:71], v[104:107]
ds_read_b64_tr_b16 v[38:39], v5 offset:23136
v_mfma_f32_16x16x32_bf16 v[140:143], v[40:43], a[72:75], v[140:143]
buffer_load_dwordx4 a[188:191], v28, s[32:35], s55 offen offset:3072 sc1
v_mfma_f32_16x16x32_bf16 v[140:143], v[44:47], a[88:91], v[140:143]
v_mul_u32_u24 v216, 864, v253
v_mfma_f32_16x16x32_bf16 v[176:179], v[44:47], a[92:95], v[176:179]
v_mfma_f32_16x16x32_bf16 v[176:179], v[40:43], a[76:79], v[176:179]
s_waitcnt lgkmcnt(4)
v_mfma_f32_16x16x32_bf16 v[72:75], v[48:51], a[64:67], v[72:75]
ds_read_b64_tr_b16 v[40:41], v5 offset:128
v_mfma_f32_16x16x32_bf16 v[72:75], v[52:55], a[80:83], v[72:75]
ds_read_b64_tr_b16 v[42:43], v5 offset:4736
v_lshl_add_u32 v216, v252, 4, v216
v_mfma_f32_16x16x32_bf16 v[108:111], v[52:55], a[84:87], v[108:111]
ds_read_b64_tr_b16 v[44:45], v5 offset:18560
v_mfma_f32_16x16x32_bf16 v[108:111], v[48:51], a[68:71], v[108:111]
ds_read_b64_tr_b16 v[46:47], v5 offset:23168
v_mfma_f32_16x16x32_bf16 v[144:147], v[48:51], a[72:75], v[144:147]
v_add_u32 v216, s61, v216
v_mfma_f32_16x16x32_bf16 v[144:147], v[52:55], a[88:91], v[144:147]
s_add_u32 s66, s64, 516096
s_add_u32 s66, s66, s63
s_add_u32 m0, s65, 36864
v_mfma_f32_16x16x32_bf16 v[180:183], v[52:55], a[92:95], v[180:183]
buffer_load_dwordx4 v8, s[16:19], s66 offen offset:0 lds
v_mfma_f32_16x16x32_bf16 v[180:183], v[48:51], a[76:79], v[180:183]
s_waitcnt lgkmcnt(4)
v_mfma_f32_16x16x32_bf16 v[76:79], v[32:35], a[64:67], v[76:79]
ds_read_b64_tr_b16 v[48:49], v5 offset:160
s_add_u32 s58, s58, 64
v_mfma_f32_16x16x32_bf16 v[76:79], v[36:39], a[80:83], v[76:79]
ds_read_b64_tr_b16 v[50:51], v5 offset:4768
buffer_load_dwordx4 v9, s[16:19], s66 offen offset:1024 lds
v_mfma_f32_16x16x32_bf16 v[112:115], v[36:39], a[84:87], v[112:115]
ds_read_b64_tr_b16 v[52:53], v5 offset:18592
v_mfma_f32_16x16x32_bf16 v[112:115], v[32:35], a[68:71], v[112:115]
ds_read_b64_tr_b16 v[54:55], v5 offset:23200
v_add_u32 v252, s58, v1
v_mfma_f32_16x16x32_bf16 v[148:151], v[32:35], a[72:75], v[148:151]
v_mfma_f32_16x16x32_bf16 v[148:151], v[36:39], a[88:91], v[148:151]
v_mfma_f32_16x16x32_bf16 v[184:187], v[36:39], a[92:95], v[184:187]
v_mul_u32_u24 v253, 3641, v252
buffer_load_dwordx4 v10, s[16:19], s66 offen offset:2048 lds
v_mfma_f32_16x16x32_bf16 v[184:187], v[32:35], a[76:79], v[184:187]
s_waitcnt lgkmcnt(4)
v_mfma_f32_16x16x32_bf16 v[80:83], v[40:43], a[64:67], v[80:83]
ds_read_b64_tr_b16 v[32:33], v5 offset:192
v_mfma_f32_16x16x32_bf16 v[80:83], v[44:47], a[80:83], v[80:83]
ds_read_b64_tr_b16 v[34:35], v5 offset:4800
v_mfma_f32_16x16x32_bf16 v[116:119], v[44:47], a[84:87], v[116:119]
ds_read_b64_tr_b16 v[36:37], v5 offset:18624
v_lshrrev_b32 v253, 16, v253
v_mfma_f32_16x16x32_bf16 v[116:119], v[40:43], a[68:71], v[116:119]
ds_read_b64_tr_b16 v[38:39], v5 offset:23232
buffer_load_dwordx4 v11, s[16:19], s66 offen offset:3072 lds
v_mfma_f32_16x16x32_bf16 v[152:155], v[40:43], a[72:75], v[152:155]
v_mfma_f32_16x16x32_bf16 v[152:155], v[44:47], a[88:91], v[152:155]
v_mul_u32_u24 v217, 864, v253
v_mfma_f32_16x16x32_bf16 v[188:191], v[44:47], a[92:95], v[188:191]
s_add_u32 m0, s65, 40960
v_mfma_f32_16x16x32_bf16 v[188:191], v[40:43], a[76:79], v[188:191]
s_waitcnt lgkmcnt(4)
v_mfma_f32_16x16x32_bf16 v[84:87], v[48:51], a[64:67], v[84:87]
ds_read_b64_tr_b16 v[40:41], v5 offset:224
v_mfma_f32_16x16x32_bf16 v[84:87], v[52:55], a[80:83], v[84:87]
ds_read_b64_tr_b16 v[42:43], v5 offset:4832
v_lshl_add_u32 v217, v252, 4, v217
v_mfma_f32_16x16x32_bf16 v[120:123], v[52:55], a[84:87], v[120:123]
ds_read_b64_tr_b16 v[44:45], v5 offset:18656
v_mfma_f32_16x16x32_bf16 v[120:123], v[48:51], a[68:71], v[120:123]
ds_read_b64_tr_b16 v[46:47], v5 offset:23264
buffer_load_dwordx4 v12, s[16:19], s66 offen offset:0 lds
v_mfma_f32_16x16x32_bf16 v[156:159], v[48:51], a[72:75], v[156:159]
v_add_u32 v217, s61, v217
v_mfma_f32_16x16x32_bf16 v[156:159], v[52:55], a[88:91], v[156:159]
v_mfma_f32_16x16x32_bf16 v[192:195], v[52:55], a[92:95], v[192:195]
v_mfma_f32_16x16x32_bf16 v[192:195], v[48:51], a[76:79], v[192:195]
buffer_load_dwordx4 v13, s[16:19], s66 offen offset:1024 lds
s_waitcnt lgkmcnt(4)
v_mfma_f32_16x16x32_bf16 v[88:91], v[32:35], a[64:67], v[88:91]
ds_read_b64_tr_b16 v[48:49], v5 offset:256
v_subrev_u32 v217, 1024, v217
v_mfma_f32_16x16x32_bf16 v[88:91], v[36:39], a[80:83], v[88:91]
ds_read_b64_tr_b16 v[50:51], v5 offset:4864
v_mfma_f32_16x16x32_bf16 v[124:127], v[36:39], a[84:87], v[124:127]
ds_read_b64_tr_b16 v[52:53], v5 offset:18688
v_mfma_f32_16x16x32_bf16 v[124:127], v[32:35], a[68:71], v[124:127]
ds_read_b64_tr_b16 v[54:55], v5 offset:23296
s_add_u32 s58, s58, 64
v_mfma_f32_16x16x32_bf16 v[160:163], v[32:35], a[72:75], v[160:163]
buffer_load_dwordx4 v14, s[16:19], s66 offen offset:2048 lds
v_mfma_f32_16x16x32_bf16 v[160:163], v[36:39], a[88:91], v[160:163]
v_mfma_f32_16x16x32_bf16 v[196:199], v[36:39], a[92:95], v[196:199]
v_mfma_f32_16x16x32_bf16 v[196:199], v[32:35], a[76:79], v[196:199]
s_waitcnt lgkmcnt(4)
v_mfma_f32_16x16x32_bf16 v[92:95], v[40:43], a[64:67], v[92:95]
s_waitcnt vmcnt(11)
s_barrier
v_mfma_f32_16x16x32_bf16 v[92:95], v[44:47], a[80:83], v[92:95]
ds_read_b64_tr_b16 v[32:33], v2 offset:0
buffer_load_dwordx4 v15, s[16:19], s66 offen offset:3072 lds
v_mfma_f32_16x16x32_bf16 v[128:131], v[44:47], a[84:87], v[128:131]
ds_read_b64_tr_b16 v[34:35], v2 offset:4608
v_mfma_f32_16x16x32_bf16 v[128:131], v[40:43], a[68:71], v[128:131]
ds_read_b64_tr_b16 v[36:37], v2 offset:18432
v_mfma_f32_16x16x32_bf16 v[164:167], v[40:43], a[72:75], v[164:167]
ds_read_b64_tr_b16 v[38:39], v2 offset:23040
s_add_u32 m0, s65, 45056
v_mfma_f32_16x16x32_bf16 v[164:167], v[44:47], a[88:91], v[164:167]
v_mfma_f32_16x16x32_bf16 v[200:203], v[44:47], a[92:95], v[200:203]
v_mfma_f32_16x16x32_bf16 v[200:203], v[40:43], a[76:79], v[200:203]
s_waitcnt lgkmcnt(4)
v_mfma_f32_16x16x32_bf16 v[96:99], v[48:51], a[64:67], v[96:99]
ds_read_b64_tr_b16 v[40:41], v2 offset:32
buffer_load_dwordx4 v16, s[16:19], s66 offen offset:0 lds
v_mfma_f32_16x16x32_bf16 v[96:99], v[52:55], a[80:83], v[96:99]
ds_read_b64_tr_b16 v[42:43], v2 offset:4640
v_mfma_f32_16x16x32_bf16 v[132:135], v[52:55], a[84:87], v[132:135]
ds_read_b64_tr_b16 v[44:45], v2 offset:18464
v_mfma_f32_16x16x32_bf16 v[132:135], v[48:51], a[68:71], v[132:135]
ds_read_b64_tr_b16 v[46:47], v2 offset:23072
v_mfma_f32_16x16x32_bf16 v[168:171], v[48:51], a[72:75], v[168:171]
v_mfma_f32_16x16x32_bf16 v[168:171], v[52:55], a[88:91], v[168:171]
v_mfma_f32_16x16x32_bf16 v[204:207], v[52:55], a[92:95], v[204:207]
v_mfma_f32_16x16x32_bf16 v[204:207], v[48:51], a[76:79], v[204:207]
s_waitcnt lgkmcnt(4)
s_waitcnt vmcnt(53)
v_mfma_f32_16x16x32_bf16 v[64:67], v[32:35], a[96:99], v[64:67]
ds_read_b64_tr_b16 v[48:49], v2 offset:64
v_add_u32 v252, s58, v1
v_mfma_f32_16x16x32_bf16 v[64:67], v[36:39], a[112:115], v[64:67]
ds_read_b64_tr_b16 v[50:51], v2 offset:4672
buffer_load_dwordx4 a[192:195], v31, s[32:35], s52 offen offset:0 sc1
v_mfma_f32_16x16x32_bf16 v[100:103], v[36:39], a[116:119], v[100:103]
ds_read_b64_tr_b16 v[52:53], v2 offset:18496
v_mfma_f32_16x16x32_bf16 v[100:103], v[32:35], a[100:103], v[100:103]
ds_read_b64_tr_b16 v[54:55], v2 offset:23104
v_mul_u32_u24 v253, 3641, v252
v_mfma_f32_16x16x32_bf16 v[136:139], v[32:35], a[104:107], v[136:139]
buffer_load_dwordx4 a[196:199], v31, s[32:35], s53 offen offset:0 sc1
v_mfma_f32_16x16x32_bf16 v[136:139], v[36:39], a[120:123], v[136:139]
v_mfma_f32_16x16x32_bf16 v[172:175], v[36:39], a[124:127], v[172:175]
v_lshrrev_b32 v253, 16, v253
v_mfma_f32_16x16x32_bf16 v[172:175], v[32:35], a[108:111], v[172:175]
s_waitcnt lgkmcnt(4)
v_mfma_f32_16x16x32_bf16 v[68:71], v[40:43], a[96:99], v[68:71]
ds_read_b64_tr_b16 v[32:33], v2 offset:96
buffer_load_dwordx4 a[200:203], v31, s[32:35], s54 offen offset:0 sc1
v_mfma_f32_16x16x32_bf16 v[68:71], v[44:47], a[112:115], v[68:71]
ds_read_b64_tr_b16 v[34:35], v2 offset:4704
v_mul_u32_u24 v218, 864, v253
v_mfma_f32_16x16x32_bf16 v[104:107], v[44:47], a[116:119], v[104:107]
ds_read_b64_tr_b16 v[36:37], v2 offset:18528
v_mfma_f32_16x16x32_bf16 v[104:107], v[40:43], a[100:103], v[104:107]
ds_read_b64_tr_b16 v[38:39], v2 offset:23136
v_mfma_f32_16x16x32_bf16 v[140:143], v[40:43], a[104:107], v[140:143]
v_lshl_add_u32 v218, v252, 4, v218
buffer_load_dwordx4 a[204:207], v31, s[32:35], s55 offen offset:0 sc1
v_mfma_f32_16x16x32_bf16 v[140:143], v[44:47], a[120:123], v[140:143]
v_mfma_f32_16x16x32_bf16 v[176:179], v[44:47], a[124:127], v[176:179]
v_mfma_f32_16x16x32_bf16 v[176:179], v[40:43], a[108:111], v[176:179]
v_add_u32 v218, s61, v218
s_waitcnt lgkmcnt(4)
v_mfma_f32_16x16x32_bf16 v[72:75], v[48:51], a[96:99], v[72:75]
ds_read_b64_tr_b16 v[40:41], v2 offset:128
v_mfma_f32_16x16x32_bf16 v[72:75], v[52:55], a[112:115], v[72:75]
ds_read_b64_tr_b16 v[42:43], v2 offset:4736
v_mfma_f32_16x16x32_bf16 v[108:111], v[52:55], a[116:119], v[108:111]
ds_read_b64_tr_b16 v[44:45], v2 offset:18560
v_subrev_u32 v218, 2048, v218
v_mfma_f32_16x16x32_bf16 v[108:111], v[48:51], a[100:103], v[108:111]
ds_read_b64_tr_b16 v[46:47], v2 offset:23168
v_mfma_f32_16x16x32_bf16 v[144:147], v[48:51], a[104:107], v[144:147]
s_add_u32 s66, s64, 221184
s_add_u32 s66, s66, s63
s_add_u32 m0, s65, 73728
v_mfma_f32_16x16x32_bf16 v[144:147], v[52:55], a[120:123], v[144:147]
s_add_u32 s58, s58, 64
buffer_load_dwordx4 v8, s[16:19], s66 offen offset:0 lds
v_mfma_f32_16x16x32_bf16 v[180:183], v[52:55], a[124:127], v[180:183]
v_mfma_f32_16x16x32_bf16 v[180:183], v[48:51], a[108:111], v[180:183]
s_waitcnt lgkmcnt(4)
v_mfma_f32_16x16x32_bf16 v[76:79], v[32:35], a[96:99], v[76:79]
ds_read_b64_tr_b16 v[48:49], v2 offset:160
v_lshrrev_b32 v252, 2, v1
v_mfma_f32_16x16x32_bf16 v[76:79], v[36:39], a[112:115], v[76:79]
ds_read_b64_tr_b16 v[50:51], v2 offset:4768
buffer_load_dwordx4 v9, s[16:19], s66 offen offset:1024 lds
v_mfma_f32_16x16x32_bf16 v[112:115], v[36:39], a[116:119], v[112:115]
ds_read_b64_tr_b16 v[52:53], v2 offset:18592
v_mfma_f32_16x16x32_bf16 v[112:115], v[32:35], a[100:103], v[112:115]
ds_read_b64_tr_b16 v[54:55], v2 offset:23200
v_and_b32 v253, 3, v1
v_mfma_f32_16x16x32_bf16 v[148:151], v[32:35], a[104:107], v[148:151]
v_mfma_f32_16x16x32_bf16 v[148:151], v[36:39], a[120:123], v[148:151]
v_mfma_f32_16x16x32_bf16 v[184:187], v[36:39], a[124:127], v[184:187]
s_mul_i32 s58, s14, 48
buffer_load_dwordx4 v10, s[16:19], s66 offen offset:2048 lds
v_mfma_f32_16x16x32_bf16 v[184:187], v[32:35], a[108:111], v[184:187]
s_waitcnt lgkmcnt(4)
v_mfma_f32_16x16x32_bf16 v[80:83], v[40:43], a[96:99], v[80:83]
ds_read_b64_tr_b16 v[32:33], v2 offset:192
v_mfma_f32_16x16x32_bf16 v[80:83], v[44:47], a[112:115], v[80:83]
ds_read_b64_tr_b16 v[34:35], v2 offset:4800
s_add_u32 s58, s58, s45
v_mfma_f32_16x16x32_bf16 v[116:119], v[44:47], a[116:119], v[116:119]
ds_read_b64_tr_b16 v[36:37], v2 offset:18624
buffer_load_dwordx4 v11, s[16:19], s66 offen offset:3072 lds
v_mfma_f32_16x16x32_bf16 v[116:119], v[40:43], a[100:103], v[116:119]
ds_read_b64_tr_b16 v[38:39], v2 offset:23232
v_mfma_f32_16x16x32_bf16 v[152:155], v[40:43], a[104:107], v[152:155]
v_add_u32 v219, s58, v252
v_mfma_f32_16x16x32_bf16 v[152:155], v[44:47], a[120:123], v[152:155]
v_mfma_f32_16x16x32_bf16 v[188:191], v[44:47], a[124:127], v[188:191]
s_add_u32 m0, s65, 77824
STUB_g7:
s_cbranch_execz NEXT_g7
v_mfma_f32_16x16x32_bf16 v[188:191], v[40:43], a[108:111], v[188:191]
v_lshlrev_b32 v219, 12, v219
s_waitcnt lgkmcnt(4)
v_mfma_f32_16x16x32_bf16 v[84:87], v[48:51], a[96:99], v[84:87]
ds_read_b64_tr_b16 v[40:41], v2 offset:224
v_mfma_f32_16x16x32_bf16 v[84:87], v[52:55], a[112:115], v[84:87]
ds_read_b64_tr_b16 v[42:43], v2 offset:4832
v_mfma_f32_16x16x32_bf16 v[120:123], v[52:55], a[116:119], v[120:123]
ds_read_b64_tr_b16 v[44:45], v2 offset:18656
v_lshl_add_u32 v219, v253, 4, v219
v_mfma_f32_16x16x32_bf16 v[120:123], v[48:51], a[100:103], v[120:123]
ds_read_b64_tr_b16 v[46:47], v2 offset:23264
buffer_load_dwordx4 v12, s[16:19], s66 offen offset:0 lds
v_mfma_f32_16x16x32_bf16 v[156:159], v[48:51], a[104:107], v[156:159]
v_mfma_f32_16x16x32_bf16 v[156:159], v[52:55], a[120:123], v[156:159]
s_lshl_b32 s58, s43, 6
v_mfma_f32_16x16x32_bf16 v[192:195], v[52:55], a[124:127], v[192:195]
v_mfma_f32_16x16x32_bf16 v[192:195], v[48:51], a[108:111], v[192:195]
buffer_load_dwordx4 v13, s[16:19], s66 offen offset:1024 lds
s_waitcnt lgkmcnt(4)
v_mfma_f32_16x16x32_bf16 v[88:91], v[32:35], a[96:99], v[88:91]
ds_read_b64_tr_b16 v[48:49], v2 offset:256
s_add_u32 s58, s58, s61
v_mfma_f32_16x16x32_bf16 v[88:91], v[36:39], a[112:115], v[88:91]
ds_read_b64_tr_b16 v[50:51], v2 offset:4864
v_mfma_f32_16x16x32_bf16 v[124:127], v[36:39], a[116:119], v[124:127]
ds_read_b64_tr_b16 v[52:53], v2 offset:18688
v_mfma_f32_16x16x32_bf16 v[124:127], v[32:35], a[100:103], v[124:127]
ds_read_b64_tr_b16 v[54:55], v2 offset:23296
v_add_u32 v219, s58, v219
v_mfma_f32_16x16x32_bf16 v[160:163], v[32:35], a[104:107], v[160:163]
buffer_load_dwordx4 v14, s[16:19], s66 offen offset:2048 lds
v_mfma_f32_16x16x32_bf16 v[160:163], v[36:39], a[120:123], v[160:163]
v_mfma_f32_16x16x32_bf16 v[196:199], v[36:39], a[124:127], v[196:199]
v_mfma_f32_16x16x32_bf16 v[196:199], v[32:35], a[108:111], v[196:199]
s_waitcnt lgkmcnt(4)
v_mfma_f32_16x16x32_bf16 v[92:95], v[40:43], a[96:99], v[92:95]
s_waitcnt vmcnt(11)
s_barrier
v_mfma_f32_16x16x32_bf16 v[92:95], v[44:47], a[112:115], v[92:95]
ds_read_b64_tr_b16 v[32:33], v3 offset:0
buffer_load_dwordx4 v15, s[16:19], s66 offen offset:3072 lds
v_mfma_f32_16x16x32_bf16 v[128:131], v[44:47], a[116:119], v[128:131]
ds_read_b64_tr_b16 v[34:35], v3 offset:4608
v_mfma_f32_16x16x32_bf16 v[128:131], v[40:43], a[100:103], v[128:131]
ds_read_b64_tr_b16 v[36:37], v3 offset:18432
v_mfma_f32_16x16x32_bf16 v[164:167], v[40:43], a[104:107], v[164:167]
ds_read_b64_tr_b16 v[38:39], v3 offset:23040
s_add_u32 m0, s65, 81920
v_mfma_f32_16x16x32_bf16 v[164:167], v[44:47], a[120:123], v[164:167]
v_mfma_f32_16x16x32_bf16 v[200:203], v[44:47], a[124:127], v[200:203]
v_mfma_f32_16x16x32_bf16 v[200:203], v[40:43], a[108:111], v[200:203]
s_waitcnt lgkmcnt(4)
v_mfma_f32_16x16x32_bf16 v[96:99], v[48:51], a[96:99], v[96:99]
ds_read_b64_tr_b16 v[40:41], v3 offset:32
buffer_load_dwordx4 v16, s[16:19], s66 offen offset:0 lds
v_mfma_f32_16x16x32_bf16 v[96:99], v[52:55], a[112:115], v[96:99]
ds_read_b64_tr_b16 v[42:43], v3 offset:4640
v_mfma_f32_16x16x32_bf16 v[132:135], v[52:55], a[116:119], v[132:135]
ds_read_b64_tr_b16 v[44:45], v3 offset:18464
v_mfma_f32_16x16x32_bf16 v[132:135], v[48:51], a[100:103], v[132:135]
ds_read_b64_tr_b16 v[46:47], v3 offset:23072
v_mfma_f32_16x16x32_bf16 v[168:171], v[48:51], a[104:107], v[168:171]
v_mfma_f32_16x16x32_bf16 v[168:171], v[52:55], a[120:123], v[168:171]
v_mfma_f32_16x16x32_bf16 v[204:207], v[52:55], a[124:127], v[204:207]
v_mfma_f32_16x16x32_bf16 v[204:207], v[48:51], a[108:111], v[204:207]
s_waitcnt lgkmcnt(4)
s_waitcnt vmcnt(58)
v_mfma_f32_16x16x32_bf16 v[64:67], v[32:35], a[128:131], v[64:67]
ds_read_b64_tr_b16 v[48:49], v3 offset:64
s_mul_i32 s58, s14, 9216
v_mfma_f32_16x16x32_bf16 v[64:67], v[36:39], a[144:147], v[64:67]
ds_read_b64_tr_b16 v[50:51], v3 offset:4672
buffer_load_dwordx2 v[22:23], v6, s[32:35], s100 offen sc1
v_mfma_f32_16x16x32_bf16 v[100:103], v[36:39], a[148:151], v[100:103]
ds_read_b64_tr_b16 v[52:53], v3 offset:18496
s_add_u32 s58, s58, 73728
v_mfma_f32_16x16x32_bf16 v[100:103], v[32:35], a[132:135], v[100:103]
ds_read_b64_tr_b16 v[54:55], v3 offset:23104
buffer_load_dwordx4 a[208:211], v31, s[32:35], s52 offen offset:1024 sc1
v_mfma_f32_16x16x32_bf16 v[136:139], v[32:35], a[136:139], v[136:139]
v_mfma_f32_16x16x32_bf16 v[136:139], v[36:39], a[152:155], v[136:139]
v_add_u32 v234, s58, v7
v_mfma_f32_16x16x32_bf16 v[172:175], v[36:39], a[156:159], v[172:175]
v_mfma_f32_16x16x32_bf16 v[172:175], v[32:35], a[140:143], v[172:175]
buffer_load_dwordx4 a[212:215], v31, s[32:35], s53 offen offset:1024 sc1
s_waitcnt lgkmcnt(4)
v_mfma_f32_16x16x32_bf16 v[68:71], v[40:43], a[128:131], v[68:71]
ds_read_b64_tr_b16 v[32:33], v3 offset:96
s_xor_b32 s58, s14, 1
v_mfma_f32_16x16x32_bf16 v[68:71], v[44:47], a[144:147], v[68:71]
ds_read_b64_tr_b16 v[34:35], v3 offset:4704
v_mfma_f32_16x16x32_bf16 v[104:107], v[44:47], a[148:151], v[104:107]
ds_read_b64_tr_b16 v[36:37], v3 offset:18528
buffer_load_dwordx4 a[216:219], v31, s[32:35], s54 offen offset:1024 sc1
v_mfma_f32_16x16x32_bf16 v[104:107], v[40:43], a[132:135], v[104:107]
ds_read_b64_tr_b16 v[38:39], v3 offset:23136
s_mul_i32 s58, s58, 9216
v_mfma_f32_16x16x32_bf16 v[140:143], v[40:43], a[136:139], v[140:143]
v_mfma_f32_16x16x32_bf16 v[140:143], v[44:47], a[152:155], v[140:143]
v_mfma_f32_16x16x32_bf16 v[176:179], v[44:47], a[156:159], v[176:179]
s_add_u32 s58, s58, 73728
buffer_load_dwordx4 a[220:223], v31, s[32:35], s55 offen offset:1024 sc1
v_mfma_f32_16x16x32_bf16 v[176:179], v[40:43], a[140:143], v[176:179]
s_waitcnt lgkmcnt(4)
v_mfma_f32_16x16x32_bf16 v[72:75], v[48:51], a[128:131], v[72:75]
ds_read_b64_tr_b16 v[40:41], v3 offset:128
v_mfma_f32_16x16x32_bf16 v[72:75], v[52:55], a[144:147], v[72:75]
ds_read_b64_tr_b16 v[42:43], v3 offset:4736
v_add_u32 v235, s58, v7
v_mfma_f32_16x16x32_bf16 v[108:111], v[52:55], a[148:151], v[108:111]
ds_read_b64_tr_b16 v[44:45], v3 offset:18560
buffer_load_dwordx2 a[224:225], v20, s[32:35], s52 offen offset:0 sc1
v_mfma_f32_16x16x32_bf16 v[108:111], v[48:51], a[132:135], v[108:111]
ds_read_b64_tr_b16 v[46:47], v3 offset:23168
v_mfma_f32_16x16x32_bf16 v[144:147], v[48:51], a[136:139], v[144:147]
s_lshl_b32 s60, s40, 2
v_mfma_f32_16x16x32_bf16 v[144:147], v[52:55], a[152:155], v[144:147]
buffer_load_dwordx2 a[226:227], v20, s[32:35], s52 offen offset:512 sc1
v_mfma_f32_16x16x32_bf16 v[180:183], v[52:55], a[156:159], v[180:183]
v_mfma_f32_16x16x32_bf16 v[180:183], v[48:51], a[140:143], v[180:183]
s_add_u32 s60, s60, s14
s_waitcnt lgkmcnt(4)
v_mfma_f32_16x16x32_bf16 v[76:79], v[32:35], a[128:131], v[76:79]
ds_read_b64_tr_b16 v[48:49], v3 offset:160
v_mfma_f32_16x16x32_bf16 v[76:79], v[36:39], a[144:147], v[76:79]
ds_read_b64_tr_b16 v[50:51], v3 offset:4768
v_mfma_f32_16x16x32_bf16 v[112:115], v[36:39], a[148:151], v[112:115]
ds_read_b64_tr_b16 v[52:53], v3 offset:18592
s_lshl_b32 s60, s60, 2
v_mfma_f32_16x16x32_bf16 v[112:115], v[32:35], a[132:135], v[112:115]
ds_read_b64_tr_b16 v[54:55], v3 offset:23200
v_mfma_f32_16x16x32_bf16 v[148:151], v[32:35], a[136:139], v[148:151]
s_add_u32 s60, s60, s42
v_mfma_f32_16x16x32_bf16 v[148:151], v[36:39], a[152:155], v[148:151]
s_add_u32 s66, s64, 589824
s_add_u32 s66, s66, s63
s_add_u32 m0, s65, 110592
v_mfma_f32_16x16x32_bf16 v[184:187], v[36:39], a[156:159], v[184:187]
buffer_load_dwordx4 v8, s[16:19], s66 offen offset:0 lds
v_mfma_f32_16x16x32_bf16 v[184:187], v[32:35], a[140:143], v[184:187]
s_lshl_b32 s3, s60, 7
s_waitcnt lgkmcnt(4)
v_mfma_f32_16x16x32_bf16 v[80:83], v[40:43], a[128:131], v[80:83]
ds_read_b64_tr_b16 v[32:33], v3 offset:192
buffer_load_dwordx4 v9, s[16:19], s66 offen offset:1024 lds
v_mfma_f32_16x16x32_bf16 v[80:83], v[44:47], a[144:147], v[80:83]
ds_read_b64_tr_b16 v[34:35], v3 offset:4800
v_mfma_f32_16x16x32_bf16 v[116:119], v[44:47], a[148:151], v[116:119]
ds_read_b64_tr_b16 v[36:37], v3 offset:18624
s_lshl_b32 s58, s41, 3
v_mfma_f32_16x16x32_bf16 v[116:119], v[40:43], a[132:135], v[116:119]
ds_read_b64_tr_b16 v[38:39], v3 offset:23232
v_mfma_f32_16x16x32_bf16 v[152:155], v[40:43], a[136:139], v[152:155]
buffer_load_dwordx4 v10, s[16:19], s66 offen offset:2048 lds
v_mfma_f32_16x16x32_bf16 v[152:155], v[44:47], a[152:155], v[152:155]
s_add_u32 s3, s3, s58
v_mfma_f32_16x16x32_bf16 v[188:191], v[44:47], a[156:159], v[188:191]
v_mfma_f32_16x16x32_bf16 v[188:191], v[40:43], a[140:143], v[188:191]
buffer_load_dwordx4 v11, s[16:19], s66 offen offset:3072 lds
s_waitcnt lgkmcnt(4)
v_mfma_f32_16x16x32_bf16 v[84:87], v[48:51], a[128:131], v[84:87]
ds_read_b64_tr_b16 v[40:41], v3 offset:224
s_add_u32 s3, s3, 63111168
v_mfma_f32_16x16x32_bf16 v[84:87], v[52:55], a[144:147], v[84:87]
ds_read_b64_tr_b16 v[42:43], v3 offset:4832
v_mfma_f32_16x16x32_bf16 v[120:123], v[52:55], a[148:151], v[120:123]
ds_read_b64_tr_b16 v[44:45], v3 offset:18656
v_mfma_f32_16x16x32_bf16 v[120:123], v[48:51], a[132:135], v[120:123]
ds_read_b64_tr_b16 v[46:47], v3 offset:23264
s_lshl_b32 s60, s60, 2
v_mfma_f32_16x16x32_bf16 v[156:159], v[48:51], a[136:139], v[156:159]
s_add_u32 m0, s65, 114688
v_mfma_f32_16x16x32_bf16 v[156:159], v[52:55], a[152:155], v[156:159]
v_mfma_f32_16x16x32_bf16 v[192:195], v[52:55], a[156:159], v[192:195]
s_add_u32 s60, s60, s41
v_mfma_f32_16x16x32_bf16 v[192:195], v[48:51], a[140:143], v[192:195]
buffer_load_dwordx4 v12, s[16:19], s66 offen offset:0 lds
s_waitcnt lgkmcnt(4)
v_mfma_f32_16x16x32_bf16 v[88:91], v[32:35], a[128:131], v[88:91]
ds_read_b64_tr_b16 v[48:49], v3 offset:256
v_mfma_f32_16x16x32_bf16 v[88:91], v[36:39], a[144:147], v[88:91]
ds_read_b64_tr_b16 v[50:51], v3 offset:4864
s_mul_i32 s15, s60, 9216
v_mfma_f32_16x16x32_bf16 v[124:127], v[36:39], a[148:151], v[124:127]
ds_read_b64_tr_b16 v[52:53], v3 offset:18688
buffer_load_dwordx4 v13, s[16:19], s66 offen offset:1024 lds
v_mfma_f32_16x16x32_bf16 v[124:127], v[32:35], a[132:135], v[124:127]
ds_read_b64_tr_b16 v[54:55], v3 offset:23296
v_mfma_f32_16x16x32_bf16 v[160:163], v[32:35], a[136:139], v[160:163]
s_add_u32 s15, s15, 50331648
v_mfma_f32_16x16x32_bf16 v[160:163], v[36:39], a[152:155], v[160:163]
v_mfma_f32_16x16x32_bf16 v[196:199], v[36:39], a[156:159], v[196:199]
buffer_load_dwordx4 v14, s[16:19], s66 offen offset:2048 lds
v_mfma_f32_16x16x32_bf16 v[196:199], v[32:35], a[140:143], v[196:199]
s_waitcnt lgkmcnt(4)
v_mfma_f32_16x16x32_bf16 v[92:95], v[40:43], a[128:131], v[92:95]
s_waitcnt vmcnt(14)
s_barrier
v_mfma_f32_16x16x32_bf16 v[92:95], v[44:47], a[144:147], v[92:95]
ds_read_b64_tr_b16 v[32:33], v4 offset:0
v_mfma_f32_16x16x32_bf16 v[128:131], v[44:47], a[148:151], v[128:131]
ds_read_b64_tr_b16 v[34:35], v4 offset:4608
buffer_load_dwordx4 v15, s[16:19], s66 offen offset:3072 lds
v_mfma_f32_16x16x32_bf16 v[128:131], v[40:43], a[132:135], v[128:131]
ds_read_b64_tr_b16 v[36:37], v4 offset:18432
v_mfma_f32_16x16x32_bf16 v[164:167], v[40:43], a[136:139], v[164:167]
ds_read_b64_tr_b16 v[38:39], v4 offset:23040
v_mfma_f32_16x16x32_bf16 v[164:167], v[44:47], a[152:155], v[164:167]
s_add_u32 m0, s65, 118784
v_mfma_f32_16x16x32_bf16 v[200:203], v[44:47], a[156:159], v[200:203]
v_mfma_f32_16x16x32_bf16 v[200:203], v[40:43], a[140:143], v[200:203]
s_waitcnt lgkmcnt(4)
v_mfma_f32_16x16x32_bf16 v[96:99], v[48:51], a[128:131], v[96:99]
ds_read_b64_tr_b16 v[40:41], v4 offset:32
v_mfma_f32_16x16x32_bf16 v[96:99], v[52:55], a[144:147], v[96:99]
ds_read_b64_tr_b16 v[42:43], v4 offset:4640
buffer_load_dwordx4 v16, s[16:19], s66 offen offset:0 lds
v_mfma_f32_16x16x32_bf16 v[132:135], v[52:55], a[148:151], v[132:135]
ds_read_b64_tr_b16 v[44:45], v4 offset:18464
v_mfma_f32_16x16x32_bf16 v[132:135], v[48:51], a[132:135], v[132:135]
ds_read_b64_tr_b16 v[46:47], v4 offset:23072
v_mfma_f32_16x16x32_bf16 v[168:171], v[48:51], a[136:139], v[168:171]
v_mfma_f32_16x16x32_bf16 v[168:171], v[52:55], a[152:155], v[168:171]
v_mfma_f32_16x16x32_bf16 v[204:207], v[52:55], a[156:159], v[204:207]
v_mfma_f32_16x16x32_bf16 v[204:207], v[48:51], a[140:143], v[204:207]
s_waitcnt lgkmcnt(4)
s_waitcnt vmcnt(38)
v_mfma_f32_16x16x32_bf16 v[64:67], v[32:35], a[160:163], v[64:67]
ds_read_b64_tr_b16 v[48:49], v4 offset:64
buffer_load_dwordx2 a[228:229], v20, s[32:35], s53 offen offset:0 sc1
v_mfma_f32_16x16x32_bf16 v[64:67], v[36:39], a[176:179], v[64:67]
ds_read_b64_tr_b16 v[50:51], v4 offset:4672
v_mfma_f32_16x16x32_bf16 v[100:103], v[36:39], a[180:183], v[100:103]
ds_read_b64_tr_b16 v[52:53], v4 offset:18496
v_mfma_f32_16x16x32_bf16 v[100:103], v[32:35], a[164:167], v[100:103]
ds_read_b64_tr_b16 v[54:55], v4 offset:23104
buffer_load_dwordx2 a[230:231], v20, s[32:35], s53 offen offset:512 sc1
v_mfma_f32_16x16x32_bf16 v[136:139], v[32:35], a[168:171], v[136:139]
v_mfma_f32_16x16x32_bf16 v[136:139], v[36:39], a[184:187], v[136:139]
v_mfma_f32_16x16x32_bf16 v[172:175], v[36:39], a[188:191], v[172:175]
buffer_load_dwordx2 a[232:233], v20, s[32:35], s54 offen offset:0 sc1
v_mfma_f32_16x16x32_bf16 v[172:175], v[32:35], a[172:175], v[172:175]
s_waitcnt lgkmcnt(4)
v_mfma_f32_16x16x32_bf16 v[68:71], v[40:43], a[160:163], v[68:71]
ds_read_b64_tr_b16 v[32:33], v4 offset:96
v_mfma_f32_16x16x32_bf16 v[68:71], v[44:47], a[176:179], v[68:71]
ds_read_b64_tr_b16 v[34:35], v4 offset:4704
v_mfma_f32_16x16x32_bf16 v[104:107], v[44:47], a[180:183], v[104:107]
ds_read_b64_tr_b16 v[36:37], v4 offset:18528
buffer_load_dwordx2 a[234:235], v20, s[32:35], s54 offen offset:512 sc1
v_mfma_f32_16x16x32_bf16 v[104:107], v[40:43], a[164:167], v[104:107]
ds_read_b64_tr_b16 v[38:39], v4 offset:23136
v_mfma_f32_16x16x32_bf16 v[140:143], v[40:43], a[168:171], v[140:143]
v_mfma_f32_16x16x32_bf16 v[140:143], v[44:47], a[184:187], v[140:143]
buffer_load_dwordx2 a[236:237], v20, s[32:35], s55 offen offset:0 sc1
v_mfma_f32_16x16x32_bf16 v[176:179], v[44:47], a[188:191], v[176:179]
v_mfma_f32_16x16x32_bf16 v[176:179], v[40:43], a[172:175], v[176:179]
s_waitcnt lgkmcnt(4)
v_mfma_f32_16x16x32_bf16 v[72:75], v[48:51], a[160:163], v[72:75]
ds_read_b64_tr_b16 v[40:41], v4 offset:128
v_mfma_f32_16x16x32_bf16 v[72:75], v[52:55], a[176:179], v[72:75]
ds_read_b64_tr_b16 v[42:43], v4 offset:4736
buffer_load_dwordx2 a[238:239], v20, s[32:35], s55 offen offset:512 sc1
v_mfma_f32_16x16x32_bf16 v[108:111], v[52:55], a[180:183], v[108:111]
ds_read_b64_tr_b16 v[44:45], v4 offset:18560
v_mfma_f32_16x16x32_bf16 v[108:111], v[48:51], a[164:167], v[108:111]
ds_read_b64_tr_b16 v[46:47], v4 offset:23168
v_mfma_f32_16x16x32_bf16 v[144:147], v[48:51], a[168:171], v[144:147]
buffer_load_dwordx2 a[240:241], v20, s[32:35], s52 offen offset:1024 sc1
v_mfma_f32_16x16x32_bf16 v[144:147], v[52:55], a[184:187], v[144:147]
v_mfma_f32_16x16x32_bf16 v[180:183], v[52:55], a[188:191], v[180:183]
v_mfma_f32_16x16x32_bf16 v[180:183], v[48:51], a[172:175], v[180:183]
s_waitcnt lgkmcnt(4)
v_mfma_f32_16x16x32_bf16 v[76:79], v[32:35], a[160:163], v[76:79]
ds_read_b64_tr_b16 v[48:49], v4 offset:160
buffer_load_dwordx2 a[242:243], v20, s[32:35], s52 offen offset:1536 sc1
v_mfma_f32_16x16x32_bf16 v[76:79], v[36:39], a[176:179], v[76:79]
ds_read_b64_tr_b16 v[50:51], v4 offset:4768
v_mfma_f32_16x16x32_bf16 v[112:115], v[36:39], a[180:183], v[112:115]
ds_read_b64_tr_b16 v[52:53], v4 offset:18592
v_mfma_f32_16x16x32_bf16 v[112:115], v[32:35], a[164:167], v[112:115]
ds_read_b64_tr_b16 v[54:55], v4 offset:23200
v_mfma_f32_16x16x32_bf16 v[148:151], v[32:35], a[168:171], v[148:151]
s_add_u32 s66, s64, 294912
s_add_u32 s66, s66, s63
s_add_u32 m0, s65, 0
v_mfma_f32_16x16x32_bf16 v[148:151], v[36:39], a[184:187], v[148:151]
v_mfma_f32_16x16x32_bf16 v[184:187], v[36:39], a[188:191], v[184:187]
v_mfma_f32_16x16x32_bf16 v[184:187], v[32:35], a[172:175], v[184:187]
buffer_load_dwordx4 v8, s[16:19], s66 offen offset:0 lds
s_waitcnt lgkmcnt(4)
v_mfma_f32_16x16x32_bf16 v[80:83], v[40:43], a[160:163], v[80:83]
ds_read_b64_tr_b16 v[32:33], v4 offset:192
v_mfma_f32_16x16x32_bf16 v[80:83], v[44:47], a[176:179], v[80:83]
ds_read_b64_tr_b16 v[34:35], v4 offset:4800
v_mfma_f32_16x16x32_bf16 v[116:119], v[44:47], a[180:183], v[116:119]
ds_read_b64_tr_b16 v[36:37], v4 offset:18624
buffer_load_dwordx4 v9, s[16:19], s66 offen offset:1024 lds
v_mfma_f32_16x16x32_bf16 v[116:119], v[40:43], a[164:167], v[116:119]
ds_read_b64_tr_b16 v[38:39], v4 offset:23232
v_mfma_f32_16x16x32_bf16 v[152:155], v[40:43], a[168:171], v[152:155]
v_mfma_f32_16x16x32_bf16 v[152:155], v[44:47], a[184:187], v[152:155]
buffer_load_dwordx4 v10, s[16:19], s66 offen offset:2048 lds
v_mfma_f32_16x16x32_bf16 v[188:191], v[44:47], a[188:191], v[188:191]
v_mfma_f32_16x16x32_bf16 v[188:191], v[40:43], a[172:175], v[188:191]
s_waitcnt lgkmcnt(4)
v_mfma_f32_16x16x32_bf16 v[84:87], v[48:51], a[160:163], v[84:87]
ds_read_b64_tr_b16 v[40:41], v4 offset:224
v_mfma_f32_16x16x32_bf16 v[84:87], v[52:55], a[176:179], v[84:87]
ds_read_b64_tr_b16 v[42:43], v4 offset:4832
buffer_load_dwordx4 v11, s[16:19], s66 offen offset:3072 lds
v_mfma_f32_16x16x32_bf16 v[120:123], v[52:55], a[180:183], v[120:123]
ds_read_b64_tr_b16 v[44:45], v4 offset:18656
v_mfma_f32_16x16x32_bf16 v[120:123], v[48:51], a[164:167], v[120:123]
ds_read_b64_tr_b16 v[46:47], v4 offset:23264
v_mfma_f32_16x16x32_bf16 v[156:159], v[48:51], a[168:171], v[156:159]
s_add_u32 m0, s65, 4096
v_mfma_f32_16x16x32_bf16 v[156:159], v[52:55], a[184:187], v[156:159]
v_mfma_f32_16x16x32_bf16 v[192:195], v[52:55], a[188:191], v[192:195]
v_mfma_f32_16x16x32_bf16 v[192:195], v[48:51], a[172:175], v[192:195]
s_waitcnt lgkmcnt(4)
v_mfma_f32_16x16x32_bf16 v[88:91], v[32:35], a[160:163], v[88:91]
ds_read_b64_tr_b16 v[48:49], v4 offset:256
buffer_load_dwordx4 v12, s[16:19], s66 offen offset:0 lds
v_mfma_f32_16x16x32_bf16 v[88:91], v[36:39], a[176:179], v[88:91]
ds_read_b64_tr_b16 v[50:51], v4 offset:4864
v_mfma_f32_16x16x32_bf16 v[124:127], v[36:39], a[180:183], v[124:127]
ds_read_b64_tr_b16 v[52:53], v4 offset:18688
v_mfma_f32_16x16x32_bf16 v[124:127], v[32:35], a[164:167], v[124:127]
ds_read_b64_tr_b16 v[54:55], v4 offset:23296
buffer_load_dwordx4 v13, s[16:19], s66 offen offset:1024 lds
v_mfma_f32_16x16x32_bf16 v[160:163], v[32:35], a[168:171], v[160:163]
v_mfma_f32_16x16x32_bf16 v[160:163], v[36:39], a[184:187], v[160:163]
v_mfma_f32_16x16x32_bf16 v[196:199], v[36:39], a[188:191], v[196:199]
v_mfma_f32_16x16x32_bf16 v[196:199], v[32:35], a[172:175], v[196:199]
buffer_load_dwordx4 v14, s[16:19], s66 offen offset:2048 lds
s_waitcnt lgkmcnt(4)
v_mfma_f32_16x16x32_bf16 v[92:95], v[40:43], a[160:163], v[92:95]
s_waitcnt vmcnt(15)
s_barrier
v_mfma_f32_16x16x32_bf16 v[92:95], v[44:47], a[176:179], v[92:95]
ds_read_b64_tr_b16 v[32:33], v5 offset:0
v_mfma_f32_16x16x32_bf16 v[128:131], v[44:47], a[180:183], v[128:131]
ds_read_b64_tr_b16 v[34:35], v5 offset:4608
buffer_load_dwordx4 v15, s[16:19], s66 offen offset:3072 lds
v_mfma_f32_16x16x32_bf16 v[128:131], v[40:43], a[164:167], v[128:131]
ds_read_b64_tr_b16 v[36:37], v5 offset:18432
v_mfma_f32_16x16x32_bf16 v[164:167], v[40:43], a[168:171], v[164:167]
ds_read_b64_tr_b16 v[38:39], v5 offset:23040
v_mfma_f32_16x16x32_bf16 v[164:167], v[44:47], a[184:187], v[164:167]
v_cmp_ne_u64 vcc, s[94:95], v[22:23]
s_nop 1
s_cmp_lg_u64 vcc, 0
s_cbranch_scc1 SLOW_F4c
BACK_F4c:
v_mfma_f32_16x16x32_bf16 v[200:203], v[44:47], a[188:191], v[200:203]
s_add_u32 m0, s65, 8192
v_mfma_f32_16x16x32_bf16 v[200:203], v[40:43], a[172:175], v[200:203]
s_waitcnt lgkmcnt(4)
v_mfma_f32_16x16x32_bf16 v[96:99], v[48:51], a[160:163], v[96:99]
ds_read_b64_tr_b16 v[40:41], v5 offset:32
v_mfma_f32_16x16x32_bf16 v[96:99], v[52:55], a[176:179], v[96:99]
ds_read_b64_tr_b16 v[42:43], v5 offset:4640
buffer_load_dwordx4 v16, s[16:19], s66 offen offset:0 lds
v_mfma_f32_16x16x32_bf16 v[132:135], v[52:55], a[180:183], v[132:135]
ds_read_b64_tr_b16 v[44:45], v5 offset:18464
v_mfma_f32_16x16x32_bf16 v[132:135], v[48:51], a[164:167], v[132:135]
ds_read_b64_tr_b16 v[46:47], v5 offset:23072
v_mfma_f32_16x16x32_bf16 v[168:171], v[48:51], a[168:171], v[168:171]
v_mfma_f32_16x16x32_bf16 v[168:171], v[52:55], a[184:187], v[168:171]
v_mfma_f32_16x16x32_bf16 v[204:207], v[52:55], a[188:191], v[204:207]
v_mfma_f32_16x16x32_bf16 v[204:207], v[48:51], a[172:175], v[204:207]
s_waitcnt lgkmcnt(4)
s_waitcnt vmcnt(28)
v_mfma_f32_16x16x32_bf16 v[64:67], v[32:35], a[192:195], v[64:67]
ds_read_b64_tr_b16 v[48:49], v5 offset:64
buffer_load_dwordx2 a[244:245], v20, s[32:35], s53 offen offset:1024 sc1
v_mfma_f32_16x16x32_bf16 v[64:67], v[36:39], a[208:211], v[64:67]
ds_read_b64_tr_b16 v[50:51], v5 offset:4672
v_mfma_f32_16x16x32_bf16 v[100:103], v[36:39], a[212:215], v[100:103]
ds_read_b64_tr_b16 v[52:53], v5 offset:18496
v_mfma_f32_16x16x32_bf16 v[100:103], v[32:35], a[196:199], v[100:103]
ds_read_b64_tr_b16 v[54:55], v5 offset:23104
buffer_load_dwordx2 a[246:247], v20, s[32:35], s53 offen offset:1536 sc1
v_mfma_f32_16x16x32_bf16 v[136:139], v[32:35], a[200:203], v[136:139]
v_mfma_f32_16x16x32_bf16 v[136:139], v[36:39], a[216:219], v[136:139]
v_mfma_f32_16x16x32_bf16 v[172:175], v[36:39], a[220:223], v[172:175]
buffer_load_dwordx2 a[248:249], v20, s[32:35], s54 offen offset:1024 sc1
v_mfma_f32_16x16x32_bf16 v[172:175], v[32:35], a[204:207], v[172:175]
s_waitcnt lgkmcnt(4)
v_mfma_f32_16x16x32_bf16 v[68:71], v[40:43], a[192:195], v[68:71]
ds_read_b64_tr_b16 v[32:33], v5 offset:96
v_mfma_f32_16x16x32_bf16 v[68:71], v[44:47], a[208:211], v[68:71]
ds_read_b64_tr_b16 v[34:35], v5 offset:4704
v_mfma_f32_16x16x32_bf16 v[104:107], v[44:47], a[212:215], v[104:107]
ds_read_b64_tr_b16 v[36:37], v5 offset:18528
buffer_load_dwordx2 a[250:251], v20, s[32:35], s54 offen offset:1536 sc1
v_mfma_f32_16x16x32_bf16 v[104:107], v[40:43], a[196:199], v[104:107]
ds_read_b64_tr_b16 v[38:39], v5 offset:23136
v_mfma_f32_16x16x32_bf16 v[140:143], v[40:43], a[200:203], v[140:143]
v_mfma_f32_16x16x32_bf16 v[140:143], v[44:47], a[216:219], v[140:143]
buffer_load_dwordx2 a[252:253], v20, s[32:35], s55 offen offset:1024 sc1
v_mfma_f32_16x16x32_bf16 v[176:179], v[44:47], a[220:223], v[176:179]
v_mfma_f32_16x16x32_bf16 v[176:179], v[40:43], a[204:207], v[176:179]
s_waitcnt lgkmcnt(4)
v_mfma_f32_16x16x32_bf16 v[72:75], v[48:51], a[192:195], v[72:75]
ds_read_b64_tr_b16 v[40:41], v5 offset:128
v_mfma_f32_16x16x32_bf16 v[72:75], v[52:55], a[208:211], v[72:75]
ds_read_b64_tr_b16 v[42:43], v5 offset:4736
buffer_load_dwordx2 a[254:255], v20, s[32:35], s55 offen offset:1536 sc1
v_mfma_f32_16x16x32_bf16 v[108:111], v[52:55], a[212:215], v[108:111]
ds_read_b64_tr_b16 v[44:45], v5 offset:18560
v_mfma_f32_16x16x32_bf16 v[108:111], v[48:51], a[196:199], v[108:111]
ds_read_b64_tr_b16 v[46:47], v5 offset:23168
v_mfma_f32_16x16x32_bf16 v[144:147], v[48:51], a[200:203], v[144:147]
s_mov_b32 s67, 8388608
s_add_u32 m0, s50, 147456
v_mfma_f32_16x16x32_bf16 v[144:147], v[52:55], a[216:219], v[144:147]
v_mfma_f32_16x16x32_bf16 v[180:183], v[52:55], a[220:223], v[180:183]
v_mfma_f32_16x16x32_bf16 v[180:183], v[48:51], a[204:207], v[180:183]
s_waitcnt lgkmcnt(4)
v_mfma_f32_16x16x32_bf16 v[76:79], v[32:35], a[192:195], v[76:79]
ds_read_b64_tr_b16 v[48:49], v5 offset:160
buffer_load_dwordx4 v219, s[32:35], s67 offen sc1 lds
v_mfma_f32_16x16x32_bf16 v[76:79], v[36:39], a[208:211], v[76:79]
ds_read_b64_tr_b16 v[50:51], v5 offset:4768
v_mfma_f32_16x16x32_bf16 v[112:115], v[36:39], a[212:215], v[112:115]
ds_read_b64_tr_b16 v[52:53], v5 offset:18592
v_mfma_f32_16x16x32_bf16 v[112:115], v[32:35], a[196:199], v[112:115]
ds_read_b64_tr_b16 v[54:55], v5 offset:23200
v_mfma_f32_16x16x32_bf16 v[148:151], v[32:35], a[200:203], v[148:151]
s_mov_b32 s67, 8454144
s_add_u32 m0, s50, 148480
v_mfma_f32_16x16x32_bf16 v[148:151], v[36:39], a[216:219], v[148:151]
v_mfma_f32_16x16x32_bf16 v[184:187], v[36:39], a[220:223], v[184:187]
v_mfma_f32_16x16x32_bf16 v[184:187], v[32:35], a[204:207], v[184:187]
buffer_load_dwordx4 v219, s[32:35], s67 offen sc1 lds
s_waitcnt lgkmcnt(4)
v_mfma_f32_16x16x32_bf16 v[80:83], v[40:43], a[192:195], v[80:83]
ds_read_b64_tr_b16 v[32:33], v5 offset:192
v_mfma_f32_16x16x32_bf16 v[80:83], v[44:47], a[208:211], v[80:83]
ds_read_b64_tr_b16 v[34:35], v5 offset:4800
v_mfma_f32_16x16x32_bf16 v[116:119], v[44:47], a[212:215], v[116:119]
ds_read_b64_tr_b16 v[36:37], v5 offset:18624
v_mfma_f32_16x16x32_bf16 v[116:119], v[40:43], a[196:199], v[116:119]
ds_read_b64_tr_b16 v[38:39], v5 offset:23232
v_mfma_f32_16x16x32_bf16 v[152:155], v[40:43], a[200:203], v[152:155]
s_mov_b32 s67, 8519680
s_add_u32 m0, s50, 149504
v_mfma_f32_16x16x32_bf16 v[152:155], v[44:47], a[216:219], v[152:155]
buffer_load_dwordx4 v219, s[32:35], s67 offen sc1 lds
v_mfma_f32_16x16x32_bf16 v[188:191], v[44:47], a[220:223], v[188:191]
v_mfma_f32_16x16x32_bf16 v[188:191], v[40:43], a[204:207], v[188:191]
s_waitcnt lgkmcnt(4)
v_mfma_f32_16x16x32_bf16 v[84:87], v[48:51], a[192:195], v[84:87]
ds_read_b64_tr_b16 v[40:41], v5 offset:224
v_mfma_f32_16x16x32_bf16 v[84:87], v[52:55], a[208:211], v[84:87]
ds_read_b64_tr_b16 v[42:43], v5 offset:4832
s_add_u32 m0, s50, 36864
v_mfma_f32_16x16x32_bf16 v[120:123], v[52:55], a[212:215], v[120:123]
ds_read_b64_tr_b16 v[44:45], v5 offset:18656
v_mfma_f32_16x16x32_bf16 v[120:123], v[48:51], a[196:199], v[120:123]
ds_read_b64_tr_b16 v[46:47], v5 offset:23264
v_mfma_f32_16x16x32_bf16 v[156:159], v[48:51], a[200:203], v[156:159]
buffer_load_dwordx4 v216, s[36:39], s99 offen offset:0 lds
v_mfma_f32_16x16x32_bf16 v[156:159], v[52:55], a[216:219], v[156:159]
v_mfma_f32_16x16x32_bf16 v[192:195], v[52:55], a[220:223], v[192:195]
v_mfma_f32_16x16x32_bf16 v[192:195], v[48:51], a[204:207], v[192:195]
s_waitcnt lgkmcnt(4)
v_mfma_f32_16x16x32_bf16 v[88:91], v[32:35], a[192:195], v[88:91]
ds_read_b64_tr_b16 v[48:49], v5 offset:256
buffer_load_dwordx4 v217, s[36:39], s99 offen offset:1024 lds
v_mfma_f32_16x16x32_bf16 v[88:91], v[36:39], a[208:211], v[88:91]
ds_read_b64_tr_b16 v[50:51], v5 offset:4864
v_mfma_f32_16x16x32_bf16 v[124:127], v[36:39], a[212:215], v[124:127]
ds_read_b64_tr_b16 v[52:53], v5 offset:18688
v_mfma_f32_16x16x32_bf16 v[124:127], v[32:35], a[196:199], v[124:127]
ds_read_b64_tr_b16 v[54:55], v5 offset:23296
buffer_load_dwordx4 v218, s[36:39], s99 offen offset:2048 lds
v_mfma_f32_16x16x32_bf16 v[160:163], v[32:35], a[200:203], v[160:163]
v_mfma_f32_16x16x32_bf16 v[160:163], v[36:39], a[216:219], v[160:163]
v_mfma_f32_16x16x32_bf16 v[196:199], v[36:39], a[220:223], v[196:199]
v_mfma_f32_16x16x32_bf16 v[196:199], v[32:35], a[204:207], v[196:199]
s_add_u32 m0, s50, 49152
s_waitcnt lgkmcnt(4)
v_mfma_f32_16x16x32_bf16 v[92:95], v[40:43], a[192:195], v[92:95]
s_waitcnt lgkmcnt(0)
s_waitcnt vmcnt(12)
s_barrier
v_mfma_f32_16x16x32_bf16 v[92:95], v[44:47], a[208:211], v[92:95]
ds_read_b64_tr_b16 v[32:33], v2 offset:0
v_mfma_f32_16x16x32_bf16 v[128:131], v[44:47], a[212:215], v[128:131]
ds_read_b64_tr_b16 v[34:35], v2 offset:4608
buffer_load_dwordx4 v216, s[24:27], s99 offen offset:0 sc1 lds
v_mfma_f32_16x16x32_bf16 v[128:131], v[40:43], a[196:199], v[128:131]
ds_read_b64_tr_b16 v[36:37], v2 offset:18432
v_mfma_f32_16x16x32_bf16 v[164:167], v[40:43], a[200:203], v[164:167]
ds_read_b64_tr_b16 v[38:39], v2 offset:23040
v_mfma_f32_16x16x32_bf16 v[164:167], v[44:47], a[216:219], v[164:167]
v_mfma_f32_16x16x32_bf16 v[200:203], v[44:47], a[220:223], v[200:203]
buffer_load_dwordx4 v217, s[24:27], s99 offen offset:1024 sc1 lds
v_mfma_f32_16x16x32_bf16 v[200:203], v[40:43], a[204:207], v[200:203]
s_waitcnt lgkmcnt(4)
v_mfma_f32_16x16x32_bf16 v[96:99], v[48:51], a[192:195], v[96:99]
ds_read_b64_tr_b16 v[40:41], v2 offset:32
v_mfma_f32_16x16x32_bf16 v[96:99], v[52:55], a[208:211], v[96:99]
ds_read_b64_tr_b16 v[42:43], v2 offset:4640
buffer_load_dwordx4 v218, s[24:27], s99 offen offset:2048 sc1 lds
v_mfma_f32_16x16x32_bf16 v[132:135], v[52:55], a[212:215], v[132:135]
ds_read_b64_tr_b16 v[44:45], v2 offset:18464
v_mfma_f32_16x16x32_bf16 v[132:135], v[48:51], a[196:199], v[132:135]
ds_read_b64_tr_b16 v[46:47], v2 offset:23072
v_mfma_f32_16x16x32_bf16 v[168:171], v[48:51], a[200:203], v[168:171]
v_mfma_f32_16x16x32_bf16 v[168:171], v[52:55], a[216:219], v[168:171]
v_mfma_f32_16x16x32_bf16 v[204:207], v[52:55], a[220:223], v[204:207]
v_mfma_f32_16x16x32_bf16 v[204:207], v[48:51], a[204:207], v[204:207]
s_waitcnt lgkmcnt(4)
s_waitcnt vmcnt(9)
v_mfma_f32_16x16x32_bf16 v[64:67], v[32:35], a[224:227], v[64:67]
ds_read_b64_tr_b16 v[48:49], v2 offset:64
v_mfma_f32_16x16x32_bf16 v[64:67], v[36:39], a[240:243], v[64:67]
ds_read_b64_tr_b16 v[50:51], v2 offset:4672
v_mfma_f32_16x16x32_bf16 v[100:103], v[36:39], a[244:247], v[100:103]
ds_read_b64_tr_b16 v[52:53], v2 offset:18496
v_mfma_f32_16x16x32_bf16 v[100:103], v[32:35], a[228:231], v[100:103]
ds_read_b64_tr_b16 v[54:55], v2 offset:23104
v_mfma_f32_16x16x32_bf16 v[136:139], v[32:35], a[232:235], v[136:139]
v_mfma_f32_16x16x32_bf16 v[136:139], v[36:39], a[248:251], v[136:139]
v_mfma_f32_16x16x32_bf16 v[172:175], v[36:39], a[252:255], v[172:175]
v_mfma_f32_16x16x32_bf16 v[172:175], v[32:35], a[236:239], v[172:175]
s_waitcnt lgkmcnt(4)
v_mfma_f32_16x16x32_bf16 v[68:71], v[40:43], a[224:227], v[68:71]
ds_read_b64_tr_b16 v[32:33], v2 offset:96
v_mfma_f32_16x16x32_bf16 v[68:71], v[44:47], a[240:243], v[68:71]
ds_read_b64_tr_b16 v[34:35], v2 offset:4704
v_mfma_f32_16x16x32_bf16 v[104:107], v[44:47], a[244:247], v[104:107]
ds_read_b64_tr_b16 v[36:37], v2 offset:18528
v_mfma_f32_16x16x32_bf16 v[104:107], v[40:43], a[228:231], v[104:107]
ds_read_b64_tr_b16 v[38:39], v2 offset:23136
v_mfma_f32_16x16x32_bf16 v[140:143], v[40:43], a[232:235], v[140:143]
v_cvt_pk_bf16_f32 v56, v136, v137
v_cvt_pk_bf16_f32 v57, v138, v139
v_mfma_f32_16x16x32_bf16 v[140:143], v[44:47], a[248:251], v[140:143]
v_cvt_pk_bf16_f32 v58, v172, v173
v_cvt_pk_bf16_f32 v59, v174, v175
v_mfma_f32_16x16x32_bf16 v[176:179], v[44:47], a[252:255], v[176:179]
STUB_g8:
s_cbranch_execz NEXT_g8
ds_write_b128 v234, v[56:59] offset:0
v_mfma_f32_16x16x32_bf16 v[176:179], v[40:43], a[236:239], v[176:179]
s_waitcnt lgkmcnt(5)
v_mfma_f32_16x16x32_bf16 v[72:75], v[48:51], a[224:227], v[72:75]
ds_read_b64_tr_b16 v[40:41], v2 offset:128
v_mfma_f32_16x16x32_bf16 v[72:75], v[52:55], a[240:243], v[72:75]
ds_read_b64_tr_b16 v[42:43], v2 offset:4736
v_mfma_f32_16x16x32_bf16 v[108:111], v[52:55], a[244:247], v[108:111]
ds_read_b64_tr_b16 v[44:45], v2 offset:18560
v_mfma_f32_16x16x32_bf16 v[108:111], v[48:51], a[228:231], v[108:111]
ds_read_b64_tr_b16 v[46:47], v2 offset:23168
v_mfma_f32_16x16x32_bf16 v[144:147], v[48:51], a[232:235], v[144:147]
v_cvt_pk_bf16_f32 v60, v140, v141
v_cvt_pk_bf16_f32 v61, v142, v143
v_mfma_f32_16x16x32_bf16 v[144:147], v[52:55], a[248:251], v[144:147]
v_cvt_pk_bf16_f32 v62, v176, v177
v_cvt_pk_bf16_f32 v63, v178, v179
v_mfma_f32_16x16x32_bf16 v[180:183], v[52:55], a[252:255], v[180:183]
ds_write_b128 v234, v[60:63] offset:1024
v_mfma_f32_16x16x32_bf16 v[180:183], v[48:51], a[236:239], v[180:183]
s_waitcnt lgkmcnt(6)
v_mfma_f32_16x16x32_bf16 v[76:79], v[32:35], a[224:227], v[76:79]
ds_read_b64_tr_b16 v[48:49], v2 offset:160
v_mfma_f32_16x16x32_bf16 v[76:79], v[36:39], a[240:243], v[76:79]
ds_read_b64_tr_b16 v[50:51], v2 offset:4768
v_mfma_f32_16x16x32_bf16 v[112:115], v[36:39], a[244:247], v[112:115]
ds_read_b64_tr_b16 v[52:53], v2 offset:18592
v_mfma_f32_16x16x32_bf16 v[112:115], v[32:35], a[228:231], v[112:115]
ds_read_b64_tr_b16 v[54:55], v2 offset:23200
v_mfma_f32_16x16x32_bf16 v[148:151], v[32:35], a[232:235], v[148:151]
v_cvt_pk_bf16_f32 v56, v144, v145
v_cvt_pk_bf16_f32 v57, v146, v147
v_mfma_f32_16x16x32_bf16 v[148:151], v[36:39], a[248:251], v[148:151]
v_cvt_pk_bf16_f32 v58, v180, v181
v_cvt_pk_bf16_f32 v59, v182, v183
v_mfma_f32_16x16x32_bf16 v[184:187], v[36:39], a[252:255], v[184:187]
ds_write_b128 v234, v[56:59] offset:2048
v_mfma_f32_16x16x32_bf16 v[184:187], v[32:35], a[236:239], v[184:187]
s_waitcnt lgkmcnt(6)
v_mfma_f32_16x16x32_bf16 v[80:83], v[40:43], a[224:227], v[80:83]
ds_read_b64_tr_b16 v[32:33], v2 offset:192
v_mfma_f32_16x16x32_bf16 v[80:83], v[44:47], a[240:243], v[80:83]
ds_read_b64_tr_b16 v[34:35], v2 offset:4800
v_mfma_f32_16x16x32_bf16 v[116:119], v[44:47], a[244:247], v[116:119]
ds_read_b64_tr_b16 v[36:37], v2 offset:18624
v_mfma_f32_16x16x32_bf16 v[116:119], v[40:43], a[228:231], v[116:119]
ds_read_b64_tr_b16 v[38:39], v2 offset:23232
v_mfma_f32_16x16x32_bf16 v[152:155], v[40:43], a[232:235], v[152:155]
v_cvt_pk_bf16_f32 v60, v148, v149
v_cvt_pk_bf16_f32 v61, v150, v151
v_mfma_f32_16x16x32_bf16 v[152:155], v[44:47], a[248:251], v[152:155]
v_cvt_pk_bf16_f32 v62, v184, v185
v_cvt_pk_bf16_f32 v63, v186, v187
v_mfma_f32_16x16x32_bf16 v[188:191], v[44:47], a[252:255], v[188:191]
ds_write_b128 v234, v[60:63] offset:3072
v_mfma_f32_16x16x32_bf16 v[188:191], v[40:43], a[236:239], v[188:191]
s_waitcnt lgkmcnt(6)
v_mfma_f32_16x16x32_bf16 v[84:87], v[48:51], a[224:227], v[84:87]
ds_read_b64_tr_b16 v[40:41], v2 offset:224
v_mfma_f32_16x16x32_bf16 v[84:87], v[52:55], a[240:243], v[84:87]
ds_read_b64_tr_b16 v[42:43], v2 offset:4832
v_mfma_f32_16x16x32_bf16 v[120:123], v[52:55], a[244:247], v[120:123]
ds_read_b64_tr_b16 v[44:45], v2 offset:18656
v_mfma_f32_16x16x32_bf16 v[120:123], v[48:51], a[228:231], v[120:123]
ds_read_b64_tr_b16 v[46:47], v2 offset:23264
v_mfma_f32_16x16x32_bf16 v[156:159], v[48:51], a[232:235], v[156:159]
v_cvt_pk_bf16_f32 v56, v152, v153
v_cvt_pk_bf16_f32 v57, v154, v155
v_mfma_f32_16x16x32_bf16 v[156:159], v[52:55], a[248:251], v[156:159]
v_cvt_pk_bf16_f32 v58, v188, v189
v_cvt_pk_bf16_f32 v59, v190, v191
v_mfma_f32_16x16x32_bf16 v[192:195], v[52:55], a[252:255], v[192:195]
ds_write_b128 v234, v[56:59] offset:4096
v_mfma_f32_16x16x32_bf16 v[192:195], v[48:51], a[236:239], v[192:195]
s_waitcnt lgkmcnt(6)
v_mfma_f32_16x16x32_bf16 v[88:91], v[32:35], a[224:227], v[88:91]
ds_read_b64_tr_b16 v[48:49], v2 offset:256
v_mfma_f32_16x16x32_bf16 v[88:91], v[36:39], a[240:243], v[88:91]
ds_read_b64_tr_b16 v[50:51], v2 offset:4864
v_mfma_f32_16x16x32_bf16 v[124:127], v[36:39], a[244:247], v[124:127]
ds_read_b64_tr_b16 v[52:53], v2 offset:18688
v_mfma_f32_16x16x32_bf16 v[124:127], v[32:35], a[228:231], v[124:127]
ds_read_b64_tr_b16 v[54:55], v2 offset:23296
v_mfma_f32_16x16x32_bf16 v[160:163], v[32:35], a[232:235], v[160:163]
v_cvt_pk_bf16_f32 v60, v156, v157
v_cvt_pk_bf16_f32 v61, v158, v159
v_mfma_f32_16x16x32_bf16 v[160:163], v[36:39], a[248:251], v[160:163]
v_cvt_pk_bf16_f32 v62, v192, v193
v_cvt_pk_bf16_f32 v63, v194, v195
v_mfma_f32_16x16x32_bf16 v[196:199], v[36:39], a[252:255], v[196:199]
ds_write_b128 v234, v[60:63] offset:5120
v_mfma_f32_16x16x32_bf16 v[196:199], v[32:35], a[236:239], v[196:199]
s_waitcnt lgkmcnt(6)
v_mfma_f32_16x16x32_bf16 v[92:95], v[40:43], a[224:227], v[92:95]
v_mfma_f32_16x16x32_bf16 v[92:95], v[44:47], a[240:243], v[92:95]
v_mfma_f32_16x16x32_bf16 v[128:131], v[44:47], a[244:247], v[128:131]
v_mfma_f32_16x16x32_bf16 v[128:131], v[40:43], a[228:231], v[128:131]
v_mfma_f32_16x16x32_bf16 v[164:167], v[40:43], a[232:235], v[164:167]
v_cvt_pk_bf16_f32 v56, v160, v161
v_cvt_pk_bf16_f32 v57, v162, v163
v_mfma_f32_16x16x32_bf16 v[164:167], v[44:47], a[248:251], v[164:167]
v_cvt_pk_bf16_f32 v58, v196, v197
v_cvt_pk_bf16_f32 v59, v198, v199
v_mfma_f32_16x16x32_bf16 v[200:203], v[44:47], a[252:255], v[200:203]
ds_write_b128 v234, v[56:59] offset:6144
v_mfma_f32_16x16x32_bf16 v[200:203], v[40:43], a[236:239], v[200:203]
s_waitcnt lgkmcnt(2)
v_mfma_f32_16x16x32_bf16 v[96:99], v[48:51], a[224:227], v[96:99]
v_mfma_f32_16x16x32_bf16 v[96:99], v[52:55], a[240:243], v[96:99]
v_mfma_f32_16x16x32_bf16 v[132:135], v[52:55], a[244:247], v[132:135]
v_mfma_f32_16x16x32_bf16 v[132:135], v[48:51], a[228:231], v[132:135]
v_mfma_f32_16x16x32_bf16 v[168:171], v[48:51], a[232:235], v[168:171]
v_mfma_f32_16x16x32_bf16 v[168:171], v[52:55], a[248:251], v[168:171]
v_mfma_f32_16x16x32_bf16 v[204:207], v[52:55], a[252:255], v[204:207]
v_mfma_f32_16x16x32_bf16 v[204:207], v[48:51], a[236:239], v[204:207]
s_branch FINAL
NOCONV:
s_add_u32 s44, s56, 0x4000
s_add_u32 s51, s56, 0x8000
s_add_u32 s66, s64, 0
s_add_u32 s66, s66, s63
s_add_u32 m0, s65, 0
s_nop 0
buffer_load_dwordx4 v8, s[16:19], s66 offen offset:0 lds
buffer_load_dwordx4 v9, s[16:19], s66 offen offset:1024 lds
buffer_load_dwordx4 v10, s[16:19], s66 offen offset:2048 lds
buffer_load_dwordx4 v11, s[16:19], s66 offen offset:3072 lds
s_add_u32 m0, s65, 4096
s_nop 0
buffer_load_dwordx4 v12, s[16:19], s66 offen offset:0 lds
buffer_load_dwordx4 v13, s[16:19], s66 offen offset:1024 lds
buffer_load_dwordx4 v14, s[16:19], s66 offen offset:2048 lds
buffer_load_dwordx4 v15, s[16:19], s66 offen offset:3072 lds
s_add_u32 m0, s65, 8192
s_nop 0
buffer_load_dwordx4 v16, s[16:19], s66 offen offset:0 lds
buffer_load_dwordx4 a[16:19], v7, s[32:35], s52 offen offset:3072 sc1
buffer_load_dwordx4 a[20:23], v7, s[32:35], s53 offen offset:3072 sc1
buffer_load_dwordx4 a[24:27], v7, s[32:35], s54 offen offset:3072 sc1
buffer_load_dwordx4 a[28:31], v7, s[32:35], s55 offen offset:3072 sc1
s_add_u32 s66, s64, 73728
s_add_u32 s66, s66, s63
s_add_u32 m0, s65, 36864
s_nop 0
buffer_load_dwordx4 v8, s[16:19], s66 offen offset:0 lds
buffer_load_dwordx4 v9, s[16:19], s66 offen offset:1024 lds
buffer_load_dwordx4 v10, s[16:19], s66 offen offset:2048 lds
buffer_load_dwordx4 v11, s[16:19], s66 offen offset:3072 lds
s_add_u32 m0, s65, 40960
s_nop 0
buffer_load_dwordx4 v12, s[16:19], s66 offen offset:0 lds
buffer_load_dwordx4 v13, s[16:19], s66 offen offset:1024 lds
buffer_load_dwordx4 v14, s[16:19], s66 offen offset:2048 lds
buffer_load_dwordx4 v15, s[16:19], s66 offen offset:3072 lds
s_add_u32 m0, s65, 45056
s_nop 0
buffer_load_dwordx4 v16, s[16:19], s66 offen offset:0 lds
buffer_load_dwordx4 a[32:35], v29, s[32:35], s52 offen offset:2048 sc1
buffer_load_dwordx4 a[36:39], v29, s[32:35], s53 offen offset:2048 sc1
buffer_load_dwordx4 a[40:43], v29, s[32:35], s54 offen offset:2048 sc1
buffer_load_dwordx4 a[44:47], v29, s[32:35], s55 offen offset:2048 sc1
s_waitcnt vmcnt(17)
s_barrier
ds_read_b64_tr_b16 v[32:33], v2 offset:0
ds_read_b64_tr_b16 v[34:35], v2 offset:4608
ds_read_b64_tr_b16 v[36:37], v2 offset:18432
ds_read_b64_tr_b16 v[38:39], v2 offset:23040
ds_read_b64_tr_b16 v[40:41], v2 offset:32
ds_read_b64_tr_b16 v[42:43], v2 offset:4640
ds_read_b64_tr_b16 v[44:45], v2 offset:18464
ds_read_b64_tr_b16 v[46:47], v2 offset:23072
s_waitcnt vmcnt(35)
s_waitcnt lgkmcnt(4)
v_mfma_f32_16x16x32_bf16 v[64:67], v[32:35], v[224:227], 0
ds_read_b64_tr_b16 v[48:49], v2 offset:64
s_lshl_b32 s43, s40, 2
v_mfma_f32_16x16x32_bf16 v[64:67], v[36:39], v[240:243], v[64:67]
ds_read_b64_tr_b16 v[50:51], v2 offset:4672
buffer_load_dwordx2 v[22:23], v19, s[32:35], s44 offen sc1
v_mfma_f32_16x16x32_bf16 v[100:103], v[36:39], v[244:247], 0
ds_read_b64_tr_b16 v[52:53], v2 offset:18496
s_add_u32 s43, s43, s41
v_mfma_f32_16x16x32_bf16 v[100:103], v[32:35], v[228:231], v[100:103]
ds_read_b64_tr_b16 v[54:55], v2 offset:23104
buffer_load_dwordx4 a[48:51], v29, s[32:35], s52 offen offset:3072 sc1
v_mfma_f32_16x16x32_bf16 v[136:139], v[32:35], v[232:235], 0
v_mfma_f32_16x16x32_bf16 v[136:139], v[36:39], v[248:251], v[136:139]
s_mul_i32 s45, s42, 144
v_mfma_f32_16x16x32_bf16 v[172:175], v[36:39], v[252:255], 0
buffer_load_dwordx4 a[52:55], v29, s[32:35], s53 offen offset:3072 sc1
v_mfma_f32_16x16x32_bf16 v[172:175], v[32:35], v[236:239], v[172:175]
s_waitcnt lgkmcnt(4)
v_mfma_f32_16x16x32_bf16 v[68:71], v[40:43], v[224:227], 0
ds_read_b64_tr_b16 v[32:33], v2 offset:96
v_mfma_f32_16x16x32_bf16 v[68:71], v[44:47], v[240:243], v[68:71]
ds_read_b64_tr_b16 v[34:35], v2 offset:4704
buffer_load_dwordx4 a[56:59], v29, s[32:35], s54 offen offset:3072 sc1
v_mfma_f32_16x16x32_bf16 v[104:107], v[44:47], v[244:247], 0
ds_read_b64_tr_b16 v[36:37], v2 offset:18528
v_mfma_f32_16x16x32_bf16 v[104:107], v[40:43], v[228:231], v[104:107]
ds_read_b64_tr_b16 v[38:39], v2 offset:23136
v_mfma_f32_16x16x32_bf16 v[140:143], v[40:43], v[232:235], 0
s_cmp_lt_u32 s14, 3
s_cselect_b32 s61, 0, 2146435072
v_mfma_f32_16x16x32_bf16 v[140:143], v[44:47], v[248:251], v[140:143]
s_mul_i32 s50, s14, 3072
s_mul_i32 s100, s42, 288
v_mfma_f32_16x16x32_bf16 v[176:179], v[44:47], v[252:255], 0
buffer_load_dwordx4 a[60:63], v29, s[32:35], s55 offen offset:3072 sc1
v_mfma_f32_16x16x32_bf16 v[176:179], v[40:43], v[236:239], v[176:179]
s_waitcnt lgkmcnt(4)
v_mfma_f32_16x16x32_bf16 v[72:75], v[48:51], v[224:227], 0
ds_read_b64_tr_b16 v[40:41], v2 offset:128
s_add_u32 s100, s100, 63045632
v_mfma_f32_16x16x32_bf16 v[72:75], v[52:55], v[240:243], v[72:75]
ds_read_b64_tr_b16 v[42:43], v2 offset:4736
buffer_load_dwordx4 a[64:67], v30, s[32:35], s52 offen offset:0 sc1
v_mfma_f32_16x16x32_bf16 v[108:111], v[52:55], v[244:247], 0
ds_read_b64_tr_b16 v[44:45], v2 offset:18560
v_mfma_f32_16x16x32_bf16 v[108:111], v[48:51], v[228:231], v[108:111]
ds_read_b64_tr_b16 v[46:47], v2 offset:23168
s_lshl_b32 s58, s2, 3
v_mfma_f32_16x16x32_bf16 v[144:147], v[48:51], v[232:235], 0
buffer_load_dwordx4 a[68:71], v30, s[32:35], s53 offen offset:0 sc1
v_mfma_f32_16x16x32_bf16 v[144:147], v[52:55], v[248:251], v[144:147]
v_mfma_f32_16x16x32_bf16 v[180:183], v[52:55], v[252:255], 0
s_add_u32 s58, s58, 63044736
v_mfma_f32_16x16x32_bf16 v[180:183], v[48:51], v[236:239], v[180:183]
buffer_load_dwordx4 a[72:75], v30, s[32:35], s54 offen offset:0 sc1
s_waitcnt lgkmcnt(4)
v_mfma_f32_16x16x32_bf16 v[76:79], v[32:35], v[224:227], 0
ds_read_b64_tr_b16 v[48:49], v2 offset:160
v_mfma_f32_16x16x32_bf16 v[76:79], v[36:39], v[240:243], v[76:79]
ds_read_b64_tr_b16 v[50:51], v2 offset:4768
v_mfma_f32_16x16x32_bf16 v[112:115], v[36:39], v[244:247], 0
ds_read_b64_tr_b16 v[52:53], v2 offset:18592
buffer_load_dwordx4 a[76:79], v30, s[32:35], s55 offen offset:0 sc1
v_mfma_f32_16x16x32_bf16 v[112:115], v[32:35], v[228:231], v[112:115]
ds_read_b64_tr_b16 v[54:55], v2 offset:23200
v_mfma_f32_16x16x32_bf16 v[148:151], v[32:35], v[232:235], 0
s_cmp_eq_u32 s14, 0
s_cselect_b32 s59, s62, 2146435072
v_mfma_f32_16x16x32_bf16 v[148:151], v[36:39], v[248:251], v[148:151]
s_add_u32 s101, s58, s59
v_mfma_f32_16x16x32_bf16 v[184:187], v[36:39], v[252:255], 0
s_mov_b32 s36, s68
v_mfma_f32_16x16x32_bf16 v[184:187], v[32:35], v[236:239], v[184:187]
s_add_u32 s66, s64, 368640
s_add_u32 s66, s66, s63
s_add_u32 m0, s65, 73728
s_waitcnt lgkmcnt(4)
v_mfma_f32_16x16x32_bf16 v[80:83], v[40:43], v[224:227], 0
ds_read_b64_tr_b16 v[32:33], v2 offset:192
buffer_load_dwordx4 v8, s[16:19], s66 offen offset:0 lds
v_mfma_f32_16x16x32_bf16 v[80:83], v[44:47], v[240:243], v[80:83]
ds_read_b64_tr_b16 v[34:35], v2 offset:4800
s_mov_b32 s37, s69
v_mfma_f32_16x16x32_bf16 v[116:119], v[44:47], v[244:247], 0
ds_read_b64_tr_b16 v[36:37], v2 offset:18624
v_mfma_f32_16x16x32_bf16 v[116:119], v[40:43], v[228:231], v[116:119]
ds_read_b64_tr_b16 v[38:39], v2 offset:23232
s_mov_b32 s38, 2359296
v_mfma_f32_16x16x32_bf16 v[152:155], v[40:43], v[232:235], 0
buffer_load_dwordx4 v9, s[16:19], s66 offen offset:1024 lds
v_mfma_f32_16x16x32_bf16 v[152:155], v[44:47], v[248:251], v[152:155]
v_mfma_f32_16x16x32_bf16 v[188:191], v[44:47], v[252:255], 0
s_mov_b32 s39, 0x20000
v_mfma_f32_16x16x32_bf16 v[188:191], v[40:43], v[236:239], v[188:191]
buffer_load_dwordx4 v10, s[16:19], s66 offen offset:2048 lds
s_waitcnt lgkmcnt(4)
v_mfma_f32_16x16x32_bf16 v[84:87], v[48:51], v[224:227], 0
ds_read_b64_tr_b16 v[40:41], v2 offset:224
v_mfma_f32_16x16x32_bf16 v[84:87], v[52:55], v[240:243], v[84:87]
ds_read_b64_tr_b16 v[42:43], v2 offset:4832
s_mul_i32 s99, s43, 36864
v_mfma_f32_16x16x32_bf16 v[120:123], v[52:55], v[244:247], 0
ds_read_b64_tr_b16 v[44:45], v2 offset:18656
buffer_load_dwordx4 v11, s[16:19], s66 offen offset:3072 lds
v_mfma_f32_16x16x32_bf16 v[120:123], v[48:51], v[228:231], v[120:123]
ds_read_b64_tr_b16 v[46:47], v2 offset:23264
v_mfma_f32_16x16x32_bf16 v[156:159], v[48:51], v[232:235], 0
s_lshl_b32 s58, s45, 1
v_mfma_f32_16x16x32_bf16 v[156:159], v[52:55], v[248:251], v[156:159]
v_mfma_f32_16x16x32_bf16 v[192:195], v[52:55], v[252:255], 0
s_add_u32 s99, s99, s58
s_add_u32 m0, s65, 77824
v_mfma_f32_16x16x32_bf16 v[192:195], v[48:51], v[236:239], v[192:195]
s_waitcnt lgkmcnt(4)
v_mfma_f32_16x16x32_bf16 v[88:91], v[32:35], v[224:227], 0
ds_read_b64_tr_b16 v[48:49], v2 offset:256
v_mfma_f32_16x16x32_bf16 v[88:91], v[36:39], v[240:243], v[88:91]
ds_read_b64_tr_b16 v[50:51], v2 offset:4864
v_min_u32 v6, 35, v1
v_mfma_f32_16x16x32_bf16 v[124:127], v[36:39], v[244:247], 0
ds_read_b64_tr_b16 v[52:53], v2 offset:18688
buffer_load_dwordx4 v12, s[16:19], s66 offen offset:0 lds
v_mfma_f32_16x16x32_bf16 v[124:127], v[32:35], v[228:231], v[124:127]
ds_read_b64_tr_b16 v[54:55], v2 offset:23296
v_mfma_f32_16x16x32_bf16 v[160:163], v[32:35], v[232:235], 0
v_lshlrev_b32 v6, 3, v6
buffer_load_dwordx4 v13, s[16:19], s66 offen offset:1024 lds
v_mfma_f32_16x16x32_bf16 v[160:163], v[36:39], v[248:251], v[160:163]
v_mfma_f32_16x16x32_bf16 v[196:199], v[36:39], v[252:255], 0
v_mfma_f32_16x16x32_bf16 v[196:199], v[32:35], v[236:239], v[196:199]
buffer_load_dwordx4 v14, s[16:19], s66 offen offset:2048 lds
s_waitcnt lgkmcnt(4)
v_mfma_f32_16x16x32_bf16 v[92:95], v[40:43], v[224:227], 0
s_waitcnt vmcnt(15)
s_barrier
v_mfma_f32_16x16x32_bf16 v[92:95], v[44:47], v[240:243], v[92:95]
ds_read_b64_tr_b16 v[32:33], v3 offset:0
v_mfma_f32_16x16x32_bf16 v[128:131], v[44:47], v[244:247], 0
ds_read_b64_tr_b16 v[34:35], v3 offset:4608
v_mfma_f32_16x16x32_bf16 v[128:131], v[40:43], v[228:231], v[128:131]
ds_read_b64_tr_b16 v[36:37], v3 offset:18432
buffer_load_dwordx4 v15, s[16:19], s66 offen offset:3072 lds
v_mfma_f32_16x16x32_bf16 v[164:167], v[40:43], v[232:235], 0
ds_read_b64_tr_b16 v[38:39], v3 offset:23040
v_mfma_f32_16x16x32_bf16 v[164:167], v[44:47], v[248:251], v[164:167]
v_cmp_ne_u64 vcc, s[94:95], v[22:23]
s_nop 1
s_cmp_lg_u64 vcc, 0
s_cbranch_scc1 SLOW_F3Bk
BACK_F3Bk:
v_mfma_f32_16x16x32_bf16 v[200:203], v[44:47], v[252:255], 0
s_add_u32 m0, s65, 81920
v_mfma_f32_16x16x32_bf16 v[200:203], v[40:43], v[236:239], v[200:203]
s_waitcnt lgkmcnt(4)
v_mfma_f32_16x16x32_bf16 v[96:99], v[48:51], v[224:227], 0
ds_read_b64_tr_b16 v[40:41], v3 offset:32
v_mfma_f32_16x16x32_bf16 v[96:99], v[52:55], v[240:243], v[96:99]
ds_read_b64_tr_b16 v[42:43], v3 offset:4640
buffer_load_dwordx4 v16, s[16:19], s66 offen offset:0 lds
v_mfma_f32_16x16x32_bf16 v[132:135], v[52:55], v[244:247], 0
ds_read_b64_tr_b16 v[44:45], v3 offset:18464
v_mfma_f32_16x16x32_bf16 v[132:135], v[48:51], v[228:231], v[132:135]
ds_read_b64_tr_b16 v[46:47], v3 offset:23072
v_mfma_f32_16x16x32_bf16 v[168:171], v[48:51], v[232:235], 0
s_waitcnt vmcnt(44)
s_add_u32 s67, s57, 0x8000
buffer_store_dwordx2 v[26:27], v25, s[32:35], s67 offen sc1
v_mfma_f32_16x16x32_bf16 v[168:171], v[52:55], v[248:251], v[168:171]
v_mfma_f32_16x16x32_bf16 v[204:207], v[52:55], v[252:255], 0
v_mfma_f32_16x16x32_bf16 v[204:207], v[48:51], v[236:239], v[204:207]
s_waitcnt lgkmcnt(4)
s_waitcnt vmcnt(31)
v_mfma_f32_16x16x32_bf16 v[64:67], v[32:35], a[0:3], v[64:67]
ds_read_b64_tr_b16 v[48:49], v3 offset:64
buffer_load_dwordx4 a[80:83], v30, s[32:35], s52 offen offset:1024 sc1
v_mfma_f32_16x16x32_bf16 v[64:67], v[36:39], a[16:19], v[64:67]
ds_read_b64_tr_b16 v[50:51], v3 offset:4672
v_mfma_f32_16x16x32_bf16 v[100:103], v[36:39], a[20:23], v[100:103]
ds_read_b64_tr_b16 v[52:53], v3 offset:18496
v_mfma_f32_16x16x32_bf16 v[100:103], v[32:35], a[4:7], v[100:103]
ds_read_b64_tr_b16 v[54:55], v3 offset:23104
v_mfma_f32_16x16x32_bf16 v[136:139], v[32:35], a[8:11], v[136:139]
buffer_load_dwordx4 a[84:87], v30, s[32:35], s53 offen offset:1024 sc1
v_mfma_f32_16x16x32_bf16 v[136:139], v[36:39], a[24:27], v[136:139]
v_mfma_f32_16x16x32_bf16 v[172:175], v[36:39], a[28:31], v[172:175]
v_mfma_f32_16x16x32_bf16 v[172:175], v[32:35], a[12:15], v[172:175]
s_waitcnt lgkmcnt(4)
v_mfma_f32_16x16x32_bf16 v[68:71], v[40:43], a[0:3], v[68:71]
ds_read_b64_tr_b16 v[32:33], v3 offset:96
buffer_load_dwordx4 a[88:91], v30, s[32:35], s54 offen offset:1024 sc1
v_mfma_f32_16x16x32_bf16 v[68:71], v[44:47], a[16:19], v[68:71]
ds_read_b64_tr_b16 v[34:35], v3 offset:4704
v_mfma_f32_16x16x32_bf16 v[104:107], v[44:47], a[20:23], v[104:107]
ds_read_b64_tr_b16 v[36:37], v3 offset:18528
v_mfma_f32_16x16x32_bf16 v[104:107], v[40:43], a[4:7], v[104:107]
ds_read_b64_tr_b16 v[38:39], v3 offset:23136
v_mfma_f32_16x16x32_bf16 v[140:143], v[40:43], a[8:11], v[140:143]
buffer_load_dwordx4 a[92:95], v30, s[32:35], s55 offen offset:1024 sc1
v_mfma_f32_16x16x32_bf16 v[140:143], v[44:47], a[24:27], v[140:143]
v_mfma_f32_16x16x32_bf16 v[176:179], v[44:47], a[28:31], v[176:179]
v_mfma_f32_16x16x32_bf16 v[176:179], v[40:43], a[12:15], v[176:179]
s_waitcnt lgkmcnt(4)
v_mfma_f32_16x16x32_bf16 v[72:75], v[48:51], a[0:3], v[72:75]
ds_read_b64_tr_b16 v[40:41], v3 offset:128
v_mfma_f32_16x16x32_bf16 v[72:75], v[52:55], a[16:19], v[72:75]
ds_read_b64_tr_b16 v[42:43], v3 offset:4736
v_mfma_f32_16x16x32_bf16 v[108:111], v[52:55], a[20:23], v[108:111]
ds_read_b64_tr_b16 v[44:45], v3 offset:18560
v_mfma_f32_16x16x32_bf16 v[108:111], v[48:51], a[4:7], v[108:111]
ds_read_b64_tr_b16 v[46:47], v3 offset:23168
v_mfma_f32_16x16x32_bf16 v[144:147], v[48:51], a[8:11], v[144:147]
s_add_u32 s66, s64, 442368
s_add_u32 s66, s66, s63
s_add_u32 m0, s65, 110592
v_mfma_f32_16x16x32_bf16 v[144:147], v[52:55], a[24:27], v[144:147]
buffer_load_dwordx4 v8, s[16:19], s66 offen offset:0 lds
v_mfma_f32_16x16x32_bf16 v[180:183], v[52:55], a[28:31], v[180:183]
v_mfma_f32_16x16x32_bf16 v[180:183], v[48:51], a[12:15], v[180:183]
s_waitcnt lgkmcnt(4)
v_mfma_f32_16x16x32_bf16 v[76:79], v[32:35], a[0:3], v[76:79]
ds_read_b64_tr_b16 v[48:49], v3 offset:160
v_mfma_f32_16x16x32_bf16 v[76:79], v[36:39], a[16:19], v[76:79]
ds_read_b64_tr_b16 v[50:51], v3 offset:4768
buffer_load_dwordx4 v9, s[16:19], s66 offen offset:1024 lds
v_mfma_f32_16x16x32_bf16 v[112:115], v[36:39], a[20:23], v[112:115]
ds_read_b64_tr_b16 v[52:53], v3 offset:18592
v_mfma_f32_16x16x32_bf16 v[112:115], v[32:35], a[4:7], v[112:115]
ds_read_b64_tr_b16 v[54:55], v3 offset:23200
v_mfma_f32_16x16x32_bf16 v[148:151], v[32:35], a[8:11], v[148:151]
v_mfma_f32_16x16x32_bf16 v[148:151], v[36:39], a[24:27], v[148:151]
v_mfma_f32_16x16x32_bf16 v[184:187], v[36:39], a[28:31], v[184:187]
buffer_load_dwordx4 v10, s[16:19], s66 offen offset:2048 lds
v_mfma_f32_16x16x32_bf16 v[184:187], v[32:35], a[12:15], v[184:187]
s_waitcnt lgkmcnt(4)
v_mfma_f32_16x16x32_bf16 v[80:83], v[40:43], a[0:3], v[80:83]
ds_read_b64_tr_b16 v[32:33], v3 offset:192
v_mfma_f32_16x16x32_bf16 v[80:83], v[44:47], a[16:19], v[80:83]
ds_read_b64_tr_b16 v[34:35], v3 offset:4800
v_mfma_f32_16x16x32_bf16 v[116:119], v[44:47], a[20:23], v[116:119]
ds_read_b64_tr_b16 v[36:37], v3 offset:18624
buffer_load_dwordx4 v11, s[16:19], s66 offen offset:3072 lds
v_mfma_f32_16x16x32_bf16 v[116:119], v[40:43], a[4:7], v[116:119]
ds_read_b64_tr_b16 v[38:39], v3 offset:23232
v_mfma_f32_16x16x32_bf16 v[152:155], v[40:43], a[8:11], v[152:155]
v_mfma_f32_16x16x32_bf16 v[152:155], v[44:47], a[24:27], v[152:155]
v_mfma_f32_16x16x32_bf16 v[188:191], v[44:47], a[28:31], v[188:191]
s_add_u32 m0, s65, 114688
v_mfma_f32_16x16x32_bf16 v[188:191], v[40:43], a[12:15], v[188:191]
s_waitcnt lgkmcnt(4)
v_mfma_f32_16x16x32_bf16 v[84:87], v[48:51], a[0:3], v[84:87]
ds_read_b64_tr_b16 v[40:41], v3 offset:224
v_mfma_f32_16x16x32_bf16 v[84:87], v[52:55], a[16:19], v[84:87]
ds_read_b64_tr_b16 v[42:43], v3 offset:4832
v_mfma_f32_16x16x32_bf16 v[120:123], v[52:55], a[20:23], v[120:123]
ds_read_b64_tr_b16 v[44:45], v3 offset:18656
v_mfma_f32_16x16x32_bf16 v[120:123], v[48:51], a[4:7], v[120:123]
ds_read_b64_tr_b16 v[46:47], v3 offset:23264
buffer_load_dwordx4 v12, s[16:19], s66 offen offset:0 lds
v_mfma_f32_16x16x32_bf16 v[156:159], v[48:51], a[8:11], v[156:159]
v_mfma_f32_16x16x32_bf16 v[156:159], v[52:55], a[24:27], v[156:159]
v_mfma_f32_16x16x32_bf16 v[192:195], v[52:55], a[28:31], v[192:195]
v_mfma_f32_16x16x32_bf16 v[192:195], v[48:51], a[12:15], v[192:195]
buffer_load_dwordx4 v13, s[16:19], s66 offen offset:1024 lds
s_waitcnt lgkmcnt(4)
v_mfma_f32_16x16x32_bf16 v[88:91], v[32:35], a[0:3], v[88:91]
ds_read_b64_tr_b16 v[48:49], v3 offset:256
v_mfma_f32_16x16x32_bf16 v[88:91], v[36:39], a[16:19], v[88:91]
ds_read_b64_tr_b16 v[50:51], v3 offset:4864
v_mfma_f32_16x16x32_bf16 v[124:127], v[36:39], a[20:23], v[124:127]
ds_read_b64_tr_b16 v[52:53], v3 offset:18688
v_mfma_f32_16x16x32_bf16 v[124:127], v[32:35], a[4:7], v[124:127]
ds_read_b64_tr_b16 v[54:55], v3 offset:23296
buffer_load_dwordx4 v14, s[16:19], s66 offen offset:2048 lds
v_mfma_f32_16x16x32_bf16 v[160:163], v[32:35], a[8:11], v[160:163]
v_mfma_f32_16x16x32_bf16 v[160:163], v[36:39], a[24:27], v[160:163]
v_mfma_f32_16x16x32_bf16 v[196:199], v[36:39], a[28:31], v[196:199]
v_mfma_f32_16x16x32_bf16 v[196:199], v[32:35], a[12:15], v[196:199]
s_waitcnt lgkmcnt(4)
v_mfma_f32_16x16x32_bf16 v[92:95], v[40:43], a[0:3], v[92:95]
s_waitcnt vmcnt(11)
s_barrier
v_mfma_f32_16x16x32_bf16 v[92:95], v[44:47], a[16:19], v[92:95]
ds_read_b64_tr_b16 v[32:33], v4 offset:0
buffer_load_dwordx4 v15, s[16:19], s66 offen offset:3072 lds
v_mfma_f32_16x16x32_bf16 v[128:131], v[44:47], a[20:23], v[128:131]
ds_read_b64_tr_b16 v[34:35], v4 offset:4608
v_mfma_f32_16x16x32_bf16 v[128:131], v[40:43], a[4:7], v[128:131]
ds_read_b64_tr_b16 v[36:37], v4 offset:18432
v_mfma_f32_16x16x32_bf16 v[164:167], v[40:43], a[8:11], v[164:167]
ds_read_b64_tr_b16 v[38:39], v4 offset:23040
s_add_u32 m0, s65, 118784
v_mfma_f32_16x16x32_bf16 v[164:167], v[44:47], a[24:27], v[164:167]
v_mfma_f32_16x16x32_bf16 v[200:203], v[44:47], a[28:31], v[200:203]
v_mfma_f32_16x16x32_bf16 v[200:203], v[40:43], a[12:15], v[200:203]
s_waitcnt lgkmcnt(4)
v_mfma_f32_16x16x32_bf16 v[96:99], v[48:51], a[0:3], v[96:99]
ds_read_b64_tr_b16 v[40:41], v4 offset:32
buffer_load_dwordx4 v16, s[16:19], s66 offen offset:0 lds
v_mfma_f32_16x16x32_bf16 v[96:99], v[52:55], a[16:19], v[96:99]
ds_read_b64_tr_b16 v[42:43], v4 offset:4640
v_mfma_f32_16x16x32_bf16 v[132:135], v[52:55], a[20:23], v[132:135]
ds_read_b64_tr_b16 v[44:45], v4 offset:18464
v_mfma_f32_16x16x32_bf16 v[132:135], v[48:51], a[4:7], v[132:135]
ds_read_b64_tr_b16 v[46:47], v4 offset:23072
v_mfma_f32_16x16x32_bf16 v[168:171], v[48:51], a[8:11], v[168:171]
v_mfma_f32_16x16x32_bf16 v[168:171], v[52:55], a[24:27], v[168:171]
v_mfma_f32_16x16x32_bf16 v[204:207], v[52:55], a[28:31], v[204:207]
v_mfma_f32_16x16x32_bf16 v[204:207], v[48:51], a[12:15], v[204:207]
s_waitcnt lgkmcnt(4)
s_waitcnt vmcnt(26)
v_mfma_f32_16x16x32_bf16 v[64:67], v[32:35], a[32:35], v[64:67]
ds_read_b64_tr_b16 v[48:49], v4 offset:64
buffer_load_dwordx2 v[22:23], v19, s[32:35], s51 offen sc1
v_mfma_f32_16x16x32_bf16 v[64:67], v[36:39], a[48:51], v[64:67]
ds_read_b64_tr_b16 v[50:51], v4 offset:4672
v_mfma_f32_16x16x32_bf16 v[100:103], v[36:39], a[52:55], v[100:103]
ds_read_b64_tr_b16 v[52:53], v4 offset:18496
v_mfma_f32_16x16x32_bf16 v[100:103], v[32:35], a[36:39], v[100:103]
ds_read_b64_tr_b16 v[54:55], v4 offset:23104
buffer_load_dwordx4 a[96:99], v28, s[32:35], s52 offen offset:0 sc1
v_mfma_f32_16x16x32_bf16 v[136:139], v[32:35], a[40:43], v[136:139]
v_mfma_f32_16x16x32_bf16 v[136:139], v[36:39], a[56:59], v[136:139]
v_mfma_f32_16x16x32_bf16 v[172:175], v[36:39], a[60:63], v[172:175]
buffer_load_dwordx4 a[100:103], v28, s[32:35], s53 offen offset:0 sc1
v_mfma_f32_16x16x32_bf16 v[172:175], v[32:35], a[44:47], v[172:175]
s_waitcnt lgkmcnt(4)
v_mfma_f32_16x16x32_bf16 v[68:71], v[40:43], a[32:35], v[68:71]
ds_read_b64_tr_b16 v[32:33], v4 offset:96
v_mfma_f32_16x16x32_bf16 v[68:71], v[44:47], a[48:51], v[68:71]
ds_read_b64_tr_b16 v[34:35], v4 offset:4704
buffer_load_dwordx4 a[104:107], v28, s[32:35], s54 offen offset:0 sc1
v_mfma_f32_16x16x32_bf16 v[104:107], v[44:47], a[52:55], v[104:107]
ds_read_b64_tr_b16 v[36:37], v4 offset:18528
v_mfma_f32_16x16x32_bf16 v[104:107], v[40:43], a[36:39], v[104:107]
ds_read_b64_tr_b16 v[38:39], v4 offset:23136
v_mfma_f32_16x16x32_bf16 v[140:143], v[40:43], a[40:43], v[140:143]
v_mfma_f32_16x16x32_bf16 v[140:143], v[44:47], a[56:59], v[140:143]
buffer_load_dwordx4 a[108:111], v28, s[32:35], s55 offen offset:0 sc1
v_mfma_f32_16x16x32_bf16 v[176:179], v[44:47], a[60:63], v[176:179]
v_mfma_f32_16x16x32_bf16 v[176:179], v[40:43], a[44:47], v[176:179]
s_waitcnt lgkmcnt(4)
v_mfma_f32_16x16x32_bf16 v[72:75], v[48:51], a[32:35], v[72:75]
ds_read_b64_tr_b16 v[40:41], v4 offset:128
buffer_load_dwordx4 a[112:115], v28, s[32:35], s52 offen offset:1024 sc1
v_mfma_f32_16x16x32_bf16 v[72:75], v[52:55], a[48:51], v[72:75]
ds_read_b64_tr_b16 v[42:43], v4 offset:4736
v_mfma_f32_16x16x32_bf16 v[108:111], v[52:55], a[52:55], v[108:111]
ds_read_b64_tr_b16 v[44:45], v4 offset:18560
v_mfma_f32_16x16x32_bf16 v[108:111], v[48:51], a[36:39], v[108:111]
ds_read_b64_tr_b16 v[46:47], v4 offset:23168
buffer_load_dwordx4 a[116:119], v28, s[32:35], s53 offen offset:1024 sc1
v_mfma_f32_16x16x32_bf16 v[144:147], v[48:51], a[40:43], v[144:147]
v_mfma_f32_16x16x32_bf16 v[144:147], v[52:55], a[56:59], v[144:147]
v_mfma_f32_16x16x32_bf16 v[180:183], v[52:55], a[60:63], v[180:183]
v_mfma_f32_16x16x32_bf16 v[180:183], v[48:51], a[44:47], v[180:183]
buffer_load_dwordx4 a[120:123], v28, s[32:35], s54 offen offset:1024 sc1
s_waitcnt lgkmcnt(4)
v_mfma_f32_16x16x32_bf16 v[76:79], v[32:35], a[32:35], v[76:79]
ds_read_b64_tr_b16 v[48:49], v4 offset:160
v_mfma_f32_16x16x32_bf16 v[76:79], v[36:39], a[48:51], v[76:79]
ds_read_b64_tr_b16 v[50:51], v4 offset:4768
v_mfma_f32_16x16x32_bf16 v[112:115], v[36:39], a[52:55], v[112:115]
ds_read_b64_tr_b16 v[52:53], v4 offset:18592
buffer_load_dwordx4 a[124:127], v28, s[32:35], s55 offen offset:1024 sc1
v_mfma_f32_16x16x32_bf16 v[112:115], v[32:35], a[36:39], v[112:115]
ds_read_b64_tr_b16 v[54:55], v4 offset:23200
v_mfma_f32_16x16x32_bf16 v[148:151], v[32:35], a[40:43], v[148:151]
v_mfma_f32_16x16x32_bf16 v[148:151], v[36:39], a[56:59], v[148:151]
s_add_u32 s66, s64, 147456
s_add_u32 s66, s66, s63
s_add_u32 m0, s65, 0
v_mfma_f32_16x16x32_bf16 v[184:187], v[36:39], a[60:63], v[184:187]
v_mfma_f32_16x16x32_bf16 v[184:187], v[32:35], a[44:47], v[184:187]
s_waitcnt lgkmcnt(4)
v_mfma_f32_16x16x32_bf16 v[80:83], v[40:43], a[32:35], v[80:83]
STUB_g9:
s_cbranch_execz NEXT_g9
ds_read_b64_tr_b16 v[32:33], v4 offset:192
buffer_load_dwordx4 v8, s[16:19], s66 offen offset:0 lds
v_mfma_f32_16x16x32_bf16 v[80:83], v[44:47], a[48:51], v[80:83]
ds_read_b64_tr_b16 v[34:35], v4 offset:4800
v_mfma_f32_16x16x32_bf16 v[116:119], v[44:47], a[52:55], v[116:119]
ds_read_b64_tr_b16 v[36:37], v4 offset:18624
v_mfma_f32_16x16x32_bf16 v[116:119], v[40:43], a[36:39], v[116:119]
ds_read_b64_tr_b16 v[38:39], v4 offset:23232
v_mfma_f32_16x16x32_bf16 v[152:155], v[40:43], a[40:43], v[152:155]
buffer_load_dwordx4 v9, s[16:19], s66 offen offset:1024 lds
v_mfma_f32_16x16x32_bf16 v[152:155], v[44:47], a[56:59], v[152:155]
v_mfma_f32_16x16x32_bf16 v[188:191], v[44:47], a[60:63], v[188:191]
v_mfma_f32_16x16x32_bf16 v[188:191], v[40:43], a[44:47], v[188:191]
buffer_load_dwordx4 v10, s[16:19], s66 offen offset:2048 lds
s_waitcnt lgkmcnt(4)
v_mfma_f32_16x16x32_bf16 v[84:87], v[48:51], a[32:35], v[84:87]
ds_read_b64_tr_b16 v[40:41], v4 offset:224
v_mfma_f32_16x16x32_bf16 v[84:87], v[52:55], a[48:51], v[84:87]
ds_read_b64_tr_b16 v[42:43], v4 offset:4832
v_mfma_f32_16x16x32_bf16 v[120:123], v[52:55], a[52:55], v[120:123]
ds_read_b64_tr_b16 v[44:45], v4 offset:18656
buffer_load_dwordx4 v11, s[16:19], s66 offen offset:3072 lds
v_mfma_f32_16x16x32_bf16 v[120:123], v[48:51], a[36:39], v[120:123]
ds_read_b64_tr_b16 v[46:47], v4 offset:23264
v_mfma_f32_16x16x32_bf16 v[156:159], v[48:51], a[40:43], v[156:159]
v_mfma_f32_16x16x32_bf16 v[156:159], v[52:55], a[56:59], v[156:159]
v_mfma_f32_16x16x32_bf16 v[192:195], v[52:55], a[60:63], v[192:195]
s_add_u32 m0, s65, 4096
v_mfma_f32_16x16x32_bf16 v[192:195], v[48:51], a[44:47], v[192:195]
s_waitcnt lgkmcnt(4)
v_mfma_f32_16x16x32_bf16 v[88:91], v[32:35], a[32:35], v[88:91]
ds_read_b64_tr_b16 v[48:49], v4 offset:256
v_mfma_f32_16x16x32_bf16 v[88:91], v[36:39], a[48:51], v[88:91]
ds_read_b64_tr_b16 v[50:51], v4 offset:4864
buffer_load_dwordx4 v12, s[16:19], s66 offen offset:0 lds
v_mfma_f32_16x16x32_bf16 v[124:127], v[36:39], a[52:55], v[124:127]
ds_read_b64_tr_b16 v[52:53], v4 offset:18688
v_mfma_f32_16x16x32_bf16 v[124:127], v[32:35], a[36:39], v[124:127]
ds_read_b64_tr_b16 v[54:55], v4 offset:23296
v_mfma_f32_16x16x32_bf16 v[160:163], v[32:35], a[40:43], v[160:163]
buffer_load_dwordx4 v13, s[16:19], s66 offen offset:1024 lds
v_mfma_f32_16x16x32_bf16 v[160:163], v[36:39], a[56:59], v[160:163]
v_mfma_f32_16x16x32_bf16 v[196:199], v[36:39], a[60:63], v[196:199]
v_mfma_f32_16x16x32_bf16 v[196:199], v[32:35], a[44:47], v[196:199]
buffer_load_dwordx4 v14, s[16:19], s66 offen offset:2048 lds
s_waitcnt lgkmcnt(4)
v_mfma_f32_16x16x32_bf16 v[92:95], v[40:43], a[32:35], v[92:95]
s_waitcnt vmcnt(15)
s_barrier
v_mfma_f32_16x16x32_bf16 v[92:95], v[44:47], a[48:51], v[92:95]
ds_read_b64_tr_b16 v[32:33], v5 offset:0
v_mfma_f32_16x16x32_bf16 v[128:131], v[44:47], a[52:55], v[128:131]
ds_read_b64_tr_b16 v[34:35], v5 offset:4608
v_mfma_f32_16x16x32_bf16 v[128:131], v[40:43], a[36:39], v[128:131]
ds_read_b64_tr_b16 v[36:37], v5 offset:18432
buffer_load_dwordx4 v15, s[16:19], s66 offen offset:3072 lds
v_mfma_f32_16x16x32_bf16 v[164:167], v[40:43], a[40:43], v[164:167]
ds_read_b64_tr_b16 v[38:39], v5 offset:23040
v_mfma_f32_16x16x32_bf16 v[164:167], v[44:47], a[56:59], v[164:167]
s_cmp_ge_u32 s101, 2146435072
s_cbranch_scc1 F4_SKIPk
buffer_store_dwordx2 v[26:27], v25, s[32:35], s101 offen sc1
F4_SKIPk:
v_mfma_f32_16x16x32_bf16 v[200:203], v[44:47], a[60:63], v[200:203]
s_add_u32 m0, s65, 8192
v_mfma_f32_16x16x32_bf16 v[200:203], v[40:43], a[44:47], v[200:203]
s_waitcnt lgkmcnt(4)
v_mfma_f32_16x16x32_bf16 v[96:99], v[48:51], a[32:35], v[96:99]
ds_read_b64_tr_b16 v[40:41], v5 offset:32
v_mfma_f32_16x16x32_bf16 v[96:99], v[52:55], a[48:51], v[96:99]
ds_read_b64_tr_b16 v[42:43], v5 offset:4640
buffer_load_dwordx4 v16, s[16:19], s66 offen offset:0 lds
v_mfma_f32_16x16x32_bf16 v[132:135], v[52:55], a[52:55], v[132:135]
ds_read_b64_tr_b16 v[44:45], v5 offset:18464
v_mfma_f32_16x16x32_bf16 v[132:135], v[48:51], a[36:39], v[132:135]
ds_read_b64_tr_b16 v[46:47], v5 offset:23072
v_mfma_f32_16x16x32_bf16 v[168:171], v[48:51], a[40:43], v[168:171]
v_cmp_ne_u64 vcc, s[94:95], v[22:23]
s_nop 1
s_cmp_lg_u64 vcc, 0
s_cbranch_scc1 SLOW_F3Ck
BACK_F3Ck:
v_mfma_f32_16x16x32_bf16 v[168:171], v[52:55], a[56:59], v[168:171]
v_mfma_f32_16x16x32_bf16 v[204:207], v[52:55], a[60:63], v[204:207]
v_mfma_f32_16x16x32_bf16 v[204:207], v[48:51], a[44:47], v[204:207]
s_waitcnt lgkmcnt(4)
s_waitcnt vmcnt(27)
v_mfma_f32_16x16x32_bf16 v[64:67], v[32:35], a[64:67], v[64:67]
ds_read_b64_tr_b16 v[48:49], v5 offset:64
s_mul_i32 s58, s14, 192
v_mfma_f32_16x16x32_bf16 v[64:67], v[36:39], a[80:83], v[64:67]
ds_read_b64_tr_b16 v[50:51], v5 offset:4672
buffer_load_dwordx4 a[128:131], v30, s[32:35], s52 offen offset:2048 sc1
v_mfma_f32_16x16x32_bf16 v[100:103], v[36:39], a[84:87], v[100:103]
ds_read_b64_tr_b16 v[52:53], v5 offset:18496
v_mfma_f32_16x16x32_bf16 v[100:103], v[32:35], a[68:71], v[100:103]
ds_read_b64_tr_b16 v[54:55], v5 offset:23104
v_add_u32 v252, s58, v1
v_mfma_f32_16x16x32_bf16 v[136:139], v[32:35], a[72:75], v[136:139]
buffer_load_dwordx4 a[132:135], v30, s[32:35], s53 offen offset:2048 sc1
v_mfma_f32_16x16x32_bf16 v[136:139], v[36:39], a[88:91], v[136:139]
v_mfma_f32_16x16x32_bf16 v[172:175], v[36:39], a[92:95], v[172:175]
v_mul_u32_u24 v253, 3641, v252
buffer_load_dwordx4 a[136:139], v30, s[32:35], s54 offen offset:2048 sc1
v_mfma_f32_16x16x32_bf16 v[172:175], v[32:35], a[76:79], v[172:175]
s_waitcnt lgkmcnt(4)
v_mfma_f32_16x16x32_bf16 v[68:71], v[40:43], a[64:67], v[68:71]
ds_read_b64_tr_b16 v[32:33], v5 offset:96
v_mfma_f32_16x16x32_bf16 v[68:71], v[44:47], a[80:83], v[68:71]
ds_read_b64_tr_b16 v[34:35], v5 offset:4704
v_mfma_f32_16x16x32_bf16 v[104:107], v[44:47], a[84:87], v[104:107]
ds_read_b64_tr_b16 v[36:37], v5 offset:18528
v_lshrrev_b32 v253, 16, v253
v_mfma_f32_16x16x32_bf16 v[104:107], v[40:43], a[68:71], v[104:107]
ds_read_b64_tr_b16 v[38:39], v5 offset:23136
buffer_load_dwordx4 a[140:143], v30, s[32:35], s55 offen offset:2048 sc1
v_mfma_f32_16x16x32_bf16 v[140:143], v[40:43], a[72:75], v[140:143]
v_mfma_f32_16x16x32_bf16 v[140:143], v[44:47], a[88:91], v[140:143]
v_mul_u32_u24 v216, 864, v253
buffer_load_dwordx4 a[144:147], v30, s[32:35], s52 offen offset:3072 sc1
v_mfma_f32_16x16x32_bf16 v[176:179], v[44:47], a[92:95], v[176:179]
v_mfma_f32_16x16x32_bf16 v[176:179], v[40:43], a[76:79], v[176:179]
s_waitcnt lgkmcnt(4)
v_mfma_f32_16x16x32_bf16 v[72:75], v[48:51], a[64:67], v[72:75]
ds_read_b64_tr_b16 v[40:41], v5 offset:128
v_mfma_f32_16x16x32_bf16 v[72:75], v[52:55], a[80:83], v[72:75]
ds_read_b64_tr_b16 v[42:43], v5 offset:4736
v_lshl_add_u32 v216, v252, 4, v216
v_mfma_f32_16x16x32_bf16 v[108:111], v[52:55], a[84:87], v[108:111]
ds_read_b64_tr_b16 v[44:45], v5 offset:18560
buffer_load_dwordx4 a[148:151], v30, s[32:35], s53 offen offset:3072 sc1
v_mfma_f32_16x16x32_bf16 v[108:111], v[48:51], a[68:71], v[108:111]
ds_read_b64_tr_b16 v[46:47], v5 offset:23168
v_mfma_f32_16x16x32_bf16 v[144:147], v[48:51], a[72:75], v[144:147]
v_add_u32 v216, s61, v216
buffer_load_dwordx4 a[152:155], v30, s[32:35], s54 offen offset:3072 sc1
v_mfma_f32_16x16x32_bf16 v[144:147], v[52:55], a[88:91], v[144:147]
v_mfma_f32_16x16x32_bf16 v[180:183], v[52:55], a[92:95], v[180:183]
v_mfma_f32_16x16x32_bf16 v[180:183], v[48:51], a[76:79], v[180:183]
s_waitcnt lgkmcnt(4)
v_mfma_f32_16x16x32_bf16 v[76:79], v[32:35], a[64:67], v[76:79]
ds_read_b64_tr_b16 v[48:49], v5 offset:160
s_add_u32 s58, s58, 64
v_mfma_f32_16x16x32_bf16 v[76:79], v[36:39], a[80:83], v[76:79]
ds_read_b64_tr_b16 v[50:51], v5 offset:4768
buffer_load_dwordx4 a[156:159], v30, s[32:35], s55 offen offset:3072 sc1
v_mfma_f32_16x16x32_bf16 v[112:115], v[36:39], a[84:87], v[112:115]
ds_read_b64_tr_b16 v[52:53], v5 offset:18592
v_mfma_f32_16x16x32_bf16 v[112:115], v[32:35], a[68:71], v[112:115]
ds_read_b64_tr_b16 v[54:55], v5 offset:23200
v_add_u32 v252, s58, v1
v_mfma_f32_16x16x32_bf16 v[148:151], v[32:35], a[72:75], v[148:151]
s_add_u32 s66, s64, 516096
s_add_u32 s66, s66, s63
s_add_u32 m0, s65, 36864
v_mfma_f32_16x16x32_bf16 v[148:151], v[36:39], a[88:91], v[148:151]
v_mfma_f32_16x16x32_bf16 v[184:187], v[36:39], a[92:95], v[184:187]
v_mul_u32_u24 v253, 3641, v252
v_mfma_f32_16x16x32_bf16 v[184:187], v[32:35], a[76:79], v[184:187]
buffer_load_dwordx4 v8, s[16:19], s66 offen offset:0 lds
s_waitcnt lgkmcnt(4)
v_mfma_f32_16x16x32_bf16 v[80:83], v[40:43], a[64:67], v[80:83]
ds_read_b64_tr_b16 v[32:33], v5 offset:192
v_mfma_f32_16x16x32_bf16 v[80:83], v[44:47], a[80:83], v[80:83]
ds_read_b64_tr_b16 v[34:35], v5 offset:4800
v_mfma_f32_16x16x32_bf16 v[116:119], v[44:47], a[84:87], v[116:119]
ds_read_b64_tr_b16 v[36:37], v5 offset:18624
v_lshrrev_b32 v253, 16, v253
v_mfma_f32_16x16x32_bf16 v[116:119], v[40:43], a[68:71], v[116:119]
ds_read_b64_tr_b16 v[38:39], v5 offset:23232
buffer_load_dwordx4 v9, s[16:19], s66 offen offset:1024 lds
v_mfma_f32_16x16x32_bf16 v[152:155], v[40:43], a[72:75], v[152:155]
v_mfma_f32_16x16x32_bf16 v[152:155], v[44:47], a[88:91], v[152:155]
v_mul_u32_u24 v217, 864, v253
buffer_load_dwordx4 v10, s[16:19], s66 offen offset:2048 lds
v_mfma_f32_16x16x32_bf16 v[188:191], v[44:47], a[92:95], v[188:191]
v_mfma_f32_16x16x32_bf16 v[188:191], v[40:43], a[76:79], v[188:191]
s_waitcnt lgkmcnt(4)
v_mfma_f32_16x16x32_bf16 v[84:87], v[48:51], a[64:67], v[84:87]
ds_read_b64_tr_b16 v[40:41], v5 offset:224
v_mfma_f32_16x16x32_bf16 v[84:87], v[52:55], a[80:83], v[84:87]
ds_read_b64_tr_b16 v[42:43], v5 offset:4832
v_lshl_add_u32 v217, v252, 4, v217
v_mfma_f32_16x16x32_bf16 v[120:123], v[52:55], a[84:87], v[120:123]
ds_read_b64_tr_b16 v[44:45], v5 offset:18656
buffer_load_dwordx4 v11, s[16:19], s66 offen offset:3072 lds
v_mfma_f32_16x16x32_bf16 v[120:123], v[48:51], a[68:71], v[120:123]
ds_read_b64_tr_b16 v[46:47], v5 offset:23264
v_mfma_f32_16x16x32_bf16 v[156:159], v[48:51], a[72:75], v[156:159]
v_add_u32 v217, s61, v217
s_add_u32 m0, s65, 40960
v_mfma_f32_16x16x32_bf16 v[156:159], v[52:55], a[88:91], v[156:159]
v_mfma_f32_16x16x32_bf16 v[192:195], v[52:55], a[92:95], v[192:195]
v_mfma_f32_16x16x32_bf16 v[192:195], v[48:51], a[76:79], v[192:195]
s_waitcnt lgkmcnt(4)
v_mfma_f32_16x16x32_bf16 v[88:91], v[32:35], a[64:67], v[88:91]
ds_read_b64_tr_b16 v[48:49], v5 offset:256
v_subrev_u32 v217, 1024, v217
v_mfma_f32_16x16x32_bf16 v[88:91], v[36:39], a[80:83], v[88:91]
ds_read_b64_tr_b16 v[50:51], v5 offset:4864
buffer_load_dwordx4 v12, s[16:19], s66 offen offset:0 lds
v_mfma_f32_16x16x32_bf16 v[124:127], v[36:39], a[84:87], v[124:127]
ds_read_b64_tr_b16 v[52:53], v5 offset:18688
v_mfma_f32_16x16x32_bf16 v[124:127], v[32:35], a[68:71], v[124:127]
ds_read_b64_tr_b16 v[54:55], v5 offset:23296
s_add_u32 s58, s58, 64
v_mfma_f32_16x16x32_bf16 v[160:163], v[32:35], a[72:75], v[160:163]
buffer_load_dwordx4 v13, s[16:19], s66 offen offset:1024 lds
v_mfma_f32_16x16x32_bf16 v[160:163], v[36:39], a[88:91], v[160:163]
v_mfma_f32_16x16x32_bf16 v[196:199], v[36:39], a[92:95], v[196:199]
v_mfma_f32_16x16x32_bf16 v[196:199], v[32:35], a[76:79], v[196:199]
buffer_load_dwordx4 v14, s[16:19], s66 offen offset:2048 lds
s_waitcnt lgkmcnt(4)
v_mfma_f32_16x16x32_bf16 v[92:95], v[40:43], a[64:67], v[92:95]
s_waitcnt vmcnt(15)
s_barrier
v_mfma_f32_16x16x32_bf16 v[92:95], v[44:47], a[80:83], v[92:95]
ds_read_b64_tr_b16 v[32:33], v2 offset:0
v_mfma_f32_16x16x32_bf16 v[128:131], v[44:47], a[84:87], v[128:131]
ds_read_b64_tr_b16 v[34:35], v2 offset:4608
buffer_load_dwordx4 v15, s[16:19], s66 offen offset:3072 lds
v_mfma_f32_16x16x32_bf16 v[128:131], v[40:43], a[68:71], v[128:131]
ds_read_b64_tr_b16 v[36:37], v2 offset:18432
v_mfma_f32_16x16x32_bf16 v[164:167], v[40:43], a[72:75], v[164:167]
ds_read_b64_tr_b16 v[38:39], v2 offset:23040
v_mfma_f32_16x16x32_bf16 v[164:167], v[44:47], a[88:91], v[164:167]
v_mfma_f32_16x16x32_bf16 v[200:203], v[44:47], a[92:95], v[200:203]
s_add_u32 m0, s65, 45056
v_mfma_f32_16x16x32_bf16 v[200:203], v[40:43], a[76:79], v[200:203]
s_waitcnt lgkmcnt(4)
v_mfma_f32_16x16x32_bf16 v[96:99], v[48:51], a[64:67], v[96:99]
ds_read_b64_tr_b16 v[40:41], v2 offset:32
v_mfma_f32_16x16x32_bf16 v[96:99], v[52:55], a[80:83], v[96:99]
ds_read_b64_tr_b16 v[42:43], v2 offset:4640
buffer_load_dwordx4 v16, s[16:19], s66 offen offset:0 lds
v_mfma_f32_16x16x32_bf16 v[132:135], v[52:55], a[84:87], v[132:135]
ds_read_b64_tr_b16 v[44:45], v2 offset:18464
v_mfma_f32_16x16x32_bf16 v[132:135], v[48:51], a[68:71], v[132:135]
ds_read_b64_tr_b16 v[46:47], v2 offset:23072
v_mfma_f32_16x16x32_bf16 v[168:171], v[48:51], a[72:75], v[168:171]
v_mfma_f32_16x16x32_bf16 v[168:171], v[52:55], a[88:91], v[168:171]
v_mfma_f32_16x16x32_bf16 v[204:207], v[52:55], a[92:95], v[204:207]
v_mfma_f32_16x16x32_bf16 v[204:207], v[48:51], a[76:79], v[204:207]
s_waitcnt lgkmcnt(4)
s_waitcnt vmcnt(26)
v_mfma_f32_16x16x32_bf16 v[64:67], v[32:35], a[96:99], v[64:67]
ds_read_b64_tr_b16 v[48:49], v2 offset:64
v_add_u32 v252, s58, v1
v_mfma_f32_16x16x32_bf16 v[64:67], v[36:39], a[112:115], v[64:67]
ds_read_b64_tr_b16 v[50:51], v2 offset:4672
buffer_load_dwordx4 a[160:163], v28, s[32:35], s52 offen offset:2048 sc1
v_mfma_f32_16x16x32_bf16 v[100:103], v[36:39], a[116:119], v[100:103]
ds_read_b64_tr_b16 v[52:53], v2 offset:18496
v_mfma_f32_16x16x32_bf16 v[100:103], v[32:35], a[100:103], v[100:103]
ds_read_b64_tr_b16 v[54:55], v2 offset:23104
v_mul_u32_u24 v253, 3641, v252
v_mfma_f32_16x16x32_bf16 v[136:139], v[32:35], a[104:107], v[136:139]
buffer_load_dwordx4 a[164:167], v28, s[32:35], s53 offen offset:2048 sc1
v_mfma_f32_16x16x32_bf16 v[136:139], v[36:39], a[120:123], v[136:139]
v_mfma_f32_16x16x32_bf16 v[172:175], v[36:39], a[124:127], v[172:175]
v_lshrrev_b32 v253, 16, v253
buffer_load_dwordx4 a[168:171], v28, s[32:35], s54 offen offset:2048 sc1
v_mfma_f32_16x16x32_bf16 v[172:175], v[32:35], a[108:111], v[172:175]
s_waitcnt lgkmcnt(4)
v_mfma_f32_16x16x32_bf16 v[68:71], v[40:43], a[96:99], v[68:71]
ds_read_b64_tr_b16 v[32:33], v2 offset:96
v_mfma_f32_16x16x32_bf16 v[68:71], v[44:47], a[112:115], v[68:71]
ds_read_b64_tr_b16 v[34:35], v2 offset:4704
v_mul_u32_u24 v218, 864, v253
v_mfma_f32_16x16x32_bf16 v[104:107], v[44:47], a[116:119], v[104:107]
ds_read_b64_tr_b16 v[36:37], v2 offset:18528
buffer_load_dwordx4 a[172:175], v28, s[32:35], s55 offen offset:2048 sc1
v_mfma_f32_16x16x32_bf16 v[104:107], v[40:43], a[100:103], v[104:107]
ds_read_b64_tr_b16 v[38:39], v2 offset:23136
v_mfma_f32_16x16x32_bf16 v[140:143], v[40:43], a[104:107], v[140:143]
v_lshl_add_u32 v218, v252, 4, v218
v_mfma_f32_16x16x32_bf16 v[140:143], v[44:47], a[120:123], v[140:143]
buffer_load_dwordx4 a[176:179], v28, s[32:35], s52 offen offset:3072 sc1
v_mfma_f32_16x16x32_bf16 v[176:179], v[44:47], a[124:127], v[176:179]
v_mfma_f32_16x16x32_bf16 v[176:179], v[40:43], a[108:111], v[176:179]
v_add_u32 v218, s61, v218
s_waitcnt lgkmcnt(4)
v_mfma_f32_16x16x32_bf16 v[72:75], v[48:51], a[96:99], v[72:75]
ds_read_b64_tr_b16 v[40:41], v2 offset:128
v_mfma_f32_16x16x32_bf16 v[72:75], v[52:55], a[112:115], v[72:75]
ds_read_b64_tr_b16 v[42:43], v2 offset:4736
buffer_load_dwordx4 a[180:183], v28, s[32:35], s53 offen offset:3072 sc1
v_mfma_f32_16x16x32_bf16 v[108:111], v[52:55], a[116:119], v[108:111]
ds_read_b64_tr_b16 v[44:45], v2 offset:18560
v_subrev_u32 v218, 2048, v218
v_mfma_f32_16x16x32_bf16 v[108:111], v[48:51], a[100:103], v[108:111]
ds_read_b64_tr_b16 v[46:47], v2 offset:23168
v_mfma_f32_16x16x32_bf16 v[144:147], v[48:51], a[104:107], v[144:147]
buffer_load_dwordx4 a[184:187], v28, s[32:35], s54 offen offset:3072 sc1
v_mfma_f32_16x16x32_bf16 v[144:147], v[52:55], a[120:123], v[144:147]
s_add_u32 s58, s58, 64
v_mfma_f32_16x16x32_bf16 v[180:183], v[52:55], a[124:127], v[180:183]
v_mfma_f32_16x16x32_bf16 v[180:183], v[48:51], a[108:111], v[180:183]
s_waitcnt lgkmcnt(4)
v_mfma_f32_16x16x32_bf16 v[76:79], v[32:35], a[96:99], v[76:79]
ds_read_b64_tr_b16 v[48:49], v2 offset:160
v_lshrrev_b32 v252, 2, v1
v_mfma_f32_16x16x32_bf16 v[76:79], v[36:39], a[112:115], v[76:79]
ds_read_b64_tr_b16 v[50:51], v2 offset:4768
buffer_load_dwordx4 a[188:191], v28, s[32:35], s55 offen offset:3072 sc1
v_mfma_f32_16x16x32_bf16 v[112:115], v[36:39], a[116:119], v[112:115]
ds_read_b64_tr_b16 v[52:53], v2 offset:18592
v_mfma_f32_16x16x32_bf16 v[112:115], v[32:35], a[100:103], v[112:115]
ds_read_b64_tr_b16 v[54:55], v2 offset:23200
v_and_b32 v253, 3, v1
v_mfma_f32_16x16x32_bf16 v[148:151], v[32:35], a[104:107], v[148:151]
s_add_u32 s66, s64, 221184
s_add_u32 s66, s66, s63
s_add_u32 m0, s65, 73728
v_mfma_f32_16x16x32_bf16 v[148:151], v[36:39], a[120:123], v[148:151]
v_mfma_f32_16x16x32_bf16 v[184:187], v[36:39], a[124:127], v[184:187]
s_mul_i32 s58, s14, 48
v_mfma_f32_16x16x32_bf16 v[184:187], v[32:35], a[108:111], v[184:187]
buffer_load_dwordx4 v8, s[16:19], s66 offen offset:0 lds
s_waitcnt lgkmcnt(4)
v_mfma_f32_16x16x32_bf16 v[80:83], v[40:43], a[96:99], v[80:83]
ds_read_b64_tr_b16 v[32:33], v2 offset:192
v_mfma_f32_16x16x32_bf16 v[80:83], v[44:47], a[112:115], v[80:83]
ds_read_b64_tr_b16 v[34:35], v2 offset:4800
s_add_u32 s58, s58, s45
v_mfma_f32_16x16x32_bf16 v[116:119], v[44:47], a[116:119], v[116:119]
ds_read_b64_tr_b16 v[36:37], v2 offset:18624
buffer_load_dwordx4 v9, s[16:19], s66 offen offset:1024 lds
v_mfma_f32_16x16x32_bf16 v[116:119], v[40:43], a[100:103], v[116:119]
ds_read_b64_tr_b16 v[38:39], v2 offset:23232
v_mfma_f32_16x16x32_bf16 v[152:155], v[40:43], a[104:107], v[152:155]
v_add_u32 v219, s58, v252
v_mfma_f32_16x16x32_bf16 v[152:155], v[44:47], a[120:123], v[152:155]
buffer_load_dwordx4 v10, s[16:19], s66 offen offset:2048 lds
v_mfma_f32_16x16x32_bf16 v[188:191], v[44:47], a[124:127], v[188:191]
v_mfma_f32_16x16x32_bf16 v[188:191], v[40:43], a[108:111], v[188:191]
v_lshlrev_b32 v219, 12, v219
s_waitcnt lgkmcnt(4)
v_mfma_f32_16x16x32_bf16 v[84:87], v[48:51], a[96:99], v[84:87]
ds_read_b64_tr_b16 v[40:41], v2 offset:224
v_mfma_f32_16x16x32_bf16 v[84:87], v[52:55], a[112:115], v[84:87]
ds_read_b64_tr_b16 v[42:43], v2 offset:4832
buffer_load_dwordx4 v11, s[16:19], s66 offen offset:3072 lds
v_mfma_f32_16x16x32_bf16 v[120:123], v[52:55], a[116:119], v[120:123]
ds_read_b64_tr_b16 v[44:45], v2 offset:18656
v_lshl_add_u32 v219, v253, 4, v219
v_mfma_f32_16x16x32_bf16 v[120:123], v[48:51], a[100:103], v[120:123]
ds_read_b64_tr_b16 v[46:47], v2 offset:23264
v_mfma_f32_16x16x32_bf16 v[156:159], v[48:51], a[104:107], v[156:159]
s_add_u32 m0, s65, 77824
v_mfma_f32_16x16x32_bf16 v[156:159], v[52:55], a[120:123], v[156:159]
s_lshl_b32 s58, s43, 6
v_mfma_f32_16x16x32_bf16 v[192:195], v[52:55], a[124:127], v[192:195]
v_mfma_f32_16x16x32_bf16 v[192:195], v[48:51], a[108:111], v[192:195]
s_waitcnt lgkmcnt(4)
v_mfma_f32_16x16x32_bf16 v[88:91], v[32:35], a[96:99], v[88:91]
ds_read_b64_tr_b16 v[48:49], v2 offset:256
s_add_u32 s58, s58, s61
v_mfma_f32_16x16x32_bf16 v[88:91], v[36:39], a[112:115], v[88:91]
ds_read_b64_tr_b16 v[50:51], v2 offset:4864
buffer_load_dwordx4 v12, s[16:19], s66 offen offset:0 lds
v_mfma_f32_16x16x32_bf16 v[124:127], v[36:39], a[116:119], v[124:127]
ds_read_b64_tr_b16 v[52:53], v2 offset:18688
v_mfma_f32_16x16x32_bf16 v[124:127], v[32:35], a[100:103], v[124:127]
ds_read_b64_tr_b16 v[54:55], v2 offset:23296
v_add_u32 v219, s58, v219
v_mfma_f32_16x16x32_bf16 v[160:163], v[32:35], a[104:107], v[160:163]
buffer_load_dwordx4 v13, s[16:19], s66 offen offset:1024 lds
v_mfma_f32_16x16x32_bf16 v[160:163], v[36:39], a[120:123], v[160:163]
v_mfma_f32_16x16x32_bf16 v[196:199], v[36:39], a[124:127], v[196:199]
v_mfma_f32_16x16x32_bf16 v[196:199], v[32:35], a[108:111], v[196:199]
buffer_load_dwordx4 v14, s[16:19], s66 offen offset:2048 lds
s_waitcnt lgkmcnt(4)
v_mfma_f32_16x16x32_bf16 v[92:95], v[40:43], a[96:99], v[92:95]
s_waitcnt vmcnt(15)
s_barrier
v_mfma_f32_16x16x32_bf16 v[92:95], v[44:47], a[112:115], v[92:95]
ds_read_b64_tr_b16 v[32:33], v3 offset:0
v_mfma_f32_16x16x32_bf16 v[128:131], v[44:47], a[116:119], v[128:131]
ds_read_b64_tr_b16 v[34:35], v3 offset:4608
buffer_load_dwordx4 v15, s[16:19], s66 offen offset:3072 lds
v_mfma_f32_16x16x32_bf16 v[128:131], v[40:43], a[100:103], v[128:131]
ds_read_b64_tr_b16 v[36:37], v3 offset:18432
v_mfma_f32_16x16x32_bf16 v[164:167], v[40:43], a[104:107], v[164:167]
ds_read_b64_tr_b16 v[38:39], v3 offset:23040
v_mfma_f32_16x16x32_bf16 v[164:167], v[44:47], a[120:123], v[164:167]
v_mfma_f32_16x16x32_bf16 v[200:203], v[44:47], a[124:127], v[200:203]
s_add_u32 m0, s65, 81920
v_mfma_f32_16x16x32_bf16 v[200:203], v[40:43], a[108:111], v[200:203]
s_waitcnt lgkmcnt(4)
v_mfma_f32_16x16x32_bf16 v[96:99], v[48:51], a[96:99], v[96:99]
ds_read_b64_tr_b16 v[40:41], v3 offset:32
v_mfma_f32_16x16x32_bf16 v[96:99], v[52:55], a[112:115], v[96:99]
ds_read_b64_tr_b16 v[42:43], v3 offset:4640
buffer_load_dwordx4 v16, s[16:19], s66 offen offset:0 lds
v_mfma_f32_16x16x32_bf16 v[132:135], v[52:55], a[116:119], v[132:135]
ds_read_b64_tr_b16 v[44:45], v3 offset:18464
v_mfma_f32_16x16x32_bf16 v[132:135], v[48:51], a[100:103], v[132:135]
ds_read_b64_tr_b16 v[46:47], v3 offset:23072
v_mfma_f32_16x16x32_bf16 v[168:171], v[48:51], a[104:107], v[168:171]
v_mfma_f32_16x16x32_bf16 v[168:171], v[52:55], a[120:123], v[168:171]
v_mfma_f32_16x16x32_bf16 v[204:207], v[52:55], a[124:127], v[204:207]
v_mfma_f32_16x16x32_bf16 v[204:207], v[48:51], a[108:111], v[204:207]
s_waitcnt lgkmcnt(4)
s_waitcnt vmcnt(26)
v_mfma_f32_16x16x32_bf16 v[64:67], v[32:35], a[128:131], v[64:67]
ds_read_b64_tr_b16 v[48:49], v3 offset:64
s_mul_i32 s58, s14, 9216
v_mfma_f32_16x16x32_bf16 v[64:67], v[36:39], a[144:147], v[64:67]
ds_read_b64_tr_b16 v[50:51], v3 offset:4672
buffer_load_dwordx2 v[22:23], v6, s[32:35], s100 offen sc1
v_mfma_f32_16x16x32_bf16 v[100:103], v[36:39], a[148:151], v[100:103]
ds_read_b64_tr_b16 v[52:53], v3 offset:18496
s_add_u32 s58, s58, 73728
v_mfma_f32_16x16x32_bf16 v[100:103], v[32:35], a[132:135], v[100:103]
ds_read_b64_tr_b16 v[54:55], v3 offset:23104
buffer_load_dwordx4 a[192:195], v31, s[32:35], s52 offen offset:0 sc1
v_mfma_f32_16x16x32_bf16 v[136:139], v[32:35], a[136:139], v[136:139]
v_mfma_f32_16x16x32_bf16 v[136:139], v[36:39], a[152:155], v[136:139]
v_add_u32 v234, s58, v7
v_mfma_f32_16x16x32_bf16 v[172:175], v[36:39], a[156:159], v[172:175]
buffer_load_dwordx4 a[196:199], v31, s[32:35], s53 offen offset:0 sc1
v_mfma_f32_16x16x32_bf16 v[172:175], v[32:35], a[140:143], v[172:175]
s_waitcnt lgkmcnt(4)
v_mfma_f32_16x16x32_bf16 v[68:71], v[40:43], a[128:131], v[68:71]
ds_read_b64_tr_b16 v[32:33], v3 offset:96
s_xor_b32 s58, s14, 1
v_mfma_f32_16x16x32_bf16 v[68:71], v[44:47], a[144:147], v[68:71]
ds_read_b64_tr_b16 v[34:35], v3 offset:4704
buffer_load_dwordx4 a[200:203], v31, s[32:35], s54 offen offset:0 sc1
v_mfma_f32_16x16x32_bf16 v[104:107], v[44:47], a[148:151], v[104:107]
ds_read_b64_tr_b16 v[36:37], v3 offset:18528
v_mfma_f32_16x16x32_bf16 v[104:107], v[40:43], a[132:135], v[104:107]
ds_read_b64_tr_b16 v[38:39], v3 offset:23136
s_mul_i32 s58, s58, 9216
v_mfma_f32_16x16x32_bf16 v[140:143], v[40:43], a[136:139], v[140:143]
v_mfma_f32_16x16x32_bf16 v[140:143], v[44:47], a[152:155], v[140:143]
buffer_load_dwordx4 a[204:207], v31, s[32:35], s55 offen offset:0 sc1
v_mfma_f32_16x16x32_bf16 v[176:179], v[44:47], a[156:159], v[176:179]
s_add_u32 s58, s58, 73728
v_mfma_f32_16x16x32_bf16 v[176:179], v[40:43], a[140:143], v[176:179]
s_waitcnt lgkmcnt(4)
v_mfma_f32_16x16x32_bf16 v[72:75], v[48:51], a[128:131], v[72:75]
ds_read_b64_tr_b16 v[40:41], v3 offset:128
buffer_load_dwordx4 a[208:211], v31, s[32:35], s52 offen offset:1024 sc1
v_mfma_f32_16x16x32_bf16 v[72:75], v[52:55], a[144:147], v[72:75]
ds_read_b64_tr_b16 v[42:43], v3 offset:4736
v_add_u32 v235, s58, v7
v_mfma_f32_16x16x32_bf16 v[108:111], v[52:55], a[148:151], v[108:111]
ds_read_b64_tr_b16 v[44:45], v3 offset:18560
v_mfma_f32_16x16x32_bf16 v[108:111], v[48:51], a[132:135], v[108:111]
ds_read_b64_tr_b16 v[46:47], v3 offset:23168
buffer_load_dwordx4 a[212:215], v31, s[32:35], s53 offen offset:1024 sc1
v_mfma_f32_16x16x32_bf16 v[144:147], v[48:51], a[136:139], v[144:147]
s_lshl_b32 s60, s40, 2
v_mfma_f32_16x16x32_bf16 v[144:147], v[52:55], a[152:155], v[144:147]
v_mfma_f32_16x16x32_bf16 v[180:183], v[52:55], a[156:159], v[180:183]
v_mfma_f32_16x16x32_bf16 v[180:183], v[48:51], a[140:143], v[180:183]
s_add_u32 s60, s60, s14
buffer_load_dwordx4 a[216:219], v31, s[32:35], s54 offen offset:1024 sc1
s_waitcnt lgkmcnt(4)
v_mfma_f32_16x16x32_bf16 v[76:79], v[32:35], a[128:131], v[76:79]
ds_read_b64_tr_b16 v[48:49], v3 offset:160
v_mfma_f32_16x16x32_bf16 v[76:79], v[36:39], a[144:147], v[76:79]
ds_read_b64_tr_b16 v[50:51], v3 offset:4768
v_mfma_f32_16x16x32_bf16 v[112:115], v[36:39], a[148:151], v[112:115]
ds_read_b64_tr_b16 v[52:53], v3 offset:18592
s_lshl_b32 s60, s60, 2
v_mfma_f32_16x16x32_bf16 v[112:115], v[32:35], a[132:135], v[112:115]
ds_read_b64_tr_b16 v[54:55], v3 offset:23200
buffer_load_dwordx4 a[220:223], v31, s[32:35], s55 offen offset:1024 sc1
v_mfma_f32_16x16x32_bf16 v[148:151], v[32:35], a[136:139], v[148:151]
s_add_u32 s60, s60, s42
v_mfma_f32_16x16x32_bf16 v[148:151], v[36:39], a[152:155], v[148:151]
s_add_u32 s66, s64, 589824
s_add_u32 s66, s66, s63
s_add_u32 m0, s65, 110592
v_mfma_f32_16x16x32_bf16 v[184:187], v[36:39], a[156:159], v[184:187]
v_mfma_f32_16x16x32_bf16 v[184:187], v[32:35], a[140:143], v[184:187]
s_lshl_b32 s3, s60, 7
s_waitcnt lgkmcnt(4)
v_mfma_f32_16x16x32_bf16 v[80:83], v[40:43], a[128:131], v[80:83]
ds_read_b64_tr_b16 v[32:33], v3 offset:192
buffer_load_dwordx4 v8, s[16:19], s66 offen offset:0 lds
v_mfma_f32_16x16x32_bf16 v[80:83], v[44:47], a[144:147], v[80:83]
ds_read_b64_tr_b16 v[34:35], v3 offset:4800
v_mfma_f32_16x16x32_bf16 v[116:119], v[44:47], a[148:151], v[116:119]
ds_read_b64_tr_b16 v[36:37], v3 offset:18624
s_lshl_b32 s58, s41, 3
v_mfma_f32_16x16x32_bf16 v[116:119], v[40:43], a[132:135], v[116:119]
ds_read_b64_tr_b16 v[38:39], v3 offset:23232
v_mfma_f32_16x16x32_bf16 v[152:155], v[40:43], a[136:139], v[152:155]
buffer_load_dwordx4 v9, s[16:19], s66 offen offset:1024 lds
v_mfma_f32_16x16x32_bf16 v[152:155], v[44:47], a[152:155], v[152:155]
s_add_u32 s3, s3, s58
v_mfma_f32_16x16x32_bf16 v[188:191], v[44:47], a[156:159], v[188:191]
v_mfma_f32_16x16x32_bf16 v[188:191], v[40:43], a[140:143], v[188:191]
buffer_load_dwordx4 v10, s[16:19], s66 offen offset:2048 lds
s_waitcnt lgkmcnt(4)
v_mfma_f32_16x16x32_bf16 v[84:87], v[48:51], a[128:131], v[84:87]
ds_read_b64_tr_b16 v[40:41], v3 offset:224
s_add_u32 s3, s3, 63111168
v_mfma_f32_16x16x32_bf16 v[84:87], v[52:55], a[144:147], v[84:87]
ds_read_b64_tr_b16 v[42:43], v3 offset:4832
v_mfma_f32_16x16x32_bf16 v[120:123], v[52:55], a[148:151], v[120:123]
ds_read_b64_tr_b16 v[44:45], v3 offset:18656
buffer_load_dwordx4 v11, s[16:19], s66 offen offset:3072 lds
v_mfma_f32_16x16x32_bf16 v[120:123], v[48:51], a[132:135], v[120:123]
ds_read_b64_tr_b16 v[46:47], v3 offset:23264
s_lshl_b32 s60, s60, 2
v_mfma_f32_16x16x32_bf16 v[156:159], v[48:51], a[136:139], v[156:159]
v_mfma_f32_16x16x32_bf16 v[156:159], v[52:55], a[152:155], v[156:159]
v_mfma_f32_16x16x32_bf16 v[192:195], v[52:55], a[156:159], v[192:195]
s_add_u32 s60, s60, s41
s_add_u32 m0, s65, 114688
v_mfma_f32_16x16x32_bf16 v[192:195], v[48:51], a[140:143], v[192:195]
s_waitcnt lgkmcnt(4)
v_mfma_f32_16x16x32_bf16 v[88:91], v[32:35], a[128:131], v[88:91]
ds_read_b64_tr_b16 v[48:49], v3 offset:256
v_mfma_f32_16x16x32_bf16 v[88:91], v[36:39], a[144:147], v[88:91]
ds_read_b64_tr_b16 v[50:51], v3 offset:4864
s_mul_i32 s15, s60, 9216
v_mfma_f32_16x16x32_bf16 v[124:127], v[36:39], a[148:151], v[124:127]
ds_read_b64_tr_b16 v[52:53], v3 offset:18688
buffer_load_dwordx4 v12, s[16:19], s66 offen offset:0 lds
v_mfma_f32_16x16x32_bf16 v[124:127], v[32:35], a[132:135], v[124:127]
ds_read_b64_tr_b16 v[54:55], v3 offset:23296
v_mfma_f32_16x16x32_bf16 v[160:163], v[32:35], a[136:139], v[160:163]
s_add_u32 s15, s15, 50331648
buffer_load_dwordx4 v13, s[16:19], s66 offen offset:1024 lds
v_mfma_f32_16x16x32_bf16 v[160:163], v[36:39], a[152:155], v[160:163]
v_mfma_f32_16x16x32_bf16 v[196:199], v[36:39], a[156:159], v[196:199]
v_mfma_f32_16x16x32_bf16 v[196:199], v[32:35], a[140:143], v[196:199]
buffer_load_dwordx4 v14, s[16:19], s66 offen offset:2048 lds
s_waitcnt lgkmcnt(4)
v_mfma_f32_16x16x32_bf16 v[92:95], v[40:43], a[128:131], v[92:95]
s_waitcnt vmcnt(16)
s_barrier
v_mfma_f32_16x16x32_bf16 v[92:95], v[44:47], a[144:147], v[92:95]
ds_read_b64_tr_b16 v[32:33], v4 offset:0
v_mfma_f32_16x16x32_bf16 v[128:131], v[44:47], a[148:151], v[128:131]
ds_read_b64_tr_b16 v[34:35], v4 offset:4608
v_mfma_f32_16x16x32_bf16 v[128:131], v[40:43], a[132:135], v[128:131]
ds_read_b64_tr_b16 v[36:37], v4 offset:18432
buffer_load_dwordx4 v15, s[16:19], s66 offen offset:3072 lds
v_mfma_f32_16x16x32_bf16 v[164:167], v[40:43], a[136:139], v[164:167]
ds_read_b64_tr_b16 v[38:39], v4 offset:23040
v_mfma_f32_16x16x32_bf16 v[164:167], v[44:47], a[152:155], v[164:167]
v_mfma_f32_16x16x32_bf16 v[200:203], v[44:47], a[156:159], v[200:203]
s_add_u32 m0, s65, 118784
v_mfma_f32_16x16x32_bf16 v[200:203], v[40:43], a[140:143], v[200:203]
s_waitcnt lgkmcnt(4)
v_mfma_f32_16x16x32_bf16 v[96:99], v[48:51], a[128:131], v[96:99]
ds_read_b64_tr_b16 v[40:41], v4 offset:32
v_mfma_f32_16x16x32_bf16 v[96:99], v[52:55], a[144:147], v[96:99]
STUB_g10:
s_cbranch_execz NEXT_g10
ds_read_b64_tr_b16 v[42:43], v4 offset:4640
buffer_load_dwordx4 v16, s[16:19], s66 offen offset:0 lds
v_mfma_f32_16x16x32_bf16 v[132:135], v[52:55], a[148:151], v[132:135]
ds_read_b64_tr_b16 v[44:45], v4 offset:18464
v_mfma_f32_16x16x32_bf16 v[132:135], v[48:51], a[132:135], v[132:135]
ds_read_b64_tr_b16 v[46:47], v4 offset:23072
v_mfma_f32_16x16x32_bf16 v[168:171], v[48:51], a[136:139], v[168:171]
v_mfma_f32_16x16x32_bf16 v[168:171], v[52:55], a[152:155], v[168:171]
v_mfma_f32_16x16x32_bf16 v[204:207], v[52:55], a[156:159], v[204:207]
v_mfma_f32_16x16x32_bf16 v[204:207], v[48:51], a[140:143], v[204:207]
s_waitcnt lgkmcnt(4)
s_waitcnt vmcnt(27)
v_mfma_f32_16x16x32_bf16 v[64:67], v[32:35], a[160:163], v[64:67]
ds_read_b64_tr_b16 v[48:49], v4 offset:64
buffer_load_dwordx2 a[224:225], v20, s[32:35], s52 offen offset:0 sc1
v_mfma_f32_16x16x32_bf16 v[64:67], v[36:39], a[176:179], v[64:67]
ds_read_b64_tr_b16 v[50:51], v4 offset:4672
v_mfma_f32_16x16x32_bf16 v[100:103], v[36:39], a[180:183], v[100:103]
ds_read_b64_tr_b16 v[52:53], v4 offset:18496
v_mfma_f32_16x16x32_bf16 v[100:103], v[32:35], a[164:167], v[100:103]
ds_read_b64_tr_b16 v[54:55], v4 offset:23104
buffer_load_dwordx2 a[226:227], v20, s[32:35], s52 offen offset:512 sc1
v_mfma_f32_16x16x32_bf16 v[136:139], v[32:35], a[168:171], v[136:139]
v_mfma_f32_16x16x32_bf16 v[136:139], v[36:39], a[184:187], v[136:139]
v_mfma_f32_16x16x32_bf16 v[172:175], v[36:39], a[188:191], v[172:175]
buffer_load_dwordx2 a[228:229], v20, s[32:35], s53 offen offset:0 sc1
v_mfma_f32_16x16x32_bf16 v[172:175], v[32:35], a[172:175], v[172:175]
s_waitcnt lgkmcnt(4)
v_mfma_f32_16x16x32_bf16 v[68:71], v[40:43], a[160:163], v[68:71]
ds_read_b64_tr_b16 v[32:33], v4 offset:96
v_mfma_f32_16x16x32_bf16 v[68:71], v[44:47], a[176:179], v[68:71]
ds_read_b64_tr_b16 v[34:35], v4 offset:4704
v_mfma_f32_16x16x32_bf16 v[104:107], v[44:47], a[180:183], v[104:107]
ds_read_b64_tr_b16 v[36:37], v4 offset:18528
buffer_load_dwordx2 a[230:231], v20, s[32:35], s53 offen offset:512 sc1
v_mfma_f32_16x16x32_bf16 v[104:107], v[40:43], a[164:167], v[104:107]
ds_read_b64_tr_b16 v[38:39], v4 offset:23136
v_mfma_f32_16x16x32_bf16 v[140:143], v[40:43], a[168:171], v[140:143]
v_mfma_f32_16x16x32_bf16 v[140:143], v[44:47], a[184:187], v[140:143]
buffer_load_dwordx2 a[232:233], v20, s[32:35], s54 offen offset:0 sc1
v_mfma_f32_16x16x32_bf16 v[176:179], v[44:47], a[188:191], v[176:179]
v_mfma_f32_16x16x32_bf16 v[176:179], v[40:43], a[172:175], v[176:179]
s_waitcnt lgkmcnt(4)
v_mfma_f32_16x16x32_bf16 v[72:75], v[48:51], a[160:163], v[72:75]
ds_read_b64_tr_b16 v[40:41], v4 offset:128
v_mfma_f32_16x16x32_bf16 v[72:75], v[52:55], a[176:179], v[72:75]
ds_read_b64_tr_b16 v[42:43], v4 offset:4736
buffer_load_dwordx2 a[234:235], v20, s[32:35], s54 offen offset:512 sc1
v_mfma_f32_16x16x32_bf16 v[108:111], v[52:55], a[180:183], v[108:111]
ds_read_b64_tr_b16 v[44:45], v4 offset:18560
v_mfma_f32_16x16x32_bf16 v[108:111], v[48:51], a[164:167], v[108:111]
ds_read_b64_tr_b16 v[46:47], v4 offset:23168
v_mfma_f32_16x16x32_bf16 v[144:147], v[48:51], a[168:171], v[144:147]
buffer_load_dwordx2 a[236:237], v20, s[32:35], s55 offen offset:0 sc1
v_mfma_f32_16x16x32_bf16 v[144:147], v[52:55], a[184:187], v[144:147]
v_mfma_f32_16x16x32_bf16 v[180:183], v[52:55], a[188:191], v[180:183]
v_mfma_f32_16x16x32_bf16 v[180:183], v[48:51], a[172:175], v[180:183]
s_waitcnt lgkmcnt(4)
v_mfma_f32_16x16x32_bf16 v[76:79], v[32:35], a[160:163], v[76:79]
ds_read_b64_tr_b16 v[48:49], v4 offset:160
buffer_load_dwordx2 a[238:239], v20, s[32:35], s55 offen offset:512 sc1
v_mfma_f32_16x16x32_bf16 v[76:79], v[36:39], a[176:179], v[76:79]
ds_read_b64_tr_b16 v[50:51], v4 offset:4768
v_mfma_f32_16x16x32_bf16 v[112:115], v[36:39], a[180:183], v[112:115]
ds_read_b64_tr_b16 v[52:53], v4 offset:18592
v_mfma_f32_16x16x32_bf16 v[112:115], v[32:35], a[164:167], v[112:115]
ds_read_b64_tr_b16 v[54:55], v4 offset:23200
v_mfma_f32_16x16x32_bf16 v[148:151], v[32:35], a[168:171], v[148:151]
s_add_u32 s66, s64, 294912
s_add_u32 s66, s66, s63
s_add_u32 m0, s65, 0
v_mfma_f32_16x16x32_bf16 v[148:151], v[36:39], a[184:187], v[148:151]
v_mfma_f32_16x16x32_bf16 v[184:187], v[36:39], a[188:191], v[184:187]
v_mfma_f32_16x16x32_bf16 v[184:187], v[32:35], a[172:175], v[184:187]
buffer_load_dwordx4 v8, s[16:19], s66 offen offset:0 lds
s_waitcnt lgkmcnt(4)
v_mfma_f32_16x16x32_bf16 v[80:83], v[40:43], a[160:163], v[80:83]
ds_read_b64_tr_b16 v[32:33], v4 offset:192
v_mfma_f32_16x16x32_bf16 v[80:83], v[44:47], a[176:179], v[80:83]
ds_read_b64_tr_b16 v[34:35], v4 offset:4800
v_mfma_f32_16x16x32_bf16 v[116:119], v[44:47], a[180:183], v[116:119]
ds_read_b64_tr_b16 v[36:37], v4 offset:18624
buffer_load_dwordx4 v9, s[16:19], s66 offen offset:1024 lds
v_mfma_f32_16x16x32_bf16 v[116:119], v[40:43], a[164:167], v[116:119]
ds_read_b64_tr_b16 v[38:39], v4 offset:23232
v_mfma_f32_16x16x32_bf16 v[152:155], v[40:43], a[168:171], v[152:155]
v_mfma_f32_16x16x32_bf16 v[152:155], v[44:47], a[184:187], v[152:155]
buffer_load_dwordx4 v10, s[16:19], s66 offen offset:2048 lds
v_mfma_f32_16x16x32_bf16 v[188:191], v[44:47], a[188:191], v[188:191]
v_mfma_f32_16x16x32_bf16 v[188:191], v[40:43], a[172:175], v[188:191]
s_waitcnt lgkmcnt(4)
v_mfma_f32_16x16x32_bf16 v[84:87], v[48:51], a[160:163], v[84:87]
ds_read_b64_tr_b16 v[40:41], v4 offset:224
v_mfma_f32_16x16x32_bf16 v[84:87], v[52:55], a[176:179], v[84:87]
ds_read_b64_tr_b16 v[42:43], v4 offset:4832
buffer_load_dwordx4 v11, s[16:19], s66 offen offset:3072 lds
v_mfma_f32_16x16x32_bf16 v[120:123], v[52:55], a[180:183], v[120:123]
ds_read_b64_tr_b16 v[44:45], v4 offset:18656
v_mfma_f32_16x16x32_bf16 v[120:123], v[48:51], a[164:167], v[120:123]
ds_read_b64_tr_b16 v[46:47], v4 offset:23264
v_mfma_f32_16x16x32_bf16 v[156:159], v[48:51], a[168:171], v[156:159]
s_add_u32 m0, s65, 4096
v_mfma_f32_16x16x32_bf16 v[156:159], v[52:55], a[184:187], v[156:159]
v_mfma_f32_16x16x32_bf16 v[192:195], v[52:55], a[188:191], v[192:195]
v_mfma_f32_16x16x32_bf16 v[192:195], v[48:51], a[172:175], v[192:195]
s_waitcnt lgkmcnt(4)
v_mfma_f32_16x16x32_bf16 v[88:91], v[32:35], a[160:163], v[88:91]
ds_read_b64_tr_b16 v[48:49], v4 offset:256
buffer_load_dwordx4 v12, s[16:19], s66 offen offset:0 lds
v_mfma_f32_16x16x32_bf16 v[88:91], v[36:39], a[176:179], v[88:91]
ds_read_b64_tr_b16 v[50:51], v4 offset:4864
v_mfma_f32_16x16x32_bf16 v[124:127], v[36:39], a[180:183], v[124:127]
ds_read_b64_tr_b16 v[52:53], v4 offset:18688
v_mfma_f32_16x16x32_bf16 v[124:127], v[32:35], a[164:167], v[124:127]
ds_read_b64_tr_b16 v[54:55], v4 offset:23296
buffer_load_dwordx4 v13, s[16:19], s66 offen offset:1024 lds
v_mfma_f32_16x16x32_bf16 v[160:163], v[32:35], a[168:171], v[160:163]
v_mfma_f32_16x16x32_bf16 v[160:163], v[36:39], a[184:187], v[160:163]
v_mfma_f32_16x16x32_bf16 v[196:199], v[36:39], a[188:191], v[196:199]
v_mfma_f32_16x16x32_bf16 v[196:199], v[32:35], a[172:175], v[196:199]
buffer_load_dwordx4 v14, s[16:19], s66 offen offset:2048 lds
s_waitcnt lgkmcnt(4)
v_mfma_f32_16x16x32_bf16 v[92:95], v[40:43], a[160:163], v[92:95]
s_waitcnt vmcnt(15)
s_barrier
v_mfma_f32_16x16x32_bf16 v[92:95], v[44:47], a[176:179], v[92:95]
ds_read_b64_tr_b16 v[32:33], v5 offset:0
v_mfma_f32_16x16x32_bf16 v[128:131], v[44:47], a[180:183], v[128:131]
ds_read_b64_tr_b16 v[34:35], v5 offset:4608
buffer_load_dwordx4 v15, s[16:19], s66 offen offset:3072 lds
v_mfma_f32_16x16x32_bf16 v[128:131], v[40:43], a[164:167], v[128:131]
ds_read_b64_tr_b16 v[36:37], v5 offset:18432
v_mfma_f32_16x16x32_bf16 v[164:167], v[40:43], a[168:171], v[164:167]
ds_read_b64_tr_b16 v[38:39], v5 offset:23040
v_mfma_f32_16x16x32_bf16 v[164:167], v[44:47], a[184:187], v[164:167]
v_cmp_ne_u64 vcc, s[94:95], v[22:23]
s_nop 1
s_cmp_lg_u64 vcc, 0
s_cbranch_scc1 SLOW_F4k
BACK_F4k:
v_mfma_f32_16x16x32_bf16 v[200:203], v[44:47], a[188:191], v[200:203]
s_add_u32 m0, s65, 8192
v_mfma_f32_16x16x32_bf16 v[200:203], v[40:43], a[172:175], v[200:203]
s_waitcnt lgkmcnt(4)
v_mfma_f32_16x16x32_bf16 v[96:99], v[48:51], a[160:163], v[96:99]
ds_read_b64_tr_b16 v[40:41], v5 offset:32
v_mfma_f32_16x16x32_bf16 v[96:99], v[52:55], a[176:179], v[96:99]
ds_read_b64_tr_b16 v[42:43], v5 offset:4640
buffer_load_dwordx4 v16, s[16:19], s66 offen offset:0 lds
v_mfma_f32_16x16x32_bf16 v[132:135], v[52:55], a[180:183], v[132:135]
ds_read_b64_tr_b16 v[44:45], v5 offset:18464
v_mfma_f32_16x16x32_bf16 v[132:135], v[48:51], a[164:167], v[132:135]
ds_read_b64_tr_b16 v[46:47], v5 offset:23072
v_mfma_f32_16x16x32_bf16 v[168:171], v[48:51], a[168:171], v[168:171]
v_mfma_f32_16x16x32_bf16 v[168:171], v[52:55], a[184:187], v[168:171]
v_mfma_f32_16x16x32_bf16 v[204:207], v[52:55], a[188:191], v[204:207]
v_mfma_f32_16x16x32_bf16 v[204:207], v[48:51], a[172:175], v[204:207]
s_waitcnt lgkmcnt(4)
s_waitcnt vmcnt(26)
v_mfma_f32_16x16x32_bf16 v[64:67], v[32:35], a[192:195], v[64:67]
ds_read_b64_tr_b16 v[48:49], v5 offset:64
buffer_load_dwordx2 a[240:241], v20, s[32:35], s52 offen offset:1024 sc1
v_mfma_f32_16x16x32_bf16 v[64:67], v[36:39], a[208:211], v[64:67]
ds_read_b64_tr_b16 v[50:51], v5 offset:4672
v_mfma_f32_16x16x32_bf16 v[100:103], v[36:39], a[212:215], v[100:103]
ds_read_b64_tr_b16 v[52:53], v5 offset:18496
v_mfma_f32_16x16x32_bf16 v[100:103], v[32:35], a[196:199], v[100:103]
ds_read_b64_tr_b16 v[54:55], v5 offset:23104
buffer_load_dwordx2 a[242:243], v20, s[32:35], s52 offen offset:1536 sc1
v_mfma_f32_16x16x32_bf16 v[136:139], v[32:35], a[200:203], v[136:139]
v_mfma_f32_16x16x32_bf16 v[136:139], v[36:39], a[216:219], v[136:139]
v_mfma_f32_16x16x32_bf16 v[172:175], v[36:39], a[220:223], v[172:175]
buffer_load_dwordx2 a[244:245], v20, s[32:35], s53 offen offset:1024 sc1
v_mfma_f32_16x16x32_bf16 v[172:175], v[32:35], a[204:207], v[172:175]
s_waitcnt lgkmcnt(4)
v_mfma_f32_16x16x32_bf16 v[68:71], v[40:43], a[192:195], v[68:71]
ds_read_b64_tr_b16 v[32:33], v5 offset:96
v_mfma_f32_16x16x32_bf16 v[68:71], v[44:47], a[208:211], v[68:71]
ds_read_b64_tr_b16 v[34:35], v5 offset:4704
buffer_load_dwordx2 a[246:247], v20, s[32:35], s53 offen offset:1536 sc1
v_mfma_f32_16x16x32_bf16 v[104:107], v[44:47], a[212:215], v[104:107]
ds_read_b64_tr_b16 v[36:37], v5 offset:18528
v_mfma_f32_16x16x32_bf16 v[104:107], v[40:43], a[196:199], v[104:107]
ds_read_b64_tr_b16 v[38:39], v5 offset:23136
v_mfma_f32_16x16x32_bf16 v[140:143], v[40:43], a[200:203], v[140:143]
buffer_load_dwordx2 a[248:249], v20, s[32:35], s54 offen offset:1024 sc1
v_mfma_f32_16x16x32_bf16 v[140:143], v[44:47], a[216:219], v[140:143]
v_mfma_f32_16x16x32_bf16 v[176:179], v[44:47], a[220:223], v[176:179]
v_mfma_f32_16x16x32_bf16 v[176:179], v[40:43], a[204:207], v[176:179]
buffer_load_dwordx2 a[250:251], v20, s[32:35], s54 offen offset:1536 sc1
s_waitcnt lgkmcnt(4)
v_mfma_f32_16x16x32_bf16 v[72:75], v[48:51], a[192:195], v[72:75]
ds_read_b64_tr_b16 v[40:41], v5 offset:128
v_mfma_f32_16x16x32_bf16 v[72:75], v[52:55], a[208:211], v[72:75]
ds_read_b64_tr_b16 v[42:43], v5 offset:4736
v_mfma_f32_16x16x32_bf16 v[108:111], v[52:55], a[212:215], v[108:111]
ds_read_b64_tr_b16 v[44:45], v5 offset:18560
buffer_load_dwordx2 a[252:253], v20, s[32:35], s55 offen offset:1024 sc1
v_mfma_f32_16x16x32_bf16 v[108:111], v[48:51], a[196:199], v[108:111]
ds_read_b64_tr_b16 v[46:47], v5 offset:23168
v_mfma_f32_16x16x32_bf16 v[144:147], v[48:51], a[200:203], v[144:147]
v_mfma_f32_16x16x32_bf16 v[144:147], v[52:55], a[216:219], v[144:147]
buffer_load_dwordx2 a[254:255], v20, s[32:35], s55 offen offset:1536 sc1
v_mfma_f32_16x16x32_bf16 v[180:183], v[52:55], a[220:223], v[180:183]
v_mfma_f32_16x16x32_bf16 v[180:183], v[48:51], a[204:207], v[180:183]
s_waitcnt lgkmcnt(4)
v_mfma_f32_16x16x32_bf16 v[76:79], v[32:35], a[192:195], v[76:79]
ds_read_b64_tr_b16 v[48:49], v5 offset:160
v_mfma_f32_16x16x32_bf16 v[76:79], v[36:39], a[208:211], v[76:79]
ds_read_b64_tr_b16 v[50:51], v5 offset:4768
v_mfma_f32_16x16x32_bf16 v[112:115], v[36:39], a[212:215], v[112:115]
ds_read_b64_tr_b16 v[52:53], v5 offset:18592
v_mfma_f32_16x16x32_bf16 v[112:115], v[32:35], a[196:199], v[112:115]
ds_read_b64_tr_b16 v[54:55], v5 offset:23200
v_mfma_f32_16x16x32_bf16 v[148:151], v[32:35], a[200:203], v[148:151]
s_mov_b32 s67, 8388608
s_add_u32 m0, s50, 147456
v_mfma_f32_16x16x32_bf16 v[148:151], v[36:39], a[216:219], v[148:151]
buffer_load_dwordx4 v219, s[32:35], s67 offen sc1 lds
v_mfma_f32_16x16x32_bf16 v[184:187], v[36:39], a[220:223], v[184:187]
v_mfma_f32_16x16x32_bf16 v[184:187], v[32:35], a[204:207], v[184:187]
s_mov_b32 s67, 8454144
s_add_u32 m0, s50, 148480
s_waitcnt lgkmcnt(4)
v_mfma_f32_16x16x32_bf16 v[80:83], v[40:43], a[192:195], v[80:83]
ds_read_b64_tr_b16 v[32:33], v5 offset:192
v_mfma_f32_16x16x32_bf16 v[80:83], v[44:47], a[208:211], v[80:83]
ds_read_b64_tr_b16 v[34:35], v5 offset:4800
v_mfma_f32_16x16x32_bf16 v[116:119], v[44:47], a[212:215], v[116:119]
ds_read_b64_tr_b16 v[36:37], v5 offset:18624
buffer_load_dwordx4 v219, s[32:35], s67 offen sc1 lds
v_mfma_f32_16x16x32_bf16 v[116:119], v[40:43], a[196:199], v[116:119]
ds_read_b64_tr_b16 v[38:39], v5 offset:23232
v_mfma_f32_16x16x32_bf16 v[152:155], v[40:43], a[200:203], v[152:155]
v_mfma_f32_16x16x32_bf16 v[152:155], v[44:47], a[216:219], v[152:155]
s_mov_b32 s67, 8519680
s_add_u32 m0, s50, 149504
v_mfma_f32_16x16x32_bf16 v[188:191], v[44:47], a[220:223], v[188:191]
v_mfma_f32_16x16x32_bf16 v[188:191], v[40:43], a[204:207], v[188:191]
s_waitcnt lgkmcnt(4)
v_mfma_f32_16x16x32_bf16 v[84:87], v[48:51], a[192:195], v[84:87]
ds_read_b64_tr_b16 v[40:41], v5 offset:224
buffer_load_dwordx4 v219, s[32:35], s67 offen sc1 lds
v_mfma_f32_16x16x32_bf16 v[84:87], v[52:55], a[208:211], v[84:87]
ds_read_b64_tr_b16 v[42:43], v5 offset:4832
v_mfma_f32_16x16x32_bf16 v[120:123], v[52:55], a[212:215], v[120:123]
ds_read_b64_tr_b16 v[44:45], v5 offset:18656
v_mfma_f32_16x16x32_bf16 v[120:123], v[48:51], a[196:199], v[120:123]
ds_read_b64_tr_b16 v[46:47], v5 offset:23264
s_add_u32 m0, s50, 36864
v_mfma_f32_16x16x32_bf16 v[156:159], v[48:51], a[200:203], v[156:159]
v_mfma_f32_16x16x32_bf16 v[156:159], v[52:55], a[216:219], v[156:159]
v_mfma_f32_16x16x32_bf16 v[192:195], v[52:55], a[220:223], v[192:195]
v_mfma_f32_16x16x32_bf16 v[192:195], v[48:51], a[204:207], v[192:195]
buffer_load_dwordx4 v216, s[36:39], s99 offen offset:0 lds
s_waitcnt lgkmcnt(4)
v_mfma_f32_16x16x32_bf16 v[88:91], v[32:35], a[192:195], v[88:91]
ds_read_b64_tr_b16 v[48:49], v5 offset:256
v_mfma_f32_16x16x32_bf16 v[88:91], v[36:39], a[208:211], v[88:91]
ds_read_b64_tr_b16 v[50:51], v5 offset:4864
v_mfma_f32_16x16x32_bf16 v[124:127], v[36:39], a[212:215], v[124:127]
ds_read_b64_tr_b16 v[52:53], v5 offset:18688
buffer_load_dwordx4 v217, s[36:39], s99 offen offset:1024 lds
v_mfma_f32_16x16x32_bf16 v[124:127], v[32:35], a[196:199], v[124:127]
ds_read_b64_tr_b16 v[54:55], v5 offset:23296
v_mfma_f32_16x16x32_bf16 v[160:163], v[32:35], a[200:203], v[160:163]
v_mfma_f32_16x16x32_bf16 v[160:163], v[36:39], a[216:219], v[160:163]
buffer_load_dwordx4 v218, s[36:39], s99 offen offset:2048 lds
v_mfma_f32_16x16x32_bf16 v[196:199], v[36:39], a[220:223], v[196:199]
v_mfma_f32_16x16x32_bf16 v[196:199], v[32:35], a[204:207], v[196:199]
s_waitcnt lgkmcnt(4)
v_mfma_f32_16x16x32_bf16 v[92:95], v[40:43], a[192:195], v[92:95]
s_waitcnt lgkmcnt(0)
s_waitcnt vmcnt(14)
s_barrier
v_mfma_f32_16x16x32_bf16 v[92:95], v[44:47], a[208:211], v[92:95]
ds_read_b64_tr_b16 v[32:33], v2 offset:0
s_add_u32 m0, s50, 49152
v_mfma_f32_16x16x32_bf16 v[128:131], v[44:47], a[212:215], v[128:131]
ds_read_b64_tr_b16 v[34:35], v2 offset:4608
v_mfma_f32_16x16x32_bf16 v[128:131], v[40:43], a[196:199], v[128:131]
ds_read_b64_tr_b16 v[36:37], v2 offset:18432
buffer_load_dwordx4 v216, s[24:27], s99 offen offset:0 sc1 lds
v_mfma_f32_16x16x32_bf16 v[164:167], v[40:43], a[200:203], v[164:167]
ds_read_b64_tr_b16 v[38:39], v2 offset:23040
v_mfma_f32_16x16x32_bf16 v[164:167], v[44:47], a[216:219], v[164:167]
v_mfma_f32_16x16x32_bf16 v[200:203], v[44:47], a[220:223], v[200:203]
buffer_load_dwordx4 v217, s[24:27], s99 offen offset:1024 sc1 lds
v_mfma_f32_16x16x32_bf16 v[200:203], v[40:43], a[204:207], v[200:203]
s_waitcnt lgkmcnt(4)
v_mfma_f32_16x16x32_bf16 v[96:99], v[48:51], a[192:195], v[96:99]
ds_read_b64_tr_b16 v[40:41], v2 offset:32
v_mfma_f32_16x16x32_bf16 v[96:99], v[52:55], a[208:211], v[96:99]
ds_read_b64_tr_b16 v[42:43], v2 offset:4640
buffer_load_dwordx4 v218, s[24:27], s99 offen offset:2048 sc1 lds
v_mfma_f32_16x16x32_bf16 v[132:135], v[52:55], a[212:215], v[132:135]
ds_read_b64_tr_b16 v[44:45], v2 offset:18464
v_mfma_f32_16x16x32_bf16 v[132:135], v[48:51], a[196:199], v[132:135]
ds_read_b64_tr_b16 v[46:47], v2 offset:23072
v_mfma_f32_16x16x32_bf16 v[168:171], v[48:51], a[200:203], v[168:171]
v_mfma_f32_16x16x32_bf16 v[168:171], v[52:55], a[216:219], v[168:171]
v_mfma_f32_16x16x32_bf16 v[204:207], v[52:55], a[220:223], v[204:207]
v_mfma_f32_16x16x32_bf16 v[204:207], v[48:51], a[204:207], v[204:207]
s_waitcnt lgkmcnt(4)
s_waitcnt vmcnt(9)
v_mfma_f32_16x16x32_bf16 v[64:67], v[32:35], a[224:227], v[64:67]
ds_read_b64_tr_b16 v[48:49], v2 offset:64
v_mfma_f32_16x16x32_bf16 v[64:67], v[36:39], a[240:243], v[64:67]
ds_read_b64_tr_b16 v[50:51], v2 offset:4672
v_mfma_f32_16x16x32_bf16 v[100:103], v[36:39], a[244:247], v[100:103]
ds_read_b64_tr_b16 v[52:53], v2 offset:18496
v_mfma_f32_16x16x32_bf16 v[100:103], v[32:35], a[228:231], v[100:103]
ds_read_b64_tr_b16 v[54:55], v2 offset:23104
v_mfma_f32_16x16x32_bf16 v[136:139], v[32:35], a[232:235], v[136:139]
v_mfma_f32_16x16x32_bf16 v[136:139], v[36:39], a[248:251], v[136:139]
v_mfma_f32_16x16x32_bf16 v[172:175], v[36:39], a[252:255], v[172:175]
v_mfma_f32_16x16x32_bf16 v[172:175], v[32:35], a[236:239], v[172:175]
s_waitcnt lgkmcnt(4)
v_mfma_f32_16x16x32_bf16 v[68:71], v[40:43], a[224:227], v[68:71]
ds_read_b64_tr_b16 v[32:33], v2 offset:96
v_mfma_f32_16x16x32_bf16 v[68:71], v[44:47], a[240:243], v[68:71]
ds_read_b64_tr_b16 v[34:35], v2 offset:4704
v_mfma_f32_16x16x32_bf16 v[104:107], v[44:47], a[244:247], v[104:107]
ds_read_b64_tr_b16 v[36:37], v2 offset:18528
v_mfma_f32_16x16x32_bf16 v[104:107], v[40:43], a[228:231], v[104:107]
ds_read_b64_tr_b16 v[38:39], v2 offset:23136
v_mfma_f32_16x16x32_bf16 v[140:143], v[40:43], a[232:235], v[140:143]
v_cvt_pk_bf16_f32 v56, v136, v137
v_cvt_pk_bf16_f32 v57, v138, v139
v_mfma_f32_16x16x32_bf16 v[140:143], v[44:47], a[248:251], v[140:143]
v_cvt_pk_bf16_f32 v58, v172, v173
v_cvt_pk_bf16_f32 v59, v174, v175
v_mfma_f32_16x16x32_bf16 v[176:179], v[44:47], a[252:255], v[176:179]
ds_write_b128 v234, v[56:59] offset:0
v_mfma_f32_16x16x32_bf16 v[176:179], v[40:43], a[236:239], v[176:179]
s_waitcnt lgkmcnt(5)
v_mfma_f32_16x16x32_bf16 v[72:75], v[48:51], a[224:227], v[72:75]
ds_read_b64_tr_b16 v[40:41], v2 offset:128
v_mfma_f32_16x16x32_bf16 v[72:75], v[52:55], a[240:243], v[72:75]
ds_read_b64_tr_b16 v[42:43], v2 offset:4736
v_mfma_f32_16x16x32_bf16 v[108:111], v[52:55], a[244:247], v[108:111]
ds_read_b64_tr_b16 v[44:45], v2 offset:18560
v_mfma_f32_16x16x32_bf16 v[108:111], v[48:51], a[228:231], v[108:111]
ds_read_b64_tr_b16 v[46:47], v2 offset:23168
v_mfma_f32_16x16x32_bf16 v[144:147], v[48:51], a[232:235], v[144:147]
v_cvt_pk_bf16_f32 v60, v140, v141
v_cvt_pk_bf16_f32 v61, v142, v143
v_mfma_f32_16x16x32_bf16 v[144:147], v[52:55], a[248:251], v[144:147]
v_cvt_pk_bf16_f32 v62, v176, v177
v_cvt_pk_bf16_f32 v63, v178, v179
v_mfma_f32_16x16x32_bf16 v[180:183], v[52:55], a[252:255], v[180:183]
ds_write_b128 v234, v[60:63] offset:1024
v_mfma_f32_16x16x32_bf16 v[180:183], v[48:51], a[236:239], v[180:183]
s_waitcnt lgkmcnt(6)
v_mfma_f32_16x16x32_bf16 v[76:79], v[32:35], a[224:227], v[76:79]
ds_read_b64_tr_b16 v[48:49], v2 offset:160
v_mfma_f32_16x16x32_bf16 v[76:79], v[36:39], a[240:243], v[76:79]
ds_read_b64_tr_b16 v[50:51], v2 offset:4768
v_mfma_f32_16x16x32_bf16 v[112:115], v[36:39], a[244:247], v[112:115]
ds_read_b64_tr_b16 v[52:53], v2 offset:18592
v_mfma_f32_16x16x32_bf16 v[112:115], v[32:35], a[228:231], v[112:115]
ds_read_b64_tr_b16 v[54:55], v2 offset:23200
v_mfma_f32_16x16x32_bf16 v[148:151], v[32:35], a[232:235], v[148:151]
v_cvt_pk_bf16_f32 v56, v144, v145
v_cvt_pk_bf16_f32 v57, v146, v147
v_mfma_f32_16x16x32_bf16 v[148:151], v[36:39], a[248:251], v[148:151]
v_cvt_pk_bf16_f32 v58, v180, v181
v_cvt_pk_bf16_f32 v59, v182, v183
v_mfma_f32_16x16x32_bf16 v[184:187], v[36:39], a[252:255], v[184:187]
ds_write_b128 v234, v[56:59] offset:2048
v_mfma_f32_16x16x32_bf16 v[184:187], v[32:35], a[236:239], v[184:187]
s_waitcnt lgkmcnt(6)
v_mfma_f32_16x16x32_bf16 v[80:83], v[40:43], a[224:227], v[80:83]
ds_read_b64_tr_b16 v[32:33], v2 offset:192
v_mfma_f32_16x16x32_bf16 v[80:83], v[44:47], a[240:243], v[80:83]
ds_read_b64_tr_b16 v[34:35], v2 offset:4800
v_mfma_f32_16x16x32_bf16 v[116:119], v[44:47], a[244:247], v[116:119]
ds_read_b64_tr_b16 v[36:37], v2 offset:18624
v_mfma_f32_16x16x32_bf16 v[116:119], v[40:43], a[228:231], v[116:119]
ds_read_b64_tr_b16 v[38:39], v2 offset:23232
v_mfma_f32_16x16x32_bf16 v[152:155], v[40:43], a[232:235], v[152:155]
v_cvt_pk_bf16_f32 v60, v148, v149
v_cvt_pk_bf16_f32 v61, v150, v151
v_mfma_f32_16x16x32_bf16 v[152:155], v[44:47], a[248:251], v[152:155]
v_cvt_pk_bf16_f32 v62, v184, v185
v_cvt_pk_bf16_f32 v63, v186, v187
v_mfma_f32_16x16x32_bf16 v[188:191], v[44:47], a[252:255], v[188:191]
ds_write_b128 v234, v[60:63] offset:3072
v_mfma_f32_16x16x32_bf16 v[188:191], v[40:43], a[236:239], v[188:191]
s_waitcnt lgkmcnt(6)
v_mfma_f32_16x16x32_bf16 v[84:87], v[48:51], a[224:227], v[84:87]
ds_read_b64_tr_b16 v[40:41], v2 offset:224
v_mfma_f32_16x16x32_bf16 v[84:87], v[52:55], a[240:243], v[84:87]
ds_read_b64_tr_b16 v[42:43], v2 offset:4832
v_mfma_f32_16x16x32_bf16 v[120:123], v[52:55], a[244:247], v[120:123]
ds_read_b64_tr_b16 v[44:45], v2 offset:18656
v_mfma_f32_16x16x32_bf16 v[120:123], v[48:51], a[228:231], v[120:123]
ds_read_b64_tr_b16 v[46:47], v2 offset:23264
v_mfma_f32_16x16x32_bf16 v[156:159], v[48:51], a[232:235], v[156:159]
v_cvt_pk_bf16_f32 v56, v152, v153
v_cvt_pk_bf16_f32 v57, v154, v155
v_mfma_f32_16x16x32_bf16 v[156:159], v[52:55], a[248:251], v[156:159]
v_cvt_pk_bf16_f32 v58, v188, v189
v_cvt_pk_bf16_f32 v59, v190, v191
v_mfma_f32_16x16x32_bf16 v[192:195], v[52:55], a[252:255], v[192:195]
ds_write_b128 v234, v[56:59] offset:4096
v_mfma_f32_16x16x32_bf16 v[192:195], v[48:51], a[236:239], v[192:195]
s_waitcnt lgkmcnt(6)
v_mfma_f32_16x16x32_bf16 v[88:91], v[32:35], a[224:227], v[88:91]
ds_read_b64_tr_b16 v[48:49], v2 offset:256
v_mfma_f32_16x16x32_bf16 v[88:91], v[36:39], a[240:243], v[88:91]
ds_read_b64_tr_b16 v[50:51], v2 offset:4864
v_mfma_f32_16x16x32_bf16 v[124:127], v[36:39], a[244:247], v[124:127]
ds_read_b64_tr_b16 v[52:53], v2 offset:18688
v_mfma_f32_16x16x32_bf16 v[124:127], v[32:35], a[228:231], v[124:127]
ds_read_b64_tr_b16 v[54:55], v2 offset:23296
v_mfma_f32_16x16x32_bf16 v[160:163], v[32:35], a[232:235], v[160:163]
v_cvt_pk_bf16_f32 v60, v156, v157
v_cvt_pk_bf16_f32 v61, v158, v159
v_mfma_f32_16x16x32_bf16 v[160:163], v[36:39], a[248:251], v[160:163]
v_cvt_pk_bf16_f32 v62, v192, v193
v_cvt_pk_bf16_f32 v63, v194, v195
v_mfma_f32_16x16x32_bf16 v[196:199], v[36:39], a[252:255], v[196:199]
ds_write_b128 v234, v[60:63] offset:5120
v_mfma_f32_16x16x32_bf16 v[196:199], v[32:35], a[236:239], v[196:199]
s_waitcnt lgkmcnt(6)
v_mfma_f32_16x16x32_bf16 v[92:95], v[40:43], a[224:227], v[92:95]
v_mfma_f32_16x16x32_bf16 v[92:95], v[44:47], a[240:243], v[92:95]
v_mfma_f32_16x16x32_bf16 v[128:131], v[44:47], a[244:247], v[128:131]
v_mfma_f32_16x16x32_bf16 v[128:131], v[40:43], a[228:231], v[128:131]
v_mfma_f32_16x16x32_bf16 v[164:167], v[40:43], a[232:235], v[164:167]
v_cvt_pk_bf16_f32 v56, v160, v161
v_cvt_pk_bf16_f32 v57, v162, v163
v_mfma_f32_16x16x32_bf16 v[164:167], v[44:47], a[248:251], v[164:167]
v_cvt_pk_bf16_f32 v58, v196, v197
v_cvt_pk_bf16_f32 v59, v198, v199
v_mfma_f32_16x16x32_bf16 v[200:203], v[44:47], a[252:255], v[200:203]
ds_write_b128 v234, v[56:59] offset:6144
v_mfma_f32_16x16x32_bf16 v[200:203], v[40:43], a[236:239], v[200:203]
s_waitcnt lgkmcnt(2)
v_mfma_f32_16x16x32_bf16 v[96:99], v[48:51], a[224:227], v[96:99]
v_mfma_f32_16x16x32_bf16 v[96:99], v[52:55], a[240:243], v[96:99]
v_mfma_f32_16x16x32_bf16 v[132:135], v[52:55], a[244:247], v[132:135]
v_mfma_f32_16x16x32_bf16 v[132:135], v[48:51], a[228:231], v[132:135]
v_mfma_f32_16x16x32_bf16 v[168:171], v[48:51], a[232:235], v[168:171]
v_mfma_f32_16x16x32_bf16 v[168:171], v[52:55], a[248:251], v[168:171]
v_mfma_f32_16x16x32_bf16 v[204:207], v[52:55], a[252:255], v[204:207]
v_mfma_f32_16x16x32_bf16 v[204:207], v[48:51], a[236:239], v[204:207]
FINAL:
v_cvt_pk_bf16_f32 v60, v164, v165
v_cvt_pk_bf16_f32 v61, v166, v167
v_cvt_pk_bf16_f32 v62, v200, v201
v_cvt_pk_bf16_f32 v63, v202, v203
ds_write_b128 v234, v[60:63] offset:7168
v_mov_b32 v246, 0x3f80
v_mov_b32 v247, 0x3f800000
s_nop 0
v_cvt_pk_bf16_f32 v56, v168, v169
v_cvt_pk_bf16_f32 v57, v170, v171
v_cvt_pk_bf16_f32 v58, v204, v205
v_cvt_pk_bf16_f32 v59, v206, v207
ds_write_b128 v234, v[56:59] offset:8192
s_waitcnt vmcnt(0) lgkmcnt(0)
s_barrier
ds_read_b128 v[136:139], v235 offset:0
ds_read_b128 v[140:143], v235 offset:1024
ds_read_b128 v[144:147], v235 offset:2048
ds_read_b128 v[148:151], v235 offset:3072
ds_read_b128 v[152:155], v235 offset:4096
ds_read_b128 v[156:159], v235 offset:5120
ds_read_b128 v[160:163], v235 offset:6144
ds_read_b128 v[164:167], v235 offset:7168
ds_read_b128 v[168:171], v235 offset:8192
s_cmp_eq_u32 s14, s41
s_cbranch_scc1 OWNQ
s_waitcnt lgkmcnt(8)
v_dot2c_f32_bf16 v64, v136, v246
v_dot2c_f32_bf16 v65, v136, v247
v_dot2c_f32_bf16 v66, v137, v246
v_dot2c_f32_bf16 v67, v137, v247
v_dot2c_f32_bf16 v100, v138, v246
v_dot2c_f32_bf16 v101, v138, v247
v_dot2c_f32_bf16 v102, v139, v246
v_dot2c_f32_bf16 v103, v139, v247
s_waitcnt lgkmcnt(7)
v_dot2c_f32_bf16 v68, v140, v246
v_dot2c_f32_bf16 v69, v140, v247
v_dot2c_f32_bf16 v70, v141, v246
v_dot2c_f32_bf16 v71, v141, v247
v_dot2c_f32_bf16 v104, v142, v246
v_dot2c_f32_bf16 v105, v142, v247
v_dot2c_f32_bf16 v106, v143, v246
v_dot2c_f32_bf16 v107, v143, v247
v_cvt_pk_bf16_f32 v32, v64, v65
v_cvt_pk_bf16_f32 v33, v66, v67
v_cvt_pk_bf16_f32 v34, v100, v101
v_cvt_pk_bf16_f32 v35, v102, v103
buffer_store_dwordx4 v[32:35], v7, s[32:35], s15 offen offset:0 sc1
s_waitcnt lgkmcnt(6)
v_dot2c_f32_bf16 v72, v144, v246
v_dot2c_f32_bf16 v73, v144, v247
v_dot2c_f32_bf16 v74, v145, v246
v_dot2c_f32_bf16 v75, v145, v247
v_dot2c_f32_bf16 v108, v146, v246
v_dot2c_f32_bf16 v109, v146, v247
v_dot2c_f32_bf16 v110, v147, v246
v_dot2c_f32_bf16 v111, v147, v247
v_cvt_pk_bf16_f32 v36, v68, v69
v_cvt_pk_bf16_f32 v37, v70, v71
v_cvt_pk_bf16_f32 v38, v104, v105
v_cvt_pk_bf16_f32 v39, v106, v107
buffer_store_dwordx4 v[36:39], v7, s[32:35], s15 offen offset:1024 sc1
s_waitcnt lgkmcnt(5)
v_dot2c_f32_bf16 v76, v148, v246
v_dot2c_f32_bf16 v77, v148, v247
v_dot2c_f32_bf16 v78, v149, v246
v_dot2c_f32_bf16 v79, v149, v247
v_dot2c_f32_bf16 v112, v150, v246
v_dot2c_f32_bf16 v113, v150, v247
v_dot2c_f32_bf16 v114, v151, v246
v_dot2c_f32_bf16 v115, v151, v247
v_cvt_pk_bf16_f32 v40, v72, v73
v_cvt_pk_bf16_f32 v41, v74, v75
v_cvt_pk_bf16_f32 v42, v108, v109
v_cvt_pk_bf16_f32 v43, v110, v111
buffer_store_dwordx4 v[40:43], v7, s[32:35], s15 offen offset:2048 sc1
s_waitcnt lgkmcnt(4)
v_dot2c_f32_bf16 v80, v152, v246
v_dot2c_f32_bf16 v81, v152, v247
v_dot2c_f32_bf16 v82, v153, v246
v_dot2c_f32_bf16 v83, v153, v247
v_dot2c_f32_bf16 v116, v154, v246
v_dot2c_f32_bf16 v117, v154, v247
v_dot2c_f32_bf16 v118, v155, v246
v_dot2c_f32_bf16 v119, v155, v247
v_cvt_pk_bf16_f32 v44, v76, v77
v_cvt_pk_bf16_f32 v45, v78, v79
v_cvt_pk_bf16_f32 v46, v112, v113
v_cvt_pk_bf16_f32 v47, v114, v115
buffer_store_dwordx4 v[44:47], v7, s[32:35], s15 offen offset:3072 sc1
s_waitcnt lgkmcnt(3)
v_dot2c_f32_bf16 v84, v156, v246
v_dot2c_f32_bf16 v85, v156, v247
v_dot2c_f32_bf16 v86, v157, v246
v_dot2c_f32_bf16 v87, v157, v247
v_dot2c_f32_bf16 v120, v158, v246
v_dot2c_f32_bf16 v121, v158, v247
v_dot2c_f32_bf16 v122, v159, v246
v_dot2c_f32_bf16 v123, v159, v247
v_cvt_pk_bf16_f32 v48, v80, v81
v_cvt_pk_bf16_f32 v49, v82, v83
v_cvt_pk_bf16_f32 v50, v116, v117
v_cvt_pk_bf16_f32 v51, v118, v119
s_add_u32 s15, s15, 4096
buffer_store_dwordx4 v[48:51], v7, s[32:35], s15 offen offset:0 sc1
s_waitcnt lgkmcnt(2)
v_dot2c_f32_bf16 v88, v160, v246
v_dot2c_f32_bf16 v89, v160, v247
v_dot2c_f32_bf16 v90, v161, v246
v_dot2c_f32_bf16 v91, v161, v247
v_dot2c_f32_bf16 v124, v162, v246
v_dot2c_f32_bf16 v125, v162, v247
v_dot2c_f32_bf16 v126, v163, v246
v_dot2c_f32_bf16 v127, v163, v247
v_cvt_pk_bf16_f32 v52, v84, v85
v_cvt_pk_bf16_f32 v53, v86, v87
v_cvt_pk_bf16_f32 v54, v120, v121
v_cvt_pk_bf16_f32 v55, v122, v123
STUB_g11:
s_cbranch_execz NEXT_g11
buffer_store_dwordx4 v[52:55], v7, s[32:35], s15 offen offset:1024 sc1
s_waitcnt lgkmcnt(1)
v_dot2c_f32_bf16 v92, v164, v246
v_dot2c_f32_bf16 v93, v164, v247
v_dot2c_f32_bf16 v94, v165, v246
v_dot2c_f32_bf16 v95, v165, v247
v_dot2c_f32_bf16 v128, v166, v246
v_dot2c_f32_bf16 v129, v166, v247
v_dot2c_f32_bf16 v130, v167, v246
v_dot2c_f32_bf16 v131, v167, v247
v_cvt_pk_bf16_f32 v32, v88, v89
v_cvt_pk_bf16_f32 v33, v90, v91
v_cvt_pk_bf16_f32 v34, v124, v125
v_cvt_pk_bf16_f32 v35, v126, v127
buffer_store_dwordx4 v[32:35], v7, s[32:35], s15 offen offset:2048 sc1
s_waitcnt lgkmcnt(0)
v_dot2c_f32_bf16 v96, v168, v246
v_dot2c_f32_bf16 v97, v168, v247
v_dot2c_f32_bf16 v98, v169, v246
v_dot2c_f32_bf16 v99, v169, v247
v_dot2c_f32_bf16 v132, v170, v246
v_dot2c_f32_bf16 v133, v170, v247
v_dot2c_f32_bf16 v134, v171, v246
v_dot2c_f32_bf16 v135, v171, v247
v_cvt_pk_bf16_f32 v36, v92, v93
v_cvt_pk_bf16_f32 v37, v94, v95
v_cvt_pk_bf16_f32 v38, v128, v129
v_cvt_pk_bf16_f32 v39, v130, v131
buffer_store_dwordx4 v[36:39], v7, s[32:35], s15 offen offset:3072 sc1
s_nop 2
v_cvt_pk_bf16_f32 v40, v96, v97
v_cvt_pk_bf16_f32 v41, v98, v99
v_cvt_pk_bf16_f32 v42, v132, v133
v_cvt_pk_bf16_f32 v43, v134, v135
s_add_u32 s15, s15, 4096
buffer_store_dwordx4 v[40:43], v7, s[32:35], s15 offen offset:0 sc1
s_branch OWNQ_DONE
OWNQ:
s_waitcnt lgkmcnt(8)
v_dot2c_f32_bf16 v64, v136, v246
v_dot2c_f32_bf16 v65, v136, v247
v_dot2c_f32_bf16 v66, v137, v246
v_dot2c_f32_bf16 v67, v137, v247
v_dot2c_f32_bf16 v100, v138, v246
v_dot2c_f32_bf16 v101, v138, v247
v_dot2c_f32_bf16 v102, v139, v246
v_dot2c_f32_bf16 v103, v139, v247
s_waitcnt lgkmcnt(7)
v_dot2c_f32_bf16 v68, v140, v246
v_dot2c_f32_bf16 v69, v140, v247
v_dot2c_f32_bf16 v70, v141, v246
v_dot2c_f32_bf16 v71, v141, v247
v_dot2c_f32_bf16 v104, v142, v246
v_dot2c_f32_bf16 v105, v142, v247
v_dot2c_f32_bf16 v106, v143, v246
v_dot2c_f32_bf16 v107, v143, v247
s_waitcnt lgkmcnt(6)
v_dot2c_f32_bf16 v72, v144, v246
v_dot2c_f32_bf16 v73, v144, v247
v_dot2c_f32_bf16 v74, v145, v246
v_dot2c_f32_bf16 v75, v145, v247
v_dot2c_f32_bf16 v108, v146, v246
v_dot2c_f32_bf16 v109, v146, v247
v_dot2c_f32_bf16 v110, v147, v246
v_dot2c_f32_bf16 v111, v147, v247
s_waitcnt lgkmcnt(5)
v_dot2c_f32_bf16 v76, v148, v246
v_dot2c_f32_bf16 v77, v148, v247
v_dot2c_f32_bf16 v78, v149, v246
v_dot2c_f32_bf16 v79, v149, v247
v_dot2c_f32_bf16 v112, v150, v246
v_dot2c_f32_bf16 v113, v150, v247
v_dot2c_f32_bf16 v114, v151, v246
v_dot2c_f32_bf16 v115, v151, v247
s_waitcnt lgkmcnt(4)
v_dot2c_f32_bf16 v80, v152, v246
v_dot2c_f32_bf16 v81, v152, v247
v_dot2c_f32_bf16 v82, v153, v246
v_dot2c_f32_bf16 v83, v153, v247
v_dot2c_f32_bf16 v116, v154, v246
v_dot2c_f32_bf16 v117, v154, v247
v_dot2c_f32_bf16 v118, v155, v246
v_dot2c_f32_bf16 v119, v155, v247
s_waitcnt lgkmcnt(3)
v_dot2c_f32_bf16 v84, v156, v246
v_dot2c_f32_bf16 v85, v156, v247
v_dot2c_f32_bf16 v86, v157, v246
v_dot2c_f32_bf16 v87, v157, v247
v_dot2c_f32_bf16 v120, v158, v246
v_dot2c_f32_bf16 v121, v158, v247
v_dot2c_f32_bf16 v122, v159, v246
v_dot2c_f32_bf16 v123, v159, v247
s_waitcnt lgkmcnt(2)
v_dot2c_f32_bf16 v88, v160, v246
v_dot2c_f32_bf16 v89, v160, v247
v_dot2c_f32_bf16 v90, v161, v246
v_dot2c_f32_bf16 v91, v161, v247
v_dot2c_f32_bf16 v124, v162, v246
v_dot2c_f32_bf16 v125, v162, v247
v_dot2c_f32_bf16 v126, v163, v246
v_dot2c_f32_bf16 v127, v163, v247
s_waitcnt lgkmcnt(1)
v_dot2c_f32_bf16 v92, v164, v246
v_dot2c_f32_bf16 v93, v164, v247
v_dot2c_f32_bf16 v94, v165, v246
v_dot2c_f32_bf16 v95, v165, v247
v_dot2c_f32_bf16 v128, v166, v246
v_dot2c_f32_bf16 v129, v166, v247
v_dot2c_f32_bf16 v130, v167, v246
v_dot2c_f32_bf16 v131, v167, v247
s_waitcnt lgkmcnt(0)
v_dot2c_f32_bf16 v96, v168, v246
v_dot2c_f32_bf16 v97, v168, v247
v_dot2c_f32_bf16 v98, v169, v246
v_dot2c_f32_bf16 v99, v169, v247
v_dot2c_f32_bf16 v132, v170, v246
v_dot2c_f32_bf16 v133, v170, v247
v_dot2c_f32_bf16 v134, v171, v246
v_dot2c_f32_bf16 v135, v171, v247
s_nop 2
ds_write_b128 v7, v[64:67] offset:0
ds_write_b128 v7, v[100:103] offset:1024
ds_write_b128 v7, v[68:71] offset:2048
ds_write_b128 v7, v[104:107] offset:3072
ds_write_b128 v7, v[72:75] offset:4096
ds_write_b128 v7, v[108:111] offset:5120
ds_write_b128 v7, v[76:79] offset:6144
ds_write_b128 v7, v[112:115] offset:7168
ds_write_b128 v7, v[80:83] offset:8192
ds_write_b128 v7, v[116:119] offset:9216
ds_write_b128 v7, v[84:87] offset:10240
ds_write_b128 v7, v[120:123] offset:11264
ds_write_b128 v7, v[88:91] offset:12288
ds_write_b128 v7, v[124:127] offset:13312
ds_write_b128 v7, v[92:95] offset:14336
ds_write_b128 v7, v[128:131] offset:15360
ds_write_b128 v7, v[96:99] offset:16384
ds_write_b128 v7, v[132:135] offset:17408
OWNQ_DONE:
v_and_b32 v252, 15, v1
v_lshrrev_b32 v253, 4, v1
s_and_b32 s59, s14, 1
s_lshl_b32 s58, s14, 6
v_mul_u32_u24 v227, 288, v252
v_lshl_add_u32 v227, v253, 3, v227
s_mul_i32 s60, s59, 4608
s_add_u32 s60, s60, 37120
v_add_u32 v228, s60, v227
s_add_u32 s58, s58, 36864
v_add_u32 v227, s58, v227
v_lshrrev_b32 v250, 2, v1
v_and_b32 v251, 3, v1
v_lshlrev_b32 v229, 6, v250
v_lshl_add_u32 v229, v251, 3, v229
s_lshl_b32 s58, s59, 5
s_add_u32 s58, s58, 155648
v_add_u32 v230, s58, v229
s_lshl_b32 s58, s14, 11
s_add_u32 s58, s58, 147456
v_add_u32 v229, s58, v229
ds_read_b64 v[236:237], v227 offset:12288
ds_read_b64_tr_b16 v[146:147], v229 offset:0
ds_read_b64 v[136:137], v227 offset:0
ds_read_b64 v[238:239], v227 offset:16896
ds_read_b64_tr_b16 v[148:149], v229 offset:32
ds_read_b64 v[138:139], v227 offset:4608
ds_read_b64 v[240:241], v227 offset:12320
ds_read_b64_tr_b16 v[150:151], v229 offset:1024
ds_read_b64 v[140:141], v227 offset:32
ds_read_b64 v[242:243], v227 offset:16928
ds_read_b64_tr_b16 v[152:153], v229 offset:1056
ds_read_b64 v[142:143], v227 offset:4640
ds_read_b64 v[244:245], v228 offset:12288
ds_read_b64_tr_b16 v[154:155], v230 offset:0
ds_read_b64 v[144:145], v228 offset:0
v_mul_u32_u24 v224, 1152, v252
v_lshl_add_u32 v224, v253, 3, v224
s_mul_i32 s58, s59, 18432
s_add_u32 s58, s58, 256
s_cmp_lt_u32 s14, 2
s_cselect_b32 s58, s58, 2146435072
v_add_u32 v226, s58, v224
s_lshl_b32 s58, s14, 6
v_add_u32 v224, s58, v224
v_add_u32 v225, 18432, v224
s_lshl_b32 s58, s59, 3
v_add_u32 v233, s58, v7
s_mov_b32 s20, s88
s_mov_b32 s21, s89
s_mov_b32 s22, 2359296
s_lshl_b32 s60, s43, 2
s_add_u32 s60, s60, s42
s_lshl_b32 s44, s60, 7
s_add_u32 s44, s44, 63111168
s_mul_i32 s60, s60, 36864
s_add_u32 s60, s60, 50331648
s_lshl_b32 s59, s14, 11
s_add_u32 s58, s41, 1
s_and_b32 s58, s58, 3
s_mul_i32 s58, s58, 9216
s_add_u32 s8, s58, s60
s_add_u32 s4, s8, s59
s_add_u32 s8, s8, 8192
s_add_u32 s58, s41, 2
s_and_b32 s58, s58, 3
s_mul_i32 s58, s58, 9216
s_add_u32 s9, s58, s60
s_add_u32 s5, s9, s59
s_add_u32 s9, s9, 8192
s_add_u32 s58, s41, 3
s_and_b32 s58, s58, 3
s_mul_i32 s58, s58, 9216
s_add_u32 s10, s58, s60
s_add_u32 s6, s10, s59
s_add_u32 s10, s10, 8192
v_and_b32 v19, 3, v1
v_lshlrev_b32 v19, 3, v19
s_mov_b32 s50, 0xbfb8aa3b
s_waitcnt lgkmcnt(0)
v_lshlrev_b32 v176, 16, v136
v_and_b32 v177, s80, v136
v_lshlrev_b32 v178, 16, v137
v_and_b32 v179, s80, v137
v_lshlrev_b32 v156, 16, v236
v_and_b32 v157, s80, v236
v_lshlrev_b32 v158, 16, v237
v_and_b32 v159, s80, v237
v_lshlrev_b32 v196, 16, v146
v_and_b32 v197, s80, v146
v_lshlrev_b32 v198, 16, v147
v_and_b32 v199, s80, v147
v_mul_f32 v156, v156, v196
v_mul_f32 v157, v157, v197
v_mul_f32 v158, v158, v198
v_mul_f32 v159, v159, v199
v_lshlrev_b32 v180, 16, v138
v_and_b32 v181, s80, v138
v_lshlrev_b32 v182, 16, v139
v_and_b32 v183, s80, v139
v_lshlrev_b32 v160, 16, v238
v_and_b32 v161, s80, v238
v_lshlrev_b32 v162, 16, v239
v_and_b32 v163, s80, v239
v_lshlrev_b32 v196, 16, v148
v_and_b32 v197, s80, v148
v_lshlrev_b32 v198, 16, v149
v_and_b32 v199, s80, v149
v_mul_f32 v160, v160, v196
v_mul_f32 v161, v161, v197
v_mul_f32 v162, v162, v198
v_mul_f32 v163, v163, v199
v_lshlrev_b32 v184, 16, v140
v_and_b32 v185, s80, v140
v_lshlrev_b32 v186, 16, v141
v_and_b32 v187, s80, v141
v_lshlrev_b32 v164, 16, v240
v_and_b32 v165, s80, v240
v_lshlrev_b32 v166, 16, v241
v_and_b32 v167, s80, v241
v_lshlrev_b32 v196, 16, v150
v_and_b32 v197, s80, v150
v_lshlrev_b32 v198, 16, v151
v_and_b32 v199, s80, v151
v_mul_f32 v164, v164, v196
v_mul_f32 v165, v165, v197
v_mul_f32 v166, v166, v198
v_mul_f32 v167, v167, v199
v_lshlrev_b32 v188, 16, v142
v_and_b32 v189, s80, v142
v_lshlrev_b32 v190, 16, v143
v_and_b32 v191, s80, v143
v_lshlrev_b32 v168, 16, v242
v_and_b32 v169, s80, v242
v_lshlrev_b32 v170, 16, v243
v_and_b32 v171, s80, v243
v_lshlrev_b32 v196, 16, v152
v_and_b32 v197, s80, v152
v_lshlrev_b32 v198, 16, v153
v_and_b32 v199, s80, v153
v_mul_f32 v168, v168, v196
v_mul_f32 v169, v169, v197
v_mul_f32 v170, v170, v198
v_mul_f32 v171, v171, v199
v_lshlrev_b32 v192, 16, v144
v_and_b32 v193, s80, v144
v_lshlrev_b32 v194, 16, v145
v_and_b32 v195, s80, v145
v_lshlrev_b32 v172, 16, v244
v_and_b32 v173, s80, v244
v_lshlrev_b32 v174, 16, v245
v_and_b32 v175, s80, v245
v_lshlrev_b32 v196, 16, v154
v_and_b32 v197, s80, v154
v_lshlrev_b32 v198, 16, v155
v_and_b32 v199, s80, v155
v_mul_f32 v172, v172, v196
v_mul_f32 v173, v173, v197
v_mul_f32 v174, v174, v198
v_mul_f32 v175, v175, v199
s_waitcnt vmcnt(0)
buffer_store_dwordx2 v[26:27], v25, s[32:35], s3 offen sc1
s_barrier
s_lshl_b32 s58, s14, 12
v_add_u32 v2, s58, v7
s_lshl_b32 s58, s47, 10
s_add_u32 s58, s58, 16384
v_add_u32 v3, s58, v7
s_mov_b32 s98, 0
buffer_load_dwordx2 v[22:23], v19, s[32:35], s44 offen sc1
ds_read_b128 v[64:67], v2 offset:0
ds_read_b128 v[68:71], v2 offset:1024
ds_read_b128 v[72:75], v2 offset:2048
ds_read_b128 v[76:79], v2 offset:3072
ds_read_b128 v[80:83], v3
s_branch PE_F5
PL_F5:
buffer_load_dwordx2 v[22:23], v19, s[32:35], s44 offen sc1
PE_F5:
s_add_u32 s98, s98, 1
s_waitcnt vmcnt(0)
v_cmp_ne_u64 vcc, s[94:95], v[22:23]
s_cmp_gt_u32 s98, 524288
s_cbranch_scc1 PD_F5
s_cmp_lg_u64 vcc, 0
s_cbranch_scc1 PL_F5
PD_F5:
buffer_load_dwordx4 v[84:87], v7, s[32:35], s4 offen offset:0 sc1
buffer_load_dwordx4 v[88:91], v7, s[32:35], s5 offen offset:0 sc1
buffer_load_dwordx4 v[92:95], v7, s[32:35], s6 offen offset:0 sc1
buffer_load_dwordx4 v[96:99], v7, s[32:35], s4 offen offset:1024 sc1
buffer_load_dwordx4 v[100:103], v7, s[32:35], s5 offen offset:1024 sc1
buffer_load_dwordx4 v[104:107], v7, s[32:35], s6 offen offset:1024 sc1
buffer_load_dwordx2 v[108:109], v233, s[32:35], s8 offen sc1
buffer_load_dwordx2 v[110:111], v233, s[32:35], s9 offen sc1
buffer_load_dwordx2 v[112:113], v233, s[32:35], s10 offen sc1
s_waitcnt lgkmcnt(0)
s_waitcnt vmcnt(6)
v_dot2c_f32_bf16 v64, v84, v246
v_dot2c_f32_bf16 v65, v84, v247
v_dot2c_f32_bf16 v66, v85, v246
v_dot2c_f32_bf16 v67, v85, v247
v_dot2c_f32_bf16 v64, v88, v246
v_dot2c_f32_bf16 v65, v88, v247
v_dot2c_f32_bf16 v66, v89, v246
v_dot2c_f32_bf16 v67, v89, v247
v_dot2c_f32_bf16 v64, v92, v246
v_dot2c_f32_bf16 v65, v92, v247
v_dot2c_f32_bf16 v66, v93, v246
v_dot2c_f32_bf16 v67, v93, v247
s_nop 2
v_mul_f32 v196, s50, v64
v_mul_f32 v197, s50, v65
v_mul_f32 v198, s50, v66
v_mul_f32 v199, s50, v67
v_exp_f32 v196, v196
v_exp_f32 v197, v197
v_exp_f32 v198, v198
v_exp_f32 v199, v199
v_mul_f32 v64, v64, v156
v_mul_f32 v65, v65, v157
v_mul_f32 v66, v66, v158
v_mul_f32 v67, v67, v159
v_add_f32 v196, 1.0, v196
v_add_f32 v197, 1.0, v197
v_add_f32 v198, 1.0, v198
v_add_f32 v199, 1.0, v199
v_rcp_f32 v196, v196
v_rcp_f32 v197, v197
v_rcp_f32 v198, v198
v_rcp_f32 v199, v199
s_nop 0
v_fmac_f32 v176, v64, v196
v_fmac_f32 v177, v65, v197
v_fmac_f32 v178, v66, v198
v_fmac_f32 v179, v67, v199
v_cvt_pk_bf16_f32 v116, v176, v177
v_cvt_pk_bf16_f32 v117, v178, v179
buffer_store_dwordx2 v[116:117], v224, s[20:23], s99 offen offset:0
v_dot2c_f32_bf16 v68, v86, v246
v_dot2c_f32_bf16 v69, v86, v247
v_dot2c_f32_bf16 v70, v87, v246
v_dot2c_f32_bf16 v71, v87, v247
v_dot2c_f32_bf16 v68, v90, v246
v_dot2c_f32_bf16 v69, v90, v247
v_dot2c_f32_bf16 v70, v91, v246
v_dot2c_f32_bf16 v71, v91, v247
v_dot2c_f32_bf16 v68, v94, v246
v_dot2c_f32_bf16 v69, v94, v247
v_dot2c_f32_bf16 v70, v95, v246
v_dot2c_f32_bf16 v71, v95, v247
s_nop 2
v_mul_f32 v200, s50, v68
v_mul_f32 v201, s50, v69
v_mul_f32 v202, s50, v70
v_mul_f32 v203, s50, v71
v_exp_f32 v200, v200
v_exp_f32 v201, v201
v_exp_f32 v202, v202
v_exp_f32 v203, v203
v_mul_f32 v68, v68, v160
v_mul_f32 v69, v69, v161
v_mul_f32 v70, v70, v162
v_mul_f32 v71, v71, v163
v_add_f32 v200, 1.0, v200
v_add_f32 v201, 1.0, v201
v_add_f32 v202, 1.0, v202
v_add_f32 v203, 1.0, v203
v_rcp_f32 v200, v200
v_rcp_f32 v201, v201
v_rcp_f32 v202, v202
v_rcp_f32 v203, v203
s_nop 0
v_fmac_f32 v180, v68, v200
v_fmac_f32 v181, v69, v201
v_fmac_f32 v182, v70, v202
v_fmac_f32 v183, v71, v203
v_cvt_pk_bf16_f32 v118, v180, v181
v_cvt_pk_bf16_f32 v119, v182, v183
buffer_store_dwordx2 v[118:119], v225, s[20:23], s99 offen offset:0
s_waitcnt vmcnt(5)
v_dot2c_f32_bf16 v72, v96, v246
v_dot2c_f32_bf16 v73, v96, v247
v_dot2c_f32_bf16 v74, v97, v246
v_dot2c_f32_bf16 v75, v97, v247
v_dot2c_f32_bf16 v72, v100, v246
v_dot2c_f32_bf16 v73, v100, v247
v_dot2c_f32_bf16 v74, v101, v246
v_dot2c_f32_bf16 v75, v101, v247
v_dot2c_f32_bf16 v72, v104, v246
v_dot2c_f32_bf16 v73, v104, v247
v_dot2c_f32_bf16 v74, v105, v246
v_dot2c_f32_bf16 v75, v105, v247
s_nop 2
v_mul_f32 v196, s50, v72
v_mul_f32 v197, s50, v73
v_mul_f32 v198, s50, v74
v_mul_f32 v199, s50, v75
v_exp_f32 v196, v196
v_exp_f32 v197, v197
v_exp_f32 v198, v198
v_exp_f32 v199, v199
v_mul_f32 v72, v72, v164
v_mul_f32 v73, v73, v165
v_mul_f32 v74, v74, v166
v_mul_f32 v75, v75, v167
v_add_f32 v196, 1.0, v196
v_add_f32 v197, 1.0, v197
v_add_f32 v198, 1.0, v198
v_add_f32 v199, 1.0, v199
v_rcp_f32 v196, v196
v_rcp_f32 v197, v197
v_rcp_f32 v198, v198
v_rcp_f32 v199, v199
s_nop 0
v_fmac_f32 v184, v72, v196
v_fmac_f32 v185, v73, v197
v_fmac_f32 v186, v74, v198
v_fmac_f32 v187, v75, v199
v_cvt_pk_bf16_f32 v120, v184, v185
v_cvt_pk_bf16_f32 v121, v186, v187
buffer_store_dwordx2 v[120:121], v224, s[20:23], s99 offen offset:32
v_dot2c_f32_bf16 v76, v98, v246
v_dot2c_f32_bf16 v77, v98, v247
v_dot2c_f32_bf16 v78, v99, v246
v_dot2c_f32_bf16 v79, v99, v247
v_dot2c_f32_bf16 v76, v102, v246
v_dot2c_f32_bf16 v77, v102, v247
v_dot2c_f32_bf16 v78, v103, v246
v_dot2c_f32_bf16 v79, v103, v247
v_dot2c_f32_bf16 v76, v106, v246
v_dot2c_f32_bf16 v77, v106, v247
v_dot2c_f32_bf16 v78, v107, v246
v_dot2c_f32_bf16 v79, v107, v247
s_nop 2
v_mul_f32 v200, s50, v76
v_mul_f32 v201, s50, v77
v_mul_f32 v202, s50, v78
v_mul_f32 v203, s50, v79
v_exp_f32 v200, v200
v_exp_f32 v201, v201
v_exp_f32 v202, v202
v_exp_f32 v203, v203
v_mul_f32 v76, v76, v168
v_mul_f32 v77, v77, v169
v_mul_f32 v78, v78, v170
v_mul_f32 v79, v79, v171
v_add_f32 v200, 1.0, v200
v_add_f32 v201, 1.0, v201
v_add_f32 v202, 1.0, v202
v_add_f32 v203, 1.0, v203
v_rcp_f32 v200, v200
v_rcp_f32 v201, v201
v_rcp_f32 v202, v202
v_rcp_f32 v203, v203
s_nop 0
v_fmac_f32 v188, v76, v200
v_fmac_f32 v189, v77, v201
v_fmac_f32 v190, v78, v202
v_fmac_f32 v191, v79, v203
v_cvt_pk_bf16_f32 v122, v188, v189
v_cvt_pk_bf16_f32 v123, v190, v191
buffer_store_dwordx2 v[122:123], v225, s[20:23], s99 offen offset:32
s_waitcnt vmcnt(4)
v_dot2c_f32_bf16 v80, v108, v246
v_dot2c_f32_bf16 v81, v108, v247
v_dot2c_f32_bf16 v82, v109, v246
v_dot2c_f32_bf16 v83, v109, v247
v_dot2c_f32_bf16 v80, v110, v246
v_dot2c_f32_bf16 v81, v110, v247
v_dot2c_f32_bf16 v82, v111, v246
v_dot2c_f32_bf16 v83, v111, v247
v_dot2c_f32_bf16 v80, v112, v246
v_dot2c_f32_bf16 v81, v112, v247
v_dot2c_f32_bf16 v82, v113, v246
v_dot2c_f32_bf16 v83, v113, v247
s_nop 2
v_mul_f32 v196, s50, v80
v_mul_f32 v197, s50, v81
v_mul_f32 v198, s50, v82
v_mul_f32 v199, s50, v83
v_exp_f32 v196, v196
v_exp_f32 v197, v197
v_exp_f32 v198, v198
v_exp_f32 v199, v199
v_mul_f32 v80, v80, v172
v_mul_f32 v81, v81, v173
v_mul_f32 v82, v82, v174
v_mul_f32 v83, v83, v175
v_add_f32 v196, 1.0, v196
v_add_f32 v197, 1.0, v197
v_add_f32 v198, 1.0, v198
v_add_f32 v199, 1.0, v199
v_rcp_f32 v196, v196
v_rcp_f32 v197, v197
v_rcp_f32 v198, v198
v_rcp_f32 v199, v199
s_nop 0
v_fmac_f32 v192, v80, v196
v_fmac_f32 v193, v81, v197
v_fmac_f32 v194, v82, v198
v_fmac_f32 v195, v83, v199
v_cvt_pk_bf16_f32 v124, v192, v193
v_cvt_pk_bf16_f32 v125, v194, v195
buffer_store_dwordx2 v[124:125], v226, s[20:23], s99 offen
s_endpgm
CODE_TAIL:
KV_LOADS:
s_mul_i32 s59, s2, 7282
s_lshr_b32 s59, s59, 16
s_mul_i32 s66, s59, 9
s_sub_u32 s58, s2, s66
s_lshl_b32 s61, s58, 7
s_lshl_b32 s66, s59, 3
s_add_u32 s61, s61, s66
s_add_u32 s61, s61, 62914560
s_cmp_eq_u32 s14, 0
s_cselect_b32 s61, s61, 2146435072
s_lshl_b32 s59, s59, 2
s_add_u32 s59, s59, s14
s_lshl_b32 s59, s59, 6
v_lshrrev_b32 v191, 3, v1
v_and_b32 v209, 7, v1
v_lshl_add_u32 v210, v191, 3, s59
v_mul_u32_u24 v210, 1152, v210
s_lshl_b32 s58, s58, 3
v_add_u32 v189, s58, v209
v_lshl_add_u32 v210, v189, 4, v210
v_subrev_u32 v211, 4608, v210
v_add_u32 v190, 4608, v210
s_mov_b32 s28, s70
s_mov_b32 s29, s71
s_mov_b32 s30, 2359296
s_mov_b32 s31, 0x20000
s_mov_b32 s36, s72
s_mov_b32 s37, s73
s_mov_b32 s38, 2359296
s_mov_b32 s39, 0x20000
buffer_load_dwordx4 v[64:67], v211, s[28:31], 0 offen offset:0 nt
buffer_load_dwordx4 v[68:71], v211, s[28:31], 0 offen offset:1152 nt
buffer_load_dwordx4 v[72:75], v211, s[28:31], 0 offen offset:2304 nt
buffer_load_dwordx4 v[76:79], v211, s[28:31], 0 offen offset:3456 nt
buffer_load_dwordx4 v[80:83], v210, s[28:31], 0 offen offset:0 nt
buffer_load_dwordx4 v[84:87], v210, s[28:31], 0 offen offset:1152 nt
buffer_load_dwordx4 v[88:91], v210, s[28:31], 0 offen offset:2304 nt
buffer_load_dwordx4 v[92:95], v210, s[28:31], 0 offen offset:3456 nt
buffer_load_dwordx4 v[96:99], v190, s[28:31], 0 offen offset:0 nt
buffer_load_dwordx4 v[100:103], v190, s[28:31], 0 offen offset:1152 nt
buffer_load_dwordx4 v[104:107], v190, s[28:31], 0 offen offset:2304 nt
buffer_load_dwordx4 v[108:111], v190, s[28:31], 0 offen offset:3456 nt
buffer_load_dwordx4 v[112:115], v211, s[36:39], 0 offen offset:3456 nt
buffer_load_dwordx4 v[116:119], v210, s[36:39], 0 offen offset:0 nt
buffer_load_dwordx4 v[120:123], v210, s[36:39], 0 offen offset:1152 nt
buffer_load_dwordx4 v[124:127], v210, s[36:39], 0 offen offset:2304 nt
buffer_load_dwordx4 v[128:131], v210, s[36:39], 0 offen offset:3456 nt
buffer_load_dwordx4 v[132:135], v190, s[36:39], 0 offen offset:0 nt
buffer_load_dwordx4 v[136:139], v190, s[36:39], 0 offen offset:1152 nt
buffer_load_dwordx4 v[140:143], v190, s[36:39], 0 offen offset:2304 nt
buffer_load_dwordx4 v[144:147], v190, s[36:39], 0 offen offset:3456 nt
s_mov_b32 s28, s74
s_mov_b32 s29, s75
s_mov_b32 s30, 4608
s_mov_b32 s31, 0x20000
v_lshlrev_b32 v190, 6, v189
buffer_load_dwordx4 v[148:151], v190, s[28:31], 0 offen offset:0
buffer_load_dwordx4 v[152:155], v190, s[28:31], 0 offen offset:16
buffer_load_dwordx4 v[156:159], v190, s[28:31], 0 offen offset:32
buffer_load_dwordx4 v[160:163], v190, s[28:31], 0 offen offset:48
v_add_u32 v214, s58, v191
v_lshlrev_b32 v214, 15, v214
v_lshlrev_b32 v190, 4, v209
v_sub_u32 v214, v214, v190
s_lshl_b32 s59, s59, 1
s_sub_u32 s59, 4080, s59
v_add_u32 v214, s59, v214
s_mul_i32 s58, s14, 1152
s_add_u32 s58, s58, 155648
v_mul_u32_u24 v189, 144, v191
v_lshl_add_u32 v189, v209, 4, v189
v_add_u32 v189, s58, v189
v_mul_u32_u24 v209, 144, v209
v_lshl_add_u32 v209, v191, 4, v209
v_add_u32 v209, s58, v209
s_branch WALK_GO
KV_WAIT:
s_waitcnt vmcnt(0)
v_lshlrev_b32 v164, 16, v64
v_lshlrev_b32 v165, 16, v68
v_lshlrev_b32 v166, 16, v72
v_lshlrev_b32 v167, 16, v76
v_lshlrev_b32 v168, 16, v80
v_lshlrev_b32 v169, 16, v84
v_lshlrev_b32 v170, 16, v88
v_lshlrev_b32 v171, 16, v92
v_lshlrev_b32 v172, 16, v96
v_lshlrev_b32 v173, 16, v100
v_lshlrev_b32 v174, 16, v104
v_lshlrev_b32 v175, 16, v108
v_lshlrev_b32 v176, 16, v148
v_and_b32 v177, s80, v148
v_lshlrev_b32 v178, 16, v149
v_and_b32 v179, s80, v149
v_mul_f32 v180, v164, v179
v_mul_f32 v181, v165, v179
v_mul_f32 v182, v166, v179
v_mul_f32 v183, v167, v179
v_mul_f32 v184, v168, v179
v_mul_f32 v185, v169, v179
v_mul_f32 v186, v170, v179
v_mul_f32 v187, v171, v179
v_mul_f32 v188, v172, v179
v_fmac_f32 v180, v165, v178
v_fmac_f32 v181, v166, v178
v_fmac_f32 v182, v167, v178
v_fmac_f32 v183, v168, v178
v_fmac_f32 v184, v169, v178
v_fmac_f32 v185, v170, v178
v_fmac_f32 v186, v171, v178
v_fmac_f32 v187, v172, v178
v_fmac_f32 v188, v173, v178
v_fmac_f32 v180, v166, v177
v_fmac_f32 v181, v167, v177
v_fmac_f32 v182, v168, v177
v_fmac_f32 v183, v169, v177
v_fmac_f32 v184, v170, v177
v_fmac_f32 v185, v171, v177
v_fmac_f32 v186, v172, v177
v_fmac_f32 v187, v173, v177
v_fmac_f32 v188, v174, v177
v_fmac_f32 v180, v167, v176
v_fmac_f32 v181, v168, v176
v_fmac_f32 v182, v169, v176
v_fmac_f32 v183, v170, v176
v_fmac_f32 v184, v171, v176
v_fmac_f32 v185, v172, v176
v_fmac_f32 v186, v173, v176
v_fmac_f32 v187, v174, v176
v_fmac_f32 v188, v175, v176
v_lshlrev_b32 v164, 16, v112
v_lshlrev_b32 v165, 16, v116
v_lshlrev_b32 v166, 16, v120
v_lshlrev_b32 v167, 16, v124
v_lshlrev_b32 v168, 16, v128
v_lshlrev_b32 v169, 16, v132
v_lshlrev_b32 v170, 16, v136
v_lshlrev_b32 v171, 16, v140
v_lshlrev_b32 v172, 16, v144
v_mul_f32 v180, v180, v164
v_mul_f32 v181, v181, v165
v_mul_f32 v182, v182, v166
v_mul_f32 v183, v183, v167
v_mul_f32 v184, v184, v168
v_mul_f32 v185, v185, v169
v_mul_f32 v186, v186, v170
v_mul_f32 v187, v187, v171
v_mul_f32 v188, v188, v172
v_cvt_pk_bf16_f32 v32, v188, v187
v_cvt_pk_bf16_f32 v36, v187, v186
v_cvt_pk_bf16_f32 v33, v186, v185
v_cvt_pk_bf16_f32 v37, v185, v184
v_cvt_pk_bf16_f32 v34, v184, v183
v_cvt_pk_bf16_f32 v38, v183, v182
v_cvt_pk_bf16_f32 v35, v182, v181
v_cvt_pk_bf16_f32 v39, v181, v180
ds_write_b128 v189, v[32:35]
ds_read_b128 v[32:35], v209
ds_write_b128 v189, v[36:39]
ds_read_b128 v[36:39], v209
s_add_u32 s66, s64, 0
s_add_u32 m0, s65, 0
s_nop 0
buffer_load_dwordx4 v2, s[16:19], s66 offen offset:0 lds
buffer_load_dwordx4 v2, s[20:23], s66 offen offset:1024 lds
buffer_load_dwordx4 v3, s[16:19], s66 offen offset:2048 lds
buffer_load_dwordx4 v3, s[20:23], s66 offen offset:3072 lds
s_add_u32 s66, s64, 589824
s_add_u32 m0, s65, 4096
s_nop 0
buffer_load_dwordx4 v2, s[16:19], s66 offen offset:0 lds
buffer_load_dwordx4 v2, s[20:23], s66 offen offset:1024 lds
s_add_u32 s66, s64, 884736
s_add_u32 m0, s65, 24576
s_nop 0
buffer_load_dwordx4 v2, s[16:19], s66 offen offset:0 lds
buffer_load_dwordx4 v2, s[20:23], s66 offen offset:1024 lds
buffer_load_dwordx4 v3, s[16:19], s66 offen offset:2048 lds
buffer_load_dwordx4 v3, s[20:23], s66 offen offset:3072 lds
s_add_u32 s66, s64, 1474560
s_add_u32 m0, s65, 28672
s_nop 0
buffer_load_dwordx4 v2, s[16:19], s66 offen offset:0 lds
buffer_load_dwordx4 v2, s[20:23], s66 offen offset:1024 lds
s_add_u32 s66, s64, 1769472
s_add_u32 m0, s65, 49152
s_nop 0
buffer_load_dwordx4 v2, s[16:19], s66 offen offset:0 lds
buffer_load_dwordx4 v2, s[20:23], s66 offen offset:1024 lds
buffer_load_dwordx4 v3, s[16:19], s66 offen offset:2048 lds
buffer_load_dwordx4 v3, s[20:23], s66 offen offset:3072 lds
s_add_u32 s66, s64, 2359296
s_add_u32 m0, s65, 53248
s_nop 0
buffer_load_dwordx4 v2, s[16:19], s66 offen offset:0 lds
buffer_load_dwordx4 v2, s[20:23], s66 offen offset:1024 lds
v_and_b32 v164, s80, v64
v_and_b32 v165, s80, v68
v_and_b32 v166, s80, v72
v_and_b32 v167, s80, v76
v_and_b32 v168, s80, v80
v_and_b32 v169, s80, v84
v_and_b32 v170, s80, v88
v_and_b32 v171, s80, v92
v_and_b32 v172, s80, v96
v_and_b32 v173, s80, v100
v_and_b32 v174, s80, v104
v_and_b32 v175, s80, v108
v_lshlrev_b32 v176, 16, v150
v_and_b32 v177, s80, v150
v_lshlrev_b32 v178, 16, v151
v_and_b32 v179, s80, v151
v_mul_f32 v180, v164, v179
v_mul_f32 v181, v165, v179
v_mul_f32 v182, v166, v179
v_mul_f32 v183, v167, v179
v_mul_f32 v184, v168, v179
v_mul_f32 v185, v169, v179
v_mul_f32 v186, v170, v179
v_mul_f32 v187, v171, v179
v_mul_f32 v188, v172, v179
v_fmac_f32 v180, v165, v178
v_fmac_f32 v181, v166, v178
v_fmac_f32 v182, v167, v178
v_fmac_f32 v183, v168, v178
v_fmac_f32 v184, v169, v178
v_fmac_f32 v185, v170, v178
v_fmac_f32 v186, v171, v178
v_fmac_f32 v187, v172, v178
v_fmac_f32 v188, v173, v178
v_fmac_f32 v180, v166, v177
v_fmac_f32 v181, v167, v177
v_fmac_f32 v182, v168, v177
v_fmac_f32 v183, v169, v177
v_fmac_f32 v184, v170, v177
v_fmac_f32 v185, v171, v177
v_fmac_f32 v186, v172, v177
v_fmac_f32 v187, v173, v177
v_fmac_f32 v188, v174, v177
v_fmac_f32 v180, v167, v176
v_fmac_f32 v181, v168, v176
v_fmac_f32 v182, v169, v176
v_fmac_f32 v183, v170, v176
v_fmac_f32 v184, v171, v176
v_fmac_f32 v185, v172, v176
v_fmac_f32 v186, v173, v176
v_fmac_f32 v187, v174, v176
v_fmac_f32 v188, v175, v176
v_and_b32 v164, s80, v112
v_and_b32 v165, s80, v116
v_and_b32 v166, s80, v120
v_and_b32 v167, s80, v124
v_and_b32 v168, s80, v128
v_and_b32 v169, s80, v132
v_and_b32 v170, s80, v136
v_and_b32 v171, s80, v140
v_and_b32 v172, s80, v144
v_mul_f32 v180, v180, v164
v_mul_f32 v181, v181, v165
v_mul_f32 v182, v182, v166
v_mul_f32 v183, v183, v167
v_mul_f32 v184, v184, v168
v_mul_f32 v185, v185, v169
v_mul_f32 v186, v186, v170
v_mul_f32 v187, v187, v171
v_mul_f32 v188, v188, v172
v_cvt_pk_bf16_f32 v40, v188, v187
v_cvt_pk_bf16_f32 v44, v187, v186
v_cvt_pk_bf16_f32 v41, v186, v185
v_cvt_pk_bf16_f32 v45, v185, v184
v_cvt_pk_bf16_f32 v42, v184, v183
v_cvt_pk_bf16_f32 v46, v183, v182
v_cvt_pk_bf16_f32 v43, v182, v181
v_cvt_pk_bf16_f32 v47, v181, v180
ds_write_b128 v189, v[40:43]
ds_read_b128 v[40:43], v209
ds_write_b128 v189, v[44:47]
ds_read_b128 v[44:47], v209
v_lshlrev_b32 v164, 16, v65
v_lshlrev_b32 v165, 16, v69
v_lshlrev_b32 v166, 16, v73
v_lshlrev_b32 v167, 16, v77
v_lshlrev_b32 v168, 16, v81
v_lshlrev_b32 v169, 16, v85
v_lshlrev_b32 v170, 16, v89
v_lshlrev_b32 v171, 16, v93
v_lshlrev_b32 v172, 16, v97
v_lshlrev_b32 v173, 16, v101
v_lshlrev_b32 v174, 16, v105
v_lshlrev_b32 v175, 16, v109
v_lshlrev_b32 v176, 16, v152
v_and_b32 v177, s80, v152
v_lshlrev_b32 v178, 16, v153
v_and_b32 v179, s80, v153
v_mul_f32 v180, v164, v179
v_mul_f32 v181, v165, v179
v_mul_f32 v182, v166, v179
v_mul_f32 v183, v167, v179
v_mul_f32 v184, v168, v179
v_mul_f32 v185, v169, v179
v_mul_f32 v186, v170, v179
v_mul_f32 v187, v171, v179
v_mul_f32 v188, v172, v179
v_fmac_f32 v180, v165, v178
v_fmac_f32 v181, v166, v178
v_fmac_f32 v182, v167, v178
v_fmac_f32 v183, v168, v178
v_fmac_f32 v184, v169, v178
v_fmac_f32 v185, v170, v178
v_fmac_f32 v186, v171, v178
v_fmac_f32 v187, v172, v178
v_fmac_f32 v188, v173, v178
v_fmac_f32 v180, v166, v177
v_fmac_f32 v181, v167, v177
v_fmac_f32 v182, v168, v177
v_fmac_f32 v183, v169, v177
v_fmac_f32 v184, v170, v177
v_fmac_f32 v185, v171, v177
v_fmac_f32 v186, v172, v177
v_fmac_f32 v187, v173, v177
v_fmac_f32 v188, v174, v177
v_fmac_f32 v180, v167, v176
v_fmac_f32 v181, v168, v176
v_fmac_f32 v182, v169, v176
v_fmac_f32 v183, v170, v176
v_fmac_f32 v184, v171, v176
v_fmac_f32 v185, v172, v176
v_fmac_f32 v186, v173, v176
v_fmac_f32 v187, v174, v176
v_fmac_f32 v188, v175, v176
v_lshlrev_b32 v164, 16, v113
v_lshlrev_b32 v165, 16, v117
v_lshlrev_b32 v166, 16, v121
v_lshlrev_b32 v167, 16, v125
v_lshlrev_b32 v168, 16, v129
v_lshlrev_b32 v169, 16, v133
v_lshlrev_b32 v170, 16, v137
v_lshlrev_b32 v171, 16, v141
v_lshlrev_b32 v172, 16, v145
v_mul_f32 v180, v180, v164
v_mul_f32 v181, v181, v165
v_mul_f32 v182, v182, v166
v_mul_f32 v183, v183, v167
v_mul_f32 v184, v184, v168
v_mul_f32 v185, v185, v169
v_mul_f32 v186, v186, v170
v_mul_f32 v187, v187, v171
v_mul_f32 v188, v188, v172
v_cvt_pk_bf16_f32 v48, v188, v187
v_cvt_pk_bf16_f32 v52, v187, v186
v_cvt_pk_bf16_f32 v49, v186, v185
v_cvt_pk_bf16_f32 v53, v185, v184
v_cvt_pk_bf16_f32 v50, v184, v183
v_cvt_pk_bf16_f32 v54, v183, v182
v_cvt_pk_bf16_f32 v51, v182, v181
v_cvt_pk_bf16_f32 v55, v181, v180
ds_write_b128 v189, v[48:51]
ds_read_b128 v[48:51], v209
ds_write_b128 v189, v[52:55]
ds_read_b128 v[52:55], v209
buffer_load_dwordx2 v[58:59], v63, s[32:35], s0 offen sc1
s_waitcnt vmcnt(0)
v_cmp_ne_u64 vcc, s[94:95], v[58:59]
s_nop 1
s_cmp_lg_u64 vcc, 0
s_cbranch_scc1 SLOW_F1k
BACK_F1k:
s_mov_b32 s67, 0
s_add_u32 m0, s60, 73728
s_nop 0
buffer_load_dwordx4 v6, s[24:27], s67 offen offset:0 sc1 lds
s_mov_b32 s67, 8192
buffer_load_dwordx4 v6, s[24:27], s67 offen offset:1024 sc1 lds
s_mov_b32 s67, 16384
buffer_load_dwordx4 v6, s[24:27], s67 offen offset:2048 sc1 lds
s_mov_b32 s67, 24576
buffer_load_dwordx4 v6, s[24:27], s67 offen offset:3072 sc1 lds
s_mov_b32 s67, 128
s_add_u32 m0, s60, 90112
s_nop 0
buffer_load_dwordx4 v6, s[24:27], s67 offen offset:0 sc1 lds
s_mov_b32 s67, 8320
buffer_load_dwordx4 v6, s[24:27], s67 offen offset:1024 sc1 lds
s_mov_b32 s67, 16512
buffer_load_dwordx4 v6, s[24:27], s67 offen offset:2048 sc1 lds
s_mov_b32 s67, 24704
buffer_load_dwordx4 v6, s[24:27], s67 offen offset:3072 sc1 lds
s_mov_b32 s67, 256
s_add_u32 m0, s60, 106496
s_nop 0
buffer_load_dwordx4 v6, s[24:27], s67 offen offset:0 sc1 lds
s_mov_b32 s67, 8448
buffer_load_dwordx4 v6, s[24:27], s67 offen offset:1024 sc1 lds
s_mov_b32 s67, 16640
buffer_load_dwordx4 v6, s[24:27], s67 offen offset:2048 sc1 lds
s_mov_b32 s67, 24832
buffer_load_dwordx4 v6, s[24:27], s67 offen offset:3072 sc1 lds
v_and_b32 v164, s80, v65
v_and_b32 v165, s80, v69
v_and_b32 v166, s80, v73
v_and_b32 v167, s80, v77
v_and_b32 v168, s80, v81
v_and_b32 v169, s80, v85
v_and_b32 v170, s80, v89
v_and_b32 v171, s80, v93
v_and_b32 v172, s80, v97
v_and_b32 v173, s80, v101
v_and_b32 v174, s80, v105
v_and_b32 v175, s80, v109
v_lshlrev_b32 v176, 16, v154
v_and_b32 v177, s80, v154
v_lshlrev_b32 v178, 16, v155
v_and_b32 v179, s80, v155
v_mul_f32 v180, v164, v179
v_mul_f32 v181, v165, v179
v_mul_f32 v182, v166, v179
v_mul_f32 v183, v167, v179
v_mul_f32 v184, v168, v179
v_mul_f32 v185, v169, v179
v_mul_f32 v186, v170, v179
v_mul_f32 v187, v171, v179
v_mul_f32 v188, v172, v179
v_fmac_f32 v180, v165, v178
v_fmac_f32 v181, v166, v178
v_fmac_f32 v182, v167, v178
v_fmac_f32 v183, v168, v178
v_fmac_f32 v184, v169, v178
v_fmac_f32 v185, v170, v178
v_fmac_f32 v186, v171, v178
v_fmac_f32 v187, v172, v178
v_fmac_f32 v188, v173, v178
v_fmac_f32 v180, v166, v177
v_fmac_f32 v181, v167, v177
v_fmac_f32 v182, v168, v177
v_fmac_f32 v183, v169, v177
v_fmac_f32 v184, v170, v177
v_fmac_f32 v185, v171, v177
v_fmac_f32 v186, v172, v177
v_fmac_f32 v187, v173, v177
v_fmac_f32 v188, v174, v177
v_fmac_f32 v180, v167, v176
v_fmac_f32 v181, v168, v176
v_fmac_f32 v182, v169, v176
v_fmac_f32 v183, v170, v176
v_fmac_f32 v184, v171, v176
v_fmac_f32 v185, v172, v176
v_fmac_f32 v186, v173, v176
v_fmac_f32 v187, v174, v176
v_fmac_f32 v188, v175, v176
v_and_b32 v164, s80, v113
v_and_b32 v165, s80, v117
v_and_b32 v166, s80, v121
v_and_b32 v167, s80, v125
v_and_b32 v168, s80, v129
v_and_b32 v169, s80, v133
v_and_b32 v170, s80, v137
v_and_b32 v171, s80, v141
v_and_b32 v172, s80, v145
v_mul_f32 v180, v180, v164
v_mul_f32 v181, v181, v165
v_mul_f32 v182, v182, v166
v_mul_f32 v183, v183, v167
v_mul_f32 v184, v184, v168
v_mul_f32 v185, v185, v169
v_mul_f32 v186, v186, v170
v_mul_f32 v187, v187, v171
v_mul_f32 v188, v188, v172
v_cvt_pk_bf16_f32 v224, v188, v187
v_cvt_pk_bf16_f32 v228, v187, v186
v_cvt_pk_bf16_f32 v225, v186, v185
v_cvt_pk_bf16_f32 v229, v185, v184
v_cvt_pk_bf16_f32 v226, v184, v183
v_cvt_pk_bf16_f32 v230, v183, v182
v_cvt_pk_bf16_f32 v227, v182, v181
v_cvt_pk_bf16_f32 v231, v181, v180
ds_write_b128 v189, v[224:227]
ds_read_b128 v[224:227], v209
ds_write_b128 v189, v[228:231]
ds_read_b128 v[228:231], v209
v_lshlrev_b32 v164, 16, v66
v_lshlrev_b32 v165, 16, v70
v_lshlrev_b32 v166, 16, v74
v_lshlrev_b32 v167, 16, v78
v_lshlrev_b32 v168, 16, v82
v_lshlrev_b32 v169, 16, v86
v_lshlrev_b32 v170, 16, v90
v_lshlrev_b32 v171, 16, v94
v_lshlrev_b32 v172, 16, v98
v_lshlrev_b32 v173, 16, v102
v_lshlrev_b32 v174, 16, v106
v_lshlrev_b32 v175, 16, v110
v_lshlrev_b32 v176, 16, v156
v_and_b32 v177, s80, v156
v_lshlrev_b32 v178, 16, v157
v_and_b32 v179, s80, v157
v_mul_f32 v180, v164, v179
v_mul_f32 v181, v165, v179
v_mul_f32 v182, v166, v179
v_mul_f32 v183, v167, v179
v_mul_f32 v184, v168, v179
v_mul_f32 v185, v169, v179
v_mul_f32 v186, v170, v179
v_mul_f32 v187, v171, v179
v_mul_f32 v188, v172, v179
v_fmac_f32 v180, v165, v178
v_fmac_f32 v181, v166, v178
v_fmac_f32 v182, v167, v178
v_fmac_f32 v183, v168, v178
v_fmac_f32 v184, v169, v178
v_fmac_f32 v185, v170, v178
v_fmac_f32 v186, v171, v178
v_fmac_f32 v187, v172, v178
v_fmac_f32 v188, v173, v178
v_fmac_f32 v180, v166, v177
v_fmac_f32 v181, v167, v177
v_fmac_f32 v182, v168, v177
v_fmac_f32 v183, v169, v177
v_fmac_f32 v184, v170, v177
v_fmac_f32 v185, v171, v177
v_fmac_f32 v186, v172, v177
v_fmac_f32 v187, v173, v177
v_fmac_f32 v188, v174, v177
v_fmac_f32 v180, v167, v176
v_fmac_f32 v181, v168, v176
v_fmac_f32 v182, v169, v176
v_fmac_f32 v183, v170, v176
v_fmac_f32 v184, v171, v176
v_fmac_f32 v185, v172, v176
v_fmac_f32 v186, v173, v176
v_fmac_f32 v187, v174, v176
v_fmac_f32 v188, v175, v176
v_lshlrev_b32 v164, 16, v114
v_lshlrev_b32 v165, 16, v118
v_lshlrev_b32 v166, 16, v122
v_lshlrev_b32 v167, 16, v126
v_lshlrev_b32 v168, 16, v130
v_lshlrev_b32 v169, 16, v134
v_lshlrev_b32 v170, 16, v138
v_lshlrev_b32 v171, 16, v142
v_lshlrev_b32 v172, 16, v146
v_mul_f32 v180, v180, v164
v_mul_f32 v181, v181, v165
v_mul_f32 v182, v182, v166
v_mul_f32 v183, v183, v167
v_mul_f32 v184, v184, v168
v_mul_f32 v185, v185, v169
v_mul_f32 v186, v186, v170
v_mul_f32 v187, v187, v171
v_mul_f32 v188, v188, v172
s_waitcnt lgkmcnt(0)
s_mov_b32 s67, 4194304
buffer_store_dwordx4 v[32:35], v214, s[32:35], s67 offen sc1
s_mov_b32 s67, 11534336
buffer_store_dwordx4 v[36:39], v214, s[32:35], s67 offen sc1
v_cvt_pk_bf16_f32 v232, v188, v187
v_cvt_pk_bf16_f32 v236, v187, v186
v_cvt_pk_bf16_f32 v233, v186, v185
v_cvt_pk_bf16_f32 v237, v185, v184
v_cvt_pk_bf16_f32 v234, v184, v183
v_cvt_pk_bf16_f32 v238, v183, v182
v_cvt_pk_bf16_f32 v235, v182, v181
v_cvt_pk_bf16_f32 v239, v181, v180
ds_write_b128 v189, v[232:235]
ds_read_b128 v[232:235], v209
ds_write_b128 v189, v[236:239]
ds_read_b128 v[236:239], v209
v_and_b32 v164, s80, v66
v_and_b32 v165, s80, v70
v_and_b32 v166, s80, v74
v_and_b32 v167, s80, v78
v_and_b32 v168, s80, v82
v_and_b32 v169, s80, v86
v_and_b32 v170, s80, v90
v_and_b32 v171, s80, v94
v_and_b32 v172, s80, v98
v_and_b32 v173, s80, v102
v_and_b32 v174, s80, v106
v_and_b32 v175, s80, v110
v_lshlrev_b32 v176, 16, v158
v_and_b32 v177, s80, v158
v_lshlrev_b32 v178, 16, v159
v_and_b32 v179, s80, v159
v_mul_f32 v180, v164, v179
v_mul_f32 v181, v165, v179
v_mul_f32 v182, v166, v179
v_mul_f32 v183, v167, v179
v_mul_f32 v184, v168, v179
v_mul_f32 v185, v169, v179
v_mul_f32 v186, v170, v179
v_mul_f32 v187, v171, v179
v_mul_f32 v188, v172, v179
v_fmac_f32 v180, v165, v178
v_fmac_f32 v181, v166, v178
v_fmac_f32 v182, v167, v178
v_fmac_f32 v183, v168, v178
v_fmac_f32 v184, v169, v178
v_fmac_f32 v185, v170, v178
v_fmac_f32 v186, v171, v178
v_fmac_f32 v187, v172, v178
v_fmac_f32 v188, v173, v178
v_fmac_f32 v180, v166, v177
v_fmac_f32 v181, v167, v177
v_fmac_f32 v182, v168, v177
v_fmac_f32 v183, v169, v177
v_fmac_f32 v184, v170, v177
v_fmac_f32 v185, v171, v177
v_fmac_f32 v186, v172, v177
v_fmac_f32 v187, v173, v177
v_fmac_f32 v188, v174, v177
v_fmac_f32 v180, v167, v176
v_fmac_f32 v181, v168, v176
v_fmac_f32 v182, v169, v176
v_fmac_f32 v183, v170, v176
v_fmac_f32 v184, v171, v176
v_fmac_f32 v185, v172, v176
v_fmac_f32 v186, v173, v176
v_fmac_f32 v187, v174, v176
v_fmac_f32 v188, v175, v176
v_and_b32 v164, s80, v114
v_and_b32 v165, s80, v118
v_and_b32 v166, s80, v122
v_and_b32 v167, s80, v126
v_and_b32 v168, s80, v130
v_and_b32 v169, s80, v134
v_and_b32 v170, s80, v138
v_and_b32 v171, s80, v142
v_and_b32 v172, s80, v146
v_mul_f32 v180, v180, v164
v_mul_f32 v181, v181, v165
v_mul_f32 v182, v182, v166
v_mul_f32 v183, v183, v167
v_mul_f32 v184, v184, v168
v_mul_f32 v185, v185, v169
v_mul_f32 v186, v186, v170
v_mul_f32 v187, v187, v171
v_mul_f32 v188, v188, v172
s_waitcnt lgkmcnt(0)
s_mov_b32 s67, 4198400
buffer_store_dwordx4 v[40:43], v214, s[32:35], s67 offen sc1
s_mov_b32 s67, 11538432
buffer_store_dwordx4 v[44:47], v214, s[32:35], s67 offen sc1
s_waitcnt lgkmcnt(0)
s_mov_b32 s67, 4202496
buffer_store_dwordx4 v[48:51], v214, s[32:35], s67 offen sc1
s_mov_b32 s67, 11542528
buffer_store_dwordx4 v[52:55], v214, s[32:35], s67 offen sc1
v_cvt_pk_bf16_f32 v240, v188, v187
v_cvt_pk_bf16_f32 v244, v187, v186
v_cvt_pk_bf16_f32 v241, v186, v185
v_cvt_pk_bf16_f32 v245, v185, v184
v_cvt_pk_bf16_f32 v242, v184, v183
v_cvt_pk_bf16_f32 v246, v183, v182
v_cvt_pk_bf16_f32 v243, v182, v181
v_cvt_pk_bf16_f32 v247, v181, v180
ds_write_b128 v189, v[240:243]
ds_read_b128 v[240:243], v209
ds_write_b128 v189, v[244:247]
ds_read_b128 v[244:247], v209
v_lshlrev_b32 v164, 16, v67
v_lshlrev_b32 v165, 16, v71
v_lshlrev_b32 v166, 16, v75
v_lshlrev_b32 v167, 16, v79
v_lshlrev_b32 v168, 16, v83
v_lshlrev_b32 v169, 16, v87
v_lshlrev_b32 v170, 16, v91
v_lshlrev_b32 v171, 16, v95
v_lshlrev_b32 v172, 16, v99
v_lshlrev_b32 v173, 16, v103
v_lshlrev_b32 v174, 16, v107
v_lshlrev_b32 v175, 16, v111
v_lshlrev_b32 v176, 16, v160
v_and_b32 v177, s80, v160
v_lshlrev_b32 v178, 16, v161
v_and_b32 v179, s80, v161
v_mul_f32 v180, v164, v179
v_mul_f32 v181, v165, v179
v_mul_f32 v182, v166, v179
v_mul_f32 v183, v167, v179
v_mul_f32 v184, v168, v179
v_mul_f32 v185, v169, v179
v_mul_f32 v186, v170, v179
v_mul_f32 v187, v171, v179
v_mul_f32 v188, v172, v179
v_fmac_f32 v180, v165, v178
v_fmac_f32 v181, v166, v178
v_fmac_f32 v182, v167, v178
v_fmac_f32 v183, v168, v178
v_fmac_f32 v184, v169, v178
v_fmac_f32 v185, v170, v178
v_fmac_f32 v186, v171, v178
v_fmac_f32 v187, v172, v178
v_fmac_f32 v188, v173, v178
v_fmac_f32 v180, v166, v177
v_fmac_f32 v181, v167, v177
v_fmac_f32 v182, v168, v177
v_fmac_f32 v183, v169, v177
v_fmac_f32 v184, v170, v177
v_fmac_f32 v185, v171, v177
v_fmac_f32 v186, v172, v177
v_fmac_f32 v187, v173, v177
v_fmac_f32 v188, v174, v177
v_fmac_f32 v180, v167, v176
v_fmac_f32 v181, v168, v176
v_fmac_f32 v182, v169, v176
v_fmac_f32 v183, v170, v176
v_fmac_f32 v184, v171, v176
v_fmac_f32 v185, v172, v176
v_fmac_f32 v186, v173, v176
v_fmac_f32 v187, v174, v176
v_fmac_f32 v188, v175, v176
v_lshlrev_b32 v164, 16, v115
v_lshlrev_b32 v165, 16, v119
v_lshlrev_b32 v166, 16, v123
v_lshlrev_b32 v167, 16, v127
v_lshlrev_b32 v168, 16, v131
v_lshlrev_b32 v169, 16, v135
v_lshlrev_b32 v170, 16, v139
v_lshlrev_b32 v171, 16, v143
v_lshlrev_b32 v172, 16, v147
v_mul_f32 v180, v180, v164
v_mul_f32 v181, v181, v165
v_mul_f32 v182, v182, v166
v_mul_f32 v183, v183, v167
v_mul_f32 v184, v184, v168
v_mul_f32 v185, v185, v169
v_mul_f32 v186, v186, v170
v_mul_f32 v187, v187, v171
v_mul_f32 v188, v188, v172
s_waitcnt lgkmcnt(0)
s_mov_b32 s67, 4206592
buffer_store_dwordx4 v[224:227], v214, s[32:35], s67 offen sc1
s_mov_b32 s67, 11546624
buffer_store_dwordx4 v[228:231], v214, s[32:35], s67 offen sc1
s_waitcnt lgkmcnt(0)
s_mov_b32 s67, 4210688
buffer_store_dwordx4 v[232:235], v214, s[32:35], s67 offen sc1
s_mov_b32 s67, 11550720
buffer_store_dwordx4 v[236:239], v214, s[32:35], s67 offen sc1
v_cvt_pk_bf16_f32 v248, v188, v187
v_cvt_pk_bf16_f32 v252, v187, v186
v_cvt_pk_bf16_f32 v249, v186, v185
v_cvt_pk_bf16_f32 v253, v185, v184
v_cvt_pk_bf16_f32 v250, v184, v183
v_cvt_pk_bf16_f32 v254, v183, v182
v_cvt_pk_bf16_f32 v251, v182, v181
v_cvt_pk_bf16_f32 v255, v181, v180
ds_write_b128 v189, v[248:251]
ds_read_b128 v[248:251], v209
ds_write_b128 v189, v[252:255]
ds_read_b128 v[252:255], v209
v_and_b32 v164, s80, v67
v_and_b32 v165, s80, v71
v_and_b32 v166, s80, v75
v_and_b32 v167, s80, v79
v_and_b32 v168, s80, v83
v_and_b32 v169, s80, v87
v_and_b32 v170, s80, v91
v_and_b32 v171, s80, v95
v_and_b32 v172, s80, v99
v_and_b32 v173, s80, v103
v_and_b32 v174, s80, v107
v_and_b32 v175, s80, v111
v_lshlrev_b32 v176, 16, v162
v_and_b32 v177, s80, v162
v_lshlrev_b32 v178, 16, v163
v_and_b32 v179, s80, v163
v_mul_f32 v180, v164, v179
v_mul_f32 v181, v165, v179
v_mul_f32 v182, v166, v179
v_mul_f32 v183, v167, v179
v_mul_f32 v184, v168, v179
v_mul_f32 v185, v169, v179
v_mul_f32 v186, v170, v179
v_mul_f32 v187, v171, v179
v_mul_f32 v188, v172, v179
v_fmac_f32 v180, v165, v178
v_fmac_f32 v181, v166, v178
v_fmac_f32 v182, v167, v178
v_fmac_f32 v183, v168, v178
v_fmac_f32 v184, v169, v178
v_fmac_f32 v185, v170, v178
v_fmac_f32 v186, v171, v178
v_fmac_f32 v187, v172, v178
v_fmac_f32 v188, v173, v178
v_fmac_f32 v180, v166, v177
v_fmac_f32 v181, v167, v177
v_fmac_f32 v182, v168, v177
v_fmac_f32 v183, v169, v177
v_fmac_f32 v184, v170, v177
v_fmac_f32 v185, v171, v177
v_fmac_f32 v186, v172, v177
v_fmac_f32 v187, v173, v177
v_fmac_f32 v188, v174, v177
v_fmac_f32 v180, v167, v176
v_fmac_f32 v181, v168, v176
v_fmac_f32 v182, v169, v176
v_fmac_f32 v183, v170, v176
v_fmac_f32 v184, v171, v176
v_fmac_f32 v185, v172, v176
v_fmac_f32 v186, v173, v176
v_fmac_f32 v187, v174, v176
v_fmac_f32 v188, v175, v176
v_and_b32 v164, s80, v115
v_and_b32 v165, s80, v119
v_and_b32 v166, s80, v123
v_and_b32 v167, s80, v127
v_and_b32 v168, s80, v131
v_and_b32 v169, s80, v135
v_and_b32 v170, s80, v139
v_and_b32 v171, s80, v143
v_and_b32 v172, s80, v147
v_mul_f32 v180, v180, v164
v_mul_f32 v181, v181, v165
v_mul_f32 v182, v182, v166
v_mul_f32 v183, v183, v167
v_mul_f32 v184, v184, v168
v_mul_f32 v185, v185, v169
v_mul_f32 v186, v186, v170
v_mul_f32 v187, v187, v171
v_mul_f32 v188, v188, v172
s_waitcnt lgkmcnt(0)
s_mov_b32 s67, 4214784
buffer_store_dwordx4 v[240:243], v214, s[32:35], s67 offen sc1
s_mov_b32 s67, 11554816
buffer_store_dwordx4 v[244:247], v214, s[32:35], s67 offen sc1
s_waitcnt lgkmcnt(0)
s_mov_b32 s67, 4218880
buffer_store_dwordx4 v[248:251], v214, s[32:35], s67 offen sc1
s_mov_b32 s67, 11558912
buffer_store_dwordx4 v[252:255], v214, s[32:35], s67 offen sc1
v_cvt_pk_bf16_f32 v32, v188, v187
v_cvt_pk_bf16_f32 v36, v187, v186
v_cvt_pk_bf16_f32 v33, v186, v185
v_cvt_pk_bf16_f32 v37, v185, v184
v_cvt_pk_bf16_f32 v34, v184, v183
v_cvt_pk_bf16_f32 v38, v183, v182
v_cvt_pk_bf16_f32 v35, v182, v181
v_cvt_pk_bf16_f32 v39, v181, v180
ds_write_b128 v189, v[32:35]
ds_read_b128 v[32:35], v209
ds_write_b128 v189, v[36:39]
ds_read_b128 v[36:39], v209
s_waitcnt lgkmcnt(0)
s_mov_b32 s67, 4222976
buffer_store_dwordx4 v[32:35], v214, s[32:35], s67 offen sc1
s_mov_b32 s67, 11563008
buffer_store_dwordx4 v[36:39], v214, s[32:35], s67 offen sc1
s_nop 1
s_waitcnt vmcnt(16)
s_branch KV_BACK
KV_CODE_END:
SLOW_F3A:
s_mov_b32 s98, 0
SLOWL_F3A:
s_sleep 1
buffer_load_dwordx2 v[2:3], v19, s[32:35], s56 offen sc1
s_waitcnt vmcnt(0)
v_cmp_ne_u64 vcc, s[94:95], v[2:3]
s_add_u32 s98, s98, 1
s_cmp_gt_u32 s98, 524288
s_cbranch_scc1 BACK_F3A
s_cmp_lg_u64 vcc, 0
s_cbranch_scc1 SLOWL_F3A
s_branch BACK_F3A
SLOW_F2:
s_mov_b32 s98, 0
SLOWL_F2:
s_sleep 1
buffer_load_dwordx2 v[210:211], v18, s[32:35], s44 offen sc1
s_waitcnt vmcnt(0)
v_cmp_ne_u64 vcc, s[94:95], v[210:211]
s_add_u32 s98, s98, 1
s_cmp_gt_u32 s98, 524288
s_cbranch_scc1 BACK_F2
s_cmp_lg_u64 vcc, 0
s_cbranch_scc1 SLOWL_F2
s_branch BACK_F2
SLOW_F3B1:
s_mov_b32 s98, 0
SLOWL_F3B1:
s_sleep 1
buffer_load_dwordx2 v[22:23], v19, s[32:35], s44 offen sc1
s_waitcnt vmcnt(0)
v_cmp_ne_u64 vcc, s[94:95], v[22:23]
s_add_u32 s98, s98, 1
s_cmp_gt_u32 s98, 524288
s_cbranch_scc1 BACK_F3B1
s_cmp_lg_u64 vcc, 0
s_cbranch_scc1 SLOWL_F3B1
s_branch BACK_F3B1
SLOW_F3Cc:
s_mov_b32 s98, 0
SLOWL_F3Cc:
s_sleep 1
buffer_load_dwordx2 v[22:23], v19, s[32:35], s51 offen sc1
s_waitcnt vmcnt(0)
v_cmp_ne_u64 vcc, s[94:95], v[22:23]
s_add_u32 s98, s98, 1
s_cmp_gt_u32 s98, 524288
s_cbranch_scc1 BACK_F3Cc
s_cmp_lg_u64 vcc, 0
s_cbranch_scc1 SLOWL_F3Cc
s_branch BACK_F3Cc
SLOW_F4c:
s_mov_b32 s98, 0
SLOWL_F4c:
s_sleep 1
buffer_load_dwordx2 v[22:23], v6, s[32:35], s100 offen sc1
s_waitcnt vmcnt(0)
v_cmp_ne_u64 vcc, s[94:95], v[22:23]
s_add_u32 s98, s98, 1
s_cmp_gt_u32 s98, 524288
s_cbranch_scc1 BACK_F4c
s_cmp_lg_u64 vcc, 0
s_cbranch_scc1 SLOWL_F4c
s_branch BACK_F4c
SLOW_F3Bk:
s_mov_b32 s98, 0
SLOWL_F3Bk:
s_sleep 1
buffer_load_dwordx2 v[22:23], v19, s[32:35], s44 offen sc1
s_waitcnt vmcnt(0)
v_cmp_ne_u64 vcc, s[94:95], v[22:23]
s_add_u32 s98, s98, 1
s_cmp_gt_u32 s98, 524288
s_cbranch_scc1 BACK_F3Bk
s_cmp_lg_u64 vcc, 0
s_cbranch_scc1 SLOWL_F3Bk
s_branch BACK_F3Bk
SLOW_F3Ck:
s_mov_b32 s98, 0
SLOWL_F3Ck:
s_sleep 1
buffer_load_dwordx2 v[22:23], v19, s[32:35], s51 offen sc1
s_waitcnt vmcnt(0)
v_cmp_ne_u64 vcc, s[94:95], v[22:23]
s_add_u32 s98, s98, 1
s_cmp_gt_u32 s98, 524288
s_cbranch_scc1 BACK_F3Ck
s_cmp_lg_u64 vcc, 0
s_cbranch_scc1 SLOWL_F3Ck
s_branch BACK_F3Ck
SLOW_F4k:
s_mov_b32 s98, 0
SLOWL_F4k:
s_sleep 1
buffer_load_dwordx2 v[22:23], v6, s[32:35], s100 offen sc1
s_waitcnt vmcnt(0)
v_cmp_ne_u64 vcc, s[94:95], v[22:23]
s_add_u32 s98, s98, 1
s_cmp_gt_u32 s98, 524288
s_cbranch_scc1 BACK_F4k
s_cmp_lg_u64 vcc, 0
s_cbranch_scc1 SLOWL_F4k
s_branch BACK_F4k
SLOW_F1k:
s_mov_b32 s98, 0
SLOWL_F1k:
buffer_load_dwordx2 v[58:59], v63, s[32:35], s0 offen sc1
s_waitcnt vmcnt(0)
v_cmp_ne_u64 vcc, s[94:95], v[58:59]
s_add_u32 s98, s98, 1
s_cmp_gt_u32 s98, 524288
s_cbranch_scc1 BACK_F1k
s_cmp_lg_u64 vcc, 0
s_cbranch_scc1 SLOWL_F1k
s_branch BACK_F1k
.set NEXT_g0, STUB_g4
.set NEXT_g1, STUB_g5
.set NEXT_g2, STUB_g6
.set NEXT_g3, STUB_g7
.set NEXT_g4, STUB_g8
.set NEXT_g5, STUB_g9
.set NEXT_g6, STUB_g10
.set NEXT_g7, STUB_g11
.set NEXT_g8, WALK_DONE
.set NEXT_g9, WALK_DONE
.set NEXT_g10, WALK_DONE
.set NEXT_g11, WALK_DONE
MAIN_END:
.set WALK_0, STUB_g0
.set WALK_1, STUB_g1
.set WALK_2, STUB_g2
.set WALK_3, STUB_g3
K_EXIT:
s_endpgm
.section .rodata,"a"
.p2align 6
.amdhsa_kernel recurrent_scan__ssm_conv_h3__glu_gated_bilinear__prompt_kernel
  .amdhsa_next_free_vgpr 512
  .amdhsa_next_free_sgpr 102
  .amdhsa_accum_offset 256
  .amdhsa_group_segment_fixed_size 0
  .amdhsa_kernarg_size 104
  .amdhsa_user_sgpr_count 2
  .amdhsa_user_sgpr_kernarg_segment_ptr 1
  .amdhsa_system_sgpr_workgroup_id_x 1
  .amdhsa_float_denorm_mode_32 3
.end_amdhsa_kernel
```
